```python
import torch

def _softmax(x, axis=-1):
    return torch.softmax(x, dim=axis)
def _gelu(x):
    return torch.nn.functional.gelu(x, approximate="tanh")
def _silu(x):
    return torch.nn.functional.silu(x)
def _sigmoid(x):
    return torch.sigmoid(x)
def _layernorm(x, axis=-1, eps=1e-5):
    m = x.mean(dim=axis, keepdim=True)
    v = x.var(dim=axis, keepdim=True, unbiased=False)
    return (x - m) / torch.sqrt(v + eps)
def _scatter_add(tgt, idx, src, axis=0):
    return tgt.clone().index_add_(axis, idx, src)
def _segment_sum(src, seg, n):
    out = torch.zeros((n,) + src.shape[1:], dtype=src.dtype)
    return out.index_add_(0, seg, src)
def _pad(x, pw):
    flat = tuple(v for pair in reversed(pw) for v in pair)
    return torch.nn.functional.pad(x, flat)

kernel_name = 'gated_mix__sliding_block__glu_gated_glu__prompt'

def setup_inputs():

    _w = (lambda a: (lambda t: t.to(torch.bfloat16) if t.is_floating_point() else t)(torch.as_tensor(a)))
    def _A_setup():
        B, S, D = 1, 2048, 448
        return {
            "x": _w((lambda *s: torch.randn(*s, dtype=torch.bfloat16) * 0.05)(B, S, D)),
            "wqkv": _w((lambda *s: torch.randn(*s, dtype=torch.bfloat16) * 1.6)(D, 3 * D)),
            "wo": _w((lambda *s: torch.randn(*s, dtype=torch.bfloat16) * 0.05)(D, D)),
        }
    _A_in = _A_setup()

    def _B_setup():
        B, S, D, F = 1, 2048, 448, 1792
        return {
            "x": _w((lambda *s: torch.randn(*s, dtype=torch.bfloat16) * 0.05)(B, S, D)),
            "w_gate": _w((lambda *s: torch.randn(*s, dtype=torch.bfloat16) * 3.2)(D, F)),
            "w_up": _w((lambda *s: torch.randn(*s, dtype=torch.bfloat16) * 0.2)(D, F)),
            "w_down": _w((lambda *s: torch.randn(*s, dtype=torch.bfloat16) * 0.2)(F, D)),
        }
    _B_in = _B_setup()

    return {
        "A_x": _A_in["x"],
        "A_wqkv": _A_in["wqkv"],
        "A_wo": _A_in["wo"],
        "B_x": _B_in["x"],
        "B_w_gate": _B_in["w_gate"],
        "B_w_up": _B_in["w_up"],
        "B_w_down": _B_in["w_down"],
        "gate_w": _w((lambda *s: torch.randn(*s, dtype=torch.bfloat16) * 0.05)(448) * 16.0),
    }

def reference(A_x, A_wqkv, A_wo, B_x, B_w_gate, B_w_up, B_w_down, gate_w):
    def _A_ref(x, wqkv, wo):
        B, S, D = x.shape
        H = 16; Dh = D // H; W = 256
        qkv = (lambda x, *d: x.permute(*d))((x @ wqkv).reshape(B, S, 3, H, Dh), 2, 0, 3, 1, 4)
        q, k, v = qkv[0], qkv[1], qkv[2]
        scores = torch.einsum("bhqd,bhkd->bhqk", q, k) * (Dh ** -0.5)
        idx = torch.arange(S)
        mask = (idx[:, None] - idx[None, :] >= 0) & (idx[:, None] - idx[None, :] < W)
        scores = torch.where(mask[None, None], scores, -1e9)
        p = _softmax(scores, axis=-1)
        o = torch.einsum("bhqk,bhkd->bhqd", p, v)
        return (lambda x, *d: x.permute(*d))(o, 0, 2, 1, 3).reshape(B, S, D) @ wo

    def _B_ref(x, w_gate, w_up, w_down):
        g = torch.einsum("bsd,df->bsf", x, w_gate)
        u = torch.einsum("bsd,df->bsf", x, w_up)
        h = _sigmoid(g) * u
        return torch.einsum("bsf,fd->bsd", h, w_down)

    x = A_x
    g = _sigmoid((x * gate_w).sum(-1, keepdims=True))
    a = _A_ref(x, A_wqkv, A_wo)
    b = _B_ref(x, B_w_gate, B_w_up, B_w_down)
    return g * a + (1 - g) * b
```

```asm
; @launch grid=(256,1,1) block=(256,1,1) lds=163840
.amdgcn_target "amdgcn-amd-amdhsa--gfx950"
.text
.globl gated_mix__sliding_block__glu_gated_glu__prompt_kernel
.p2align 8
.type gated_mix__sliding_block__glu_gated_glu__prompt_kernel,@function
gated_mix__sliding_block__glu_gated_glu__prompt_kernel:
    s_load_dwordx16 s[36:51], s[0:1], 0
    s_load_dwordx4 s[52:55], s[0:1], 64
    s_load_dwordx2 s[96:97], s[0:1], 80
    s_cmp_ge_u32 s2, 256
    s_cbranch_scc1 L_end
    v_lshrrev_b32 v2, 6, v0
    v_and_b32 v1, 63, v0
    s_lshr_b32 s30, s2, 3
    v_readfirstlane_b32 s4, v2
    s_getpc_b64 s[32:33]
L_pc:
    s_and_b32 s31, s30, 7
    s_lshl_b32 s31, s31, 6
    v_lshlrev_b32 v2, 4, v2
    v_and_or_b32 v2, v1, 15, v2
    v_add_lshl_u32 v2, v2, s31, 7
    v_min_u32 v2, L_code_end-L_pc-4, v2
    v_mov_b32 v3, s33
    v_add_co_u32 v2, vcc, s32, v2
    s_and_b32 s29, s2, 7
    s_and_b32 s31, s29, 1
    v_addc_co_u32 v3, vcc, 0, v3, vcc
    global_load_dword v37, v[2:3], off
    s_and_b32 s32, s30, 7
    s_lshl3_add_u32 s5, s31, s32
    s_lshr_b32 s31, s29, 1
    s_lshr_b32 s32, s30, 3
    s_xor_b32 s32, s32, 3
    s_lshl2_add_u32 s6, s31, s32
    s_lshl2_add_u32 s22, s5, s4
    s_mul_i32 s9, s22, 28672
    s_lshl_b32 s13, s4, 12
    s_lshl1_add_u32 s29, s32, s5
    s_mul_i32 s30, s29, 37
    s_lshr_b32 s30, s30, 8
    s_mul_i32 s30, s30, 7
    s_sub_u32 s29, s29, s30
    v_lshrrev_b32 v2, 3, v1
    v_and_b32 v3, 7, v1
    v_lshrrev_b32 v4, 4, v1
    v_mul_u32_u24 v5, 896, v2
    v_xor_b32 v6, v4, v3
    v_lshl_add_u32 v8, v6, 4, v5
    v_xor_b32 v5, 64, v8
    v_add_u32 v9, 6144, v5
    v_add_u32 v10, 12288, v8
    v_add_u32 v11, 12288, v9
    s_waitcnt lgkmcnt(0)
    s_lshl_b32 s0, s29, 6
    s_mov_b32 s56, s36
    s_and_b32 s57, s37, 0xffff
    s_mov_b32 s58, 1835008
    s_mov_b32 s59, 0x20000
    s_cmp_ge_u32 s6, 14
    s_cbranch_scc1 L_typeB
    s_add_u32 m0, s13, 0
    s_lshl1_add_u32 s15, s0, s9
    buffer_load_dwordx4 v8, s[56:59], s15 offen offset:0 lds
    buffer_load_dwordx4 v9, s[56:59], s15 offen offset:1024 lds
    buffer_load_dwordx4 v10, s[56:59], s15 offen offset:2048 lds
    buffer_load_dwordx4 v11, s[56:59], s15 offen offset:3072 lds
    v_and_b32 v6, 1, v4
    s_lshl_b32 s12, s4, 11
    s_mul_i32 s29, s4, 43008
    s_lshl_b32 s10, s6, 7
    s_cmp_eq_u32 s6, 15
    s_cselect_b32 s30, 384, 0
    s_add_u32 s10, s10, s30
    s_add_u32 s10, s10, s29
    v_lshlrev_b32 v7, 2, v6
    v_xor_b32 v7, v7, v3
    v_mul_u32_u24 v5, 2688, v2
    v_lshl_add_u32 v12, v7, 4, v5
    v_add_u32 v13, 20480, v12
    s_mov_b32 s60, s38
    s_and_b32 s61, s39, 0xffff
    s_mov_b32 s62, 1204224
    s_mov_b32 s63, 0x20000
    s_add_u32 s1, s0, 64
    s_cmp_eq_u32 s1, 448
    s_cselect_b32 s1, 0, s1
    s_add_u32 m0, s12, 16384
    s_mul_i32 s15, s0, 2688
    s_add_u32 s15, s15, s10
    buffer_load_dwordx4 v12, s[60:63], s15 offen offset:0 lds
    buffer_load_dwordx4 v13, s[60:63], s15 offen offset:1024 lds
    v_lshlrev_b32 v7, 1, v6
    v_xor_b32 v7, v7, v3
    v_mul_u32_u24 v5, 3584, v2
    v_lshl_add_u32 v14, v7, 4, v5
    v_add_u32 v15, 27648, v14
    v_lshlrev_b32 v7, 1, v6
    v_xor_b32 v7, v7, v3
    v_xor_b32 v7, 4, v7
    v_mul_u32_u24 v5, 3584, v2
    v_lshl_add_u32 v16, v7, 4, v5
    v_add_u32 v17, 27648, v16
    v_lshlrev_b32 v7, 2, v6
    v_xor_b32 v7, v7, v3
    v_mul_u32_u24 v5, 896, v2
    v_lshl_add_u32 v28, v7, 4, v5
    v_add_u32 v29, 6144, v28
    s_and_b32 s7, s4, 1
    s_lshr_b32 s8, s4, 1
    s_lshl_b32 s11, s6, 8
    s_mul_i32 s29, s4, 57344
    s_add_u32 s11, s11, s29
    s_mov_b32 s64, s44
    s_and_b32 s65, s45, 0xffff
    s_mov_b32 s66, 1605632
    s_mov_b32 s67, 0x20000
    s_mov_b32 s68, s46
    s_and_b32 s69, s47, 0xffff
    s_mov_b32 s70, 1605632
    s_mov_b32 s71, 0x20000
    s_mov_b32 s72, s96
    s_and_b32 s73, s97, 0xffff
    s_mov_b32 s74, 18874368
    s_mov_b32 s75, 0x20000
    s_mov_b32 s80, s40
    s_and_b32 s81, s41, 0xffff
    s_mov_b32 s82, 401408
    s_mov_b32 s83, 0x20000
    s_mov_b32 s76, s48
    s_and_b32 s77, s49, 0xffff
    s_mov_b32 s78, 1605632
    s_mov_b32 s79, 0x20000
    s_mov_b32 s84, s52
    s_and_b32 s85, s53, 0xffff
    s_mov_b32 s86, 1835008
    s_mov_b32 s87, 0x20000
    s_mov_b32 s88, s50
    s_and_b32 s89, s51, 0xffff
    s_mov_b32 s90, 896
    s_mov_b32 s91, 0x20000
    s_mov_b32 s92, s54
    s_and_b32 s93, s55, 0xffff
    s_mov_b32 s94, 256
    s_mov_b32 s95, 0x20000
    s_add_u32 s3, s1, 64
    s_cmp_eq_u32 s3, 448
    s_cselect_b32 s3, 0, s3
    s_add_u32 s96, s3, 64
    s_cmp_eq_u32 s96, 448
    s_cselect_b32 s96, 0, s96
    s_add_u32 s97, s96, 64
    s_cmp_eq_u32 s97, 448
    s_cselect_b32 s97, 0, s97
    s_add_u32 s40, s97, 64
    s_cmp_eq_u32 s40, 448
    s_cselect_b32 s40, 0, s40
    s_add_u32 s41, s40, 64
    s_cmp_eq_u32 s41, 448
    s_cselect_b32 s41, 0, s41
    v_and_b32 v2, 31, v1
    v_lshrrev_b32 v3, 5, v1
    v_bfe_u32 v4, v1, 1, 3
    v_xor_b32 v4, v4, v3
    v_lshlrev_b32 v4, 4, v4
    v_lshlrev_b32 v5, 7, v2
    s_lshl_b32 s29, s7, 13
    v_add_u32 v5, s29, v5
    v_xor_b32 v6, 0, v4
    v_add_u32 v18, v5, v6
    v_xor_b32 v6, 32, v4
    v_add_u32 v19, v5, v6
    v_xor_b32 v6, 64, v4
    v_add_u32 v20, v5, v6
    v_xor_b32 v6, 96, v4
    v_add_u32 v21, v5, v6
    v_mul_u32_u24 v6, 7168, v3
    v_lshl_add_u32 v27, v2, 4, v6
    v_bfe_u32 v2, v1, 2, 2
    v_and_b32 v6, 3, v1
    v_bfe_u32 v4, v1, 4, 1
    v_lshl_add_u32 v5, v3, 3, v2
    v_lshlrev_b32 v5, 7, v5
    v_lshl_add_u32 v5, v6, 3, v5
    v_lshl_add_u32 v3, v3, 2, v2
    v_lshlrev_b32 v3, 7, v3
    v_lshl_add_u32 v3, v6, 3, v3
    v_lshrrev_b32 v6, 1, v2
    v_xor_b32 v7, s8, v6
    v_lshlrev_b32 v7, 6, v7
    v_lshl_add_u32 v7, v4, 5, v7
    v_add_u32 v22, v5, v7
    v_add_u32 v3, s12, v3
    v_xor_b32 v7, s7, v6
    v_lshlrev_b32 v7, 6, v7
    v_lshl_add_u32 v7, v4, 5, v7
    v_add_u32 v30, v3, v7
    v_xor_b32 v7, 64, v7
    v_add_u32 v31, v3, v7
    v_lshl_add_u32 v6, v4, 1, v6
    v_lshl_add_u32 v5, v4, 13, v5
    s_lshl_b32 s29, s8, 1
    v_xor_b32 v7, s29, v6
    v_lshl_add_u32 v23, v7, 5, v5
    v_xor_b32 v7, 1, v7
    v_lshl_add_u32 v24, v7, 5, v5
    v_lshlrev_b32 v25, 3, v1
    v_lshlrev_b32 v26, 4, v1
    s_lshl_b32 s29, s5, 11
    s_lshl_b32 s30, s2, 9
    s_add_u32 s30, s30, 65536
    s_cmp_eq_u32 s4, 0
    s_cselect_b32 s21, s29, s30
    s_add_u32 s21, s21, 17039360
    v_add_u32 v14, s11, v14
    v_add_u32 v15, s11, v15
    v_add_u32 v16, s11, v16
    v_add_u32 v17, s11, v17
    s_add_u32 m0, s13, 24576
    s_lshl1_add_u32 s15, s1, s9
    buffer_load_dwordx4 v8, s[56:59], s15 offen offset:0 lds
    buffer_load_dwordx4 v9, s[56:59], s15 offen offset:1024 lds
    buffer_load_dwordx4 v10, s[56:59], s15 offen offset:2048 lds
    buffer_load_dwordx4 v11, s[56:59], s15 offen offset:3072 lds
    s_add_u32 m0, s12, 40960
    s_mul_i32 s15, s1, 2688
    s_add_u32 s15, s15, s10
    buffer_load_dwordx4 v12, s[60:63], s15 offen offset:0 lds
    buffer_load_dwordx4 v13, s[60:63], s15 offen offset:1024 lds
    s_lshr_b32 s29, s2, 3
    s_min_u32 s29, s29, 27
    s_mul_i32 s30, s29, 37
    s_lshr_b32 s30, s30, 8
    s_mul_i32 s31, s30, 7
    s_sub_u32 s24, s29, s31
    s_and_b32 s29, s2, 7
    s_lshl_b32 s29, s29, 2
    s_add_u32 s23, s29, s30
    s_mul_i32 s25, s23, 294912
    s_lshl_b32 s29, s4, 10
    s_add_u32 s25, s25, s29
    s_add_u32 s25, s25, 6291456
    s_lshl_b32 s29, s24, 7
    s_mul_i32 s26, s4, 14336
    s_add_u32 s26, s26, s29
    s_mul_i32 s30, s8, 25088
    s_mul_i32 s31, s7, 14336
    s_add_u32 s27, s30, s31
    s_add_u32 s27, s27, s29
    s_lshr_b32 s28, s23, 1
    s_lshl_b32 s28, s28, 11
    s_add_u32 s28, s28, 17039360
    s_mul_i32 s29, s8, 147456
    v_add_u32 v32, s29, v26
    s_sub_u32 s29, 147456, s29
    v_add_u32 v33, s29, v26
    v_and_b32 v2, 31, v1
    v_lshrrev_b32 v3, 5, v1
    v_lshlrev_b32 v3, 2, v3
    v_sub_u32 v2, v2, v3
    v_mov_b32 v3, 0xf149f2ca
    v_cmp_le_i32 vcc, 0, v2
    v_cmp_le_i32 s[30:31], 1, v2
    s_nop 0
    v_cndmask_b32_e64 v224, v3, 0, vcc
    v_cndmask_b32 v240, 0, v3, vcc
    v_cndmask_b32_e64 v225, v3, 0, s[30:31]
    v_cndmask_b32_e64 v241, 0, v3, s[30:31]
    v_cmp_le_i32 vcc, 2, v2
    v_cmp_le_i32 s[30:31], 3, v2
    s_nop 0
    v_cndmask_b32_e64 v226, v3, 0, vcc
    v_cndmask_b32 v242, 0, v3, vcc
    v_cndmask_b32_e64 v227, v3, 0, s[30:31]
    v_cndmask_b32_e64 v243, 0, v3, s[30:31]
    s_add_u32 m0, s13, 49152
    s_lshl1_add_u32 s15, s3, s9
    buffer_load_dwordx4 v8, s[56:59], s15 offen offset:0 lds
    v_cmp_le_i32 vcc, 8, v2
    v_cmp_le_i32 s[30:31], 9, v2
    s_nop 0
    v_cndmask_b32_e64 v228, v3, 0, vcc
    v_cndmask_b32 v244, 0, v3, vcc
    v_cndmask_b32_e64 v229, v3, 0, s[30:31]
    v_cndmask_b32_e64 v245, 0, v3, s[30:31]
    v_cmp_le_i32 vcc, 10, v2
    v_cmp_le_i32 s[30:31], 11, v2
    s_nop 0
    v_cndmask_b32_e64 v230, v3, 0, vcc
    v_cndmask_b32 v246, 0, v3, vcc
    v_cndmask_b32_e64 v231, v3, 0, s[30:31]
    v_cndmask_b32_e64 v247, 0, v3, s[30:31]
    v_cmp_le_i32 vcc, 16, v2
    v_cmp_le_i32 s[30:31], 17, v2
    s_nop 0
    v_cndmask_b32_e64 v232, v3, 0, vcc
    v_cndmask_b32 v248, 0, v3, vcc
    v_cndmask_b32_e64 v233, v3, 0, s[30:31]
    v_cndmask_b32_e64 v249, 0, v3, s[30:31]
    v_cmp_le_i32 vcc, 18, v2
    v_cmp_le_i32 s[30:31], 19, v2
    s_nop 0
    v_cndmask_b32_e64 v234, v3, 0, vcc
    v_cndmask_b32 v250, 0, v3, vcc
    v_cndmask_b32_e64 v235, v3, 0, s[30:31]
    v_cndmask_b32_e64 v251, 0, v3, s[30:31]
    v_cmp_le_i32 vcc, 24, v2
    v_cmp_le_i32 s[30:31], 25, v2
    s_nop 0
    v_cndmask_b32_e64 v236, v3, 0, vcc
    v_cndmask_b32 v252, 0, v3, vcc
    v_cndmask_b32_e64 v237, v3, 0, s[30:31]
    v_cndmask_b32_e64 v253, 0, v3, s[30:31]
    v_cmp_le_i32 vcc, 26, v2
    v_cmp_le_i32 s[30:31], 27, v2
    s_nop 0
    v_cndmask_b32_e64 v238, v3, 0, vcc
    v_cndmask_b32 v254, 0, v3, vcc
    v_cndmask_b32_e64 v239, v3, 0, s[30:31]
    v_cndmask_b32_e64 v255, 0, v3, s[30:31]
    s_lshl_b32 s29, s5, 2
    s_lshl_b32 s30, s7, 1
    s_add_u32 s29, s29, s30
    s_mul_i32 s17, s29, 57344
    s_lshl_b32 s30, s6, 12
    s_add_u32 s17, s17, s30
    s_lshl_b32 s30, s8, 11
    s_add_u32 s17, s17, s30
    s_add_u32 s18, s17, 57344
    s_mul_i32 s19, s29, 147456
    s_lshl_b32 s31, s6, 13
    s_add_u32 s19, s19, s31
    buffer_load_dwordx4 v9, s[56:59], s15 offen offset:1024 lds
    s_add_u32 s19, s19, s30
    s_add_u32 s19, s19, 6291456
    s_add_u32 s20, s19, 147456
    s_cmp_lt_u32 s6, 7
    s_cselect_b32 s16, 0x3e8b97f6, 1.0
    s_and_b32 s29, s23, 3
    s_mul_i32 s30, s29, 7
    s_lshr_b32 s30, s30, 1
    s_lshl1_add_u32 s30, s24, s30
    s_lshl1_add_u32 s29, s29, s24
    v_add_u32 v2, s30, v1
    v_mul_u32_u24 v3, 4682, v2
    v_lshrrev_b32 v3, 16, v3
    v_mul_u32_u24 v3, 14, v3
    v_sub_u32 v2, v2, v3
    v_lshlrev_b32 v2, 1, v2
    v_cmp_lt_u32 vcc, 13, v1
    v_add_u32 v3, s29, v1
    v_add_u32 v3, 4, v3
    v_addc_co_u32 v2, vcc, 0, v2, vcc
    v_and_b32 v3, 7, v3
    v_cmp_lt_u32 vcc, 27, v1
    v_mul_u32_u24 v6, 57344, v2
    v_add_u32 v6, s26, v6
    v_mul_u32_u24 v7, 50176, v3
    v_add_u32 v7, s27, v7
    v_cndmask_b32 v4, v6, v7, vcc
    v_add_u32 v3, 28, v3
    v_cndmask_b32 v2, v2, v3, vcc
    v_lshlrev_b32 v2, 12, v2
    v_add_u32 v5, s25, v2
    v_readlane_b32 s36, v4, 0
    v_readlane_b32 s38, v5, 0
    s_cmp_ge_u32 s2, 224
    s_cselect_b32 s39, 0x40000000, 0
    v_add_u32 v28, s39, v28
    v_add_u32 v29, s39, v29
    v_add_u32 v32, s39, v32
    v_add_u32 v33, s39, v33
    buffer_load_dwordx4 v10, s[56:59], s15 offen offset:2048 lds
    buffer_load_dwordx4 v11, s[56:59], s15 offen offset:3072 lds
    s_add_u32 m0, s12, 65536
    s_mul_i32 s15, s3, 2688
    s_add_u32 s15, s15, s10
    buffer_load_dwordx4 v12, s[60:63], s15 offen offset:0 lds
    buffer_load_dwordx4 v13, s[60:63], s15 offen offset:1024 lds
    s_add_u32 m0, s13, 73728
    s_lshl1_add_u32 s15, s96, s9
    buffer_load_dwordx4 v8, s[56:59], s15 offen offset:0 lds
    s_waitcnt vmcnt(13)
    s_barrier
    ds_read_b64_tr_b16 v[40:41], v22 offset:16384
    ds_read_b128 a[0:3], v18 offset:0
    ds_read_b64_tr_b16 v[42:43], v22 offset:16896
    ds_read_b128 a[112:115], v18 offset:4096
    ds_read_b64_tr_b16 v[44:45], v22 offset:18432
    ds_read_b128 a[4:7], v19 offset:0
    ds_read_b64_tr_b16 v[46:47], v22 offset:18944
    ds_read_b128 a[116:119], v19 offset:4096
    ds_read_b64_tr_b16 v[48:49], v22 offset:20480
    ds_read_b128 a[8:11], v20 offset:0
    ds_read_b64_tr_b16 v[50:51], v22 offset:20992
    ds_read_b128 a[120:123], v20 offset:4096
    s_waitcnt lgkmcnt(8)
    v_mfma_f32_32x32x16_bf16 v[128:143], v[40:43], a[0:3], 0
    ds_read_b64_tr_b16 v[52:53], v22 offset:22528
    ds_read_b128 a[12:15], v21 offset:0
    v_mfma_f32_32x32x16_bf16 v[144:159], v[40:43], a[112:115], 0
    ds_read_b64_tr_b16 v[54:55], v22 offset:23040
    ds_read_b128 a[124:127], v21 offset:4096
    buffer_load_dwordx4 v9, s[56:59], s15 offen offset:1024 lds
    s_waitcnt lgkmcnt(8)
    v_mfma_f32_32x32x16_bf16 v[128:143], v[44:47], a[4:7], v[128:143]
    buffer_load_dwordx4 v10, s[56:59], s15 offen offset:2048 lds
    buffer_load_dwordx4 v11, s[56:59], s15 offen offset:3072 lds
    s_add_u32 m0, s12, 90112
    s_mul_i32 s15, s96, 2688
    s_add_u32 s15, s15, s10
    buffer_load_dwordx4 v12, s[60:63], s15 offen offset:0 lds
    buffer_load_dwordx4 v13, s[60:63], s15 offen offset:1024 lds
    s_add_u32 m0, s13, 98304
    s_lshl1_add_u32 s15, s97, s9
    buffer_load_dwordx4 v8, s[56:59], s15 offen offset:0 lds
    s_waitcnt vmcnt(13)
    s_barrier
    ds_read_b64_tr_b16 v[40:41], v22 offset:40960
    ds_read_b128 a[16:19], v18 offset:24576
    v_mfma_f32_32x32x16_bf16 v[144:159], v[44:47], a[116:119], v[144:159]
    ds_read_b64_tr_b16 v[42:43], v22 offset:41472
    ds_read_b128 a[128:131], v18 offset:28672
    s_waitcnt lgkmcnt(8)
    v_mfma_f32_32x32x16_bf16 v[128:143], v[48:51], a[8:11], v[128:143]
    ds_read_b64_tr_b16 v[44:45], v22 offset:43008
    ds_read_b128 a[20:23], v19 offset:24576
    buffer_load_dwordx4 v9, s[56:59], s15 offen offset:1024 lds
    v_mfma_f32_32x32x16_bf16 v[144:159], v[48:51], a[120:123], v[144:159]
    ds_read_b64_tr_b16 v[46:47], v22 offset:43520
    ds_read_b128 a[132:135], v19 offset:28672
    s_waitcnt lgkmcnt(8)
    v_mfma_f32_32x32x16_bf16 v[128:143], v[52:55], a[12:15], v[128:143]
    ds_read_b64_tr_b16 v[48:49], v22 offset:45056
    ds_read_b128 a[24:27], v20 offset:24576
    buffer_load_dwordx4 v10, s[56:59], s15 offen offset:2048 lds
    v_mfma_f32_32x32x16_bf16 v[144:159], v[52:55], a[124:127], v[144:159]
    ds_read_b64_tr_b16 v[50:51], v22 offset:45568
    ds_read_b128 a[136:139], v20 offset:28672
    s_waitcnt lgkmcnt(8)
    v_mfma_f32_32x32x16_bf16 v[128:143], v[40:43], a[16:19], v[128:143]
    ds_read_b64_tr_b16 v[52:53], v22 offset:47104
    ds_read_b128 a[28:31], v21 offset:24576
    buffer_load_dwordx4 v11, s[56:59], s15 offen offset:3072 lds
    v_mfma_f32_32x32x16_bf16 v[144:159], v[40:43], a[128:131], v[144:159]
    ds_read_b64_tr_b16 v[54:55], v22 offset:47616
    ds_read_b128 a[140:143], v21 offset:28672
    s_add_u32 m0, s12, 114688
    s_mul_i32 s15, s97, 2688
    s_add_u32 s15, s15, s10
    s_waitcnt lgkmcnt(8)
    v_mfma_f32_32x32x16_bf16 v[128:143], v[44:47], a[20:23], v[128:143]
    buffer_load_dwordx4 v12, s[60:63], s15 offen offset:0 lds
    buffer_load_dwordx4 v13, s[60:63], s15 offen offset:1024 lds
    s_add_u32 m0, s13, 122880
    s_lshl1_add_u32 s15, s40, s9
    buffer_load_dwordx4 v8, s[56:59], s15 offen offset:0 lds
    s_waitcnt vmcnt(13)
    s_barrier
    v_add_u32 v22, 0x10000, v22
    ds_read_b64_tr_b16 v[40:41], v22 offset:0
    ds_read_b128 a[32:35], v18 offset:49152
    v_mfma_f32_32x32x16_bf16 v[144:159], v[44:47], a[132:135], v[144:159]
    ds_read_b64_tr_b16 v[42:43], v22 offset:512
    ds_read_b128 a[144:147], v18 offset:53248
    s_waitcnt lgkmcnt(8)
    v_mfma_f32_32x32x16_bf16 v[128:143], v[48:51], a[24:27], v[128:143]
    ds_read_b64_tr_b16 v[44:45], v22 offset:2048
    ds_read_b128 a[36:39], v19 offset:49152
    buffer_load_dwordx4 v9, s[56:59], s15 offen offset:1024 lds
    v_mfma_f32_32x32x16_bf16 v[144:159], v[48:51], a[136:139], v[144:159]
    ds_read_b64_tr_b16 v[46:47], v22 offset:2560
    ds_read_b128 a[148:151], v19 offset:53248
    s_waitcnt lgkmcnt(8)
    v_mfma_f32_32x32x16_bf16 v[128:143], v[52:55], a[28:31], v[128:143]
    ds_read_b64_tr_b16 v[48:49], v22 offset:4096
    ds_read_b128 a[40:43], v20 offset:49152
    buffer_load_dwordx4 v10, s[56:59], s15 offen offset:2048 lds
    v_mfma_f32_32x32x16_bf16 v[144:159], v[52:55], a[140:143], v[144:159]
    ds_read_b64_tr_b16 v[50:51], v22 offset:4608
    ds_read_b128 a[152:155], v20 offset:53248
    s_waitcnt lgkmcnt(8)
    v_mfma_f32_32x32x16_bf16 v[128:143], v[40:43], a[32:35], v[128:143]
    ds_read_b64_tr_b16 v[52:53], v22 offset:6144
    ds_read_b128 a[44:47], v21 offset:49152
    buffer_load_dwordx4 v11, s[56:59], s15 offen offset:3072 lds
    v_mfma_f32_32x32x16_bf16 v[144:159], v[40:43], a[144:147], v[144:159]
    ds_read_b64_tr_b16 v[54:55], v22 offset:6656
    ds_read_b128 a[156:159], v21 offset:53248
    s_add_u32 m0, s12, 139264
    s_mul_i32 s15, s40, 2688
    s_add_u32 s15, s15, s10
    s_waitcnt lgkmcnt(8)
    v_mfma_f32_32x32x16_bf16 v[128:143], v[44:47], a[36:39], v[128:143]
    buffer_load_dwordx4 v12, s[60:63], s15 offen offset:0 lds
    buffer_load_dwordx4 v13, s[60:63], s15 offen offset:1024 lds
    s_add_u32 m0, s13, 147456
    s_lshl1_add_u32 s15, s41, s9
    buffer_load_dwordx4 v8, s[56:59], s15 offen offset:0 lds
    s_waitcnt vmcnt(13)
    s_barrier
    ds_read_b64_tr_b16 v[40:41], v22 offset:24576
    v_add_u32 v18, 0x10000, v18
    ds_read_b128 a[48:51], v18 offset:8192
    v_mfma_f32_32x32x16_bf16 v[144:159], v[44:47], a[148:151], v[144:159]
    ds_read_b64_tr_b16 v[42:43], v22 offset:25088
    ds_read_b128 a[160:163], v18 offset:12288
    s_waitcnt lgkmcnt(8)
    v_mfma_f32_32x32x16_bf16 v[128:143], v[48:51], a[40:43], v[128:143]
    ds_read_b64_tr_b16 v[44:45], v22 offset:26624
    v_add_u32 v19, 0x10000, v19
    ds_read_b128 a[52:55], v19 offset:8192
    buffer_load_dwordx4 v9, s[56:59], s15 offen offset:1024 lds
    v_mfma_f32_32x32x16_bf16 v[144:159], v[48:51], a[152:155], v[144:159]
    ds_read_b64_tr_b16 v[46:47], v22 offset:27136
    ds_read_b128 a[164:167], v19 offset:12288
    s_waitcnt lgkmcnt(8)
    v_mfma_f32_32x32x16_bf16 v[128:143], v[52:55], a[44:47], v[128:143]
    ds_read_b64_tr_b16 v[48:49], v22 offset:28672
    v_add_u32 v20, 0x10000, v20
    ds_read_b128 a[56:59], v20 offset:8192
    buffer_load_dwordx4 v10, s[56:59], s15 offen offset:2048 lds
    v_mfma_f32_32x32x16_bf16 v[144:159], v[52:55], a[156:159], v[144:159]
    ds_read_b64_tr_b16 v[50:51], v22 offset:29184
    ds_read_b128 a[168:171], v20 offset:12288
    s_waitcnt lgkmcnt(8)
    v_mfma_f32_32x32x16_bf16 v[128:143], v[40:43], a[48:51], v[128:143]
    ds_read_b64_tr_b16 v[52:53], v22 offset:30720
    v_add_u32 v21, 0x10000, v21
    ds_read_b128 a[60:63], v21 offset:8192
    buffer_load_dwordx4 v11, s[56:59], s15 offen offset:3072 lds
    v_mfma_f32_32x32x16_bf16 v[144:159], v[40:43], a[160:163], v[144:159]
    ds_read_b64_tr_b16 v[54:55], v22 offset:31232
    ds_read_b128 a[172:175], v21 offset:12288
    s_add_u32 m0, s12, 0
    s_mul_i32 s15, s41, 2688
    s_add_u32 s15, s15, s10
    s_waitcnt lgkmcnt(8)
    v_mfma_f32_32x32x16_bf16 v[128:143], v[44:47], a[52:55], v[128:143]
    buffer_load_dwordx4 v12, s[60:63], s15 offen offset:0 lds
    buffer_load_dwordx4 v13, s[60:63], s15 offen offset:1024 lds
    s_add_u32 m0, s12, 16384
    s_mul_i32 s0, s0, 3584
    s_mul_i32 s1, s1, 3584
    s_mul_i32 s3, s3, 3584
    s_mul_i32 s96, s96, 3584
    s_mul_i32 s97, s97, 3584
    s_mul_i32 s40, s40, 3584
    s_mul_i32 s41, s41, 3584
    s_waitcnt vmcnt(12)
    s_barrier
    ds_read_b64_tr_b16 v[40:41], v22 offset:49152
    ds_read_b128 a[64:67], v18 offset:32768
    buffer_load_dwordx4 v14, s[64:67], s0 offen offset:0 lds
    v_mfma_f32_32x32x16_bf16 v[144:159], v[44:47], a[164:167], v[144:159]
    ds_read_b64_tr_b16 v[42:43], v22 offset:49664
    ds_read_b128 a[176:179], v18 offset:36864
    s_waitcnt lgkmcnt(8)
    v_mfma_f32_32x32x16_bf16 v[128:143], v[48:51], a[56:59], v[128:143]
    ds_read_b64_tr_b16 v[44:45], v22 offset:51200
    ds_read_b128 a[68:71], v19 offset:32768
    buffer_load_dwordx4 v15, s[64:67], s0 offen offset:1024 lds
    v_mfma_f32_32x32x16_bf16 v[144:159], v[48:51], a[168:171], v[144:159]
    ds_read_b64_tr_b16 v[46:47], v22 offset:51712
    ds_read_b128 a[180:183], v19 offset:36864
    s_add_u32 m0, s12, 24576
    s_waitcnt lgkmcnt(8)
    v_mfma_f32_32x32x16_bf16 v[128:143], v[52:55], a[60:63], v[128:143]
    ds_read_b64_tr_b16 v[48:49], v22 offset:53248
    ds_read_b128 a[72:75], v20 offset:32768
    buffer_load_dwordx4 v16, s[68:71], s0 offen offset:0 lds
    v_mfma_f32_32x32x16_bf16 v[144:159], v[52:55], a[172:175], v[144:159]
    ds_read_b64_tr_b16 v[50:51], v22 offset:53760
    ds_read_b128 a[184:187], v20 offset:36864
    s_waitcnt lgkmcnt(8)
    v_mfma_f32_32x32x16_bf16 v[128:143], v[40:43], a[64:67], v[128:143]
    ds_read_b64_tr_b16 v[52:53], v22 offset:55296
    ds_read_b128 a[76:79], v21 offset:32768
    buffer_load_dwordx4 v17, s[68:71], s0 offen offset:1024 lds
    v_mfma_f32_32x32x16_bf16 v[144:159], v[40:43], a[176:179], v[144:159]
    ds_read_b64_tr_b16 v[54:55], v22 offset:55808
    ds_read_b128 a[188:191], v21 offset:36864
    s_add_u32 m0, s12, 32768
    s_waitcnt lgkmcnt(8)
    v_mfma_f32_32x32x16_bf16 v[128:143], v[44:47], a[68:71], v[128:143]
    buffer_load_dwordx4 v14, s[64:67], s1 offen offset:0 lds
    buffer_load_dwordx4 v15, s[64:67], s1 offen offset:1024 lds
    s_add_u32 m0, s12, 40960
    s_nop 0
    buffer_load_dwordx4 v16, s[68:71], s1 offen offset:0 lds
    s_waitcnt vmcnt(13)
    s_barrier
    v_add_u32 v22, 0x10000, v22
    ds_read_b64_tr_b16 v[40:41], v22 offset:8192
    ds_read_b128 a[80:83], v18 offset:57344
    v_mfma_f32_32x32x16_bf16 v[144:159], v[44:47], a[180:183], v[144:159]
    ds_read_b64_tr_b16 v[42:43], v22 offset:8704
    ds_read_b128 a[192:195], v18 offset:61440
    s_waitcnt lgkmcnt(8)
    v_mfma_f32_32x32x16_bf16 v[128:143], v[48:51], a[72:75], v[128:143]
    ds_read_b64_tr_b16 v[44:45], v22 offset:10240
    ds_read_b128 a[84:87], v19 offset:57344
    buffer_load_dwordx4 v17, s[68:71], s1 offen offset:1024 lds
    v_mfma_f32_32x32x16_bf16 v[144:159], v[48:51], a[184:187], v[144:159]
    ds_read_b64_tr_b16 v[46:47], v22 offset:10752
    ds_read_b128 a[196:199], v19 offset:61440
    s_add_u32 m0, s12, 49152
    s_waitcnt lgkmcnt(8)
    v_mfma_f32_32x32x16_bf16 v[128:143], v[52:55], a[76:79], v[128:143]
    ds_read_b64_tr_b16 v[48:49], v22 offset:12288
    ds_read_b128 a[88:91], v20 offset:57344
    buffer_load_dwordx4 v14, s[64:67], s3 offen offset:0 lds
    v_mfma_f32_32x32x16_bf16 v[144:159], v[52:55], a[188:191], v[144:159]
    ds_read_b64_tr_b16 v[50:51], v22 offset:12800
    ds_read_b128 a[200:203], v20 offset:61440
    s_waitcnt lgkmcnt(8)
    v_mfma_f32_32x32x16_bf16 v[128:143], v[40:43], a[80:83], v[128:143]
    ds_read_b64_tr_b16 v[52:53], v22 offset:14336
    ds_read_b128 a[92:95], v21 offset:57344
    buffer_load_dwordx4 v15, s[64:67], s3 offen offset:1024 lds
    v_mfma_f32_32x32x16_bf16 v[144:159], v[40:43], a[192:195], v[144:159]
    ds_read_b64_tr_b16 v[54:55], v22 offset:14848
    ds_read_b128 a[204:207], v21 offset:61440
    s_add_u32 m0, s12, 57344
    s_waitcnt lgkmcnt(8)
    v_mfma_f32_32x32x16_bf16 v[128:143], v[44:47], a[84:87], v[128:143]
    buffer_load_dwordx4 v16, s[68:71], s3 offen offset:0 lds
    buffer_load_dwordx4 v17, s[68:71], s3 offen offset:1024 lds
    s_add_u32 m0, s12, 65536
    s_nop 0
    buffer_load_dwordx4 v14, s[64:67], s96 offen offset:0 lds
    s_waitcnt vmcnt(13)
    s_barrier
    v_add_u32 v22, 0xfffe0000, v22
    ds_read_b64_tr_b16 v[40:41], v22 offset:0
    v_add_u32 v18, 0x10000, v18
    ds_read_b128 a[96:99], v18 offset:16384
    v_mfma_f32_32x32x16_bf16 v[144:159], v[44:47], a[196:199], v[144:159]
    ds_read_b64_tr_b16 v[42:43], v22 offset:512
    ds_read_b128 a[208:211], v18 offset:20480
    s_waitcnt lgkmcnt(8)
    v_mfma_f32_32x32x16_bf16 v[128:143], v[48:51], a[88:91], v[128:143]
    ds_read_b64_tr_b16 v[44:45], v22 offset:2048
    v_add_u32 v19, 0x10000, v19
    ds_read_b128 a[100:103], v19 offset:16384
    v_mfma_f32_32x32x16_bf16 v[144:159], v[48:51], a[200:203], v[144:159]
    ds_read_b64_tr_b16 v[46:47], v22 offset:2560
    ds_read_b128 a[212:215], v19 offset:20480
    s_waitcnt lgkmcnt(8)
    v_mfma_f32_32x32x16_bf16 v[128:143], v[52:55], a[92:95], v[128:143]
    ds_read_b64_tr_b16 v[48:49], v22 offset:4096
    v_add_u32 v20, 0x10000, v20
    ds_read_b128 a[104:107], v20 offset:16384
    v_mfma_f32_32x32x16_bf16 v[144:159], v[52:55], a[204:207], v[144:159]
    ds_read_b64_tr_b16 v[50:51], v22 offset:4608
    ds_read_b128 a[216:219], v20 offset:20480
    s_waitcnt lgkmcnt(8)
    v_mfma_f32_32x32x16_bf16 v[128:143], v[40:43], a[96:99], v[128:143]
    ds_read_b64_tr_b16 v[52:53], v22 offset:6144
    v_add_u32 v21, 0x10000, v21
    ds_read_b128 a[108:111], v21 offset:16384
    v_mfma_f32_32x32x16_bf16 v[144:159], v[40:43], a[208:211], v[144:159]
    ds_read_b64_tr_b16 v[54:55], v22 offset:6656
    ds_read_b128 a[220:223], v21 offset:20480
    s_waitcnt lgkmcnt(8)
    v_mfma_f32_32x32x16_bf16 v[128:143], v[44:47], a[100:103], v[128:143]
    buffer_load_dwordx4 v15, s[64:67], s96 offen offset:1024 lds
    s_add_u32 m0, s12, 73728
    s_nop 0
    buffer_load_dwordx4 v16, s[68:71], s96 offen offset:0 lds
    buffer_load_dwordx4 v17, s[68:71], s96 offen offset:1024 lds
    s_add_u32 m0, s12, 81920
    s_nop 0
    buffer_load_dwordx4 v14, s[64:67], s97 offen offset:0 lds
    s_waitcnt vmcnt(13)
    s_barrier
    ds_read_b64_tr_b16 v[40:41], v23 offset:16384
    v_mfma_f32_32x32x16_bf16 v[144:159], v[44:47], a[212:215], v[144:159]
    ds_read_b64_tr_b16 v[42:43], v23 offset:16896
    s_waitcnt lgkmcnt(6)
    v_mfma_f32_32x32x16_bf16 v[128:143], v[48:51], a[104:107], v[128:143]
    ds_read_b64_tr_b16 v[44:45], v24 offset:16384
    buffer_load_dwordx4 v15, s[64:67], s97 offen offset:1024 lds
    v_mfma_f32_32x32x16_bf16 v[144:159], v[48:51], a[216:219], v[144:159]
    ds_read_b64_tr_b16 v[46:47], v24 offset:16896
    s_add_u32 m0, s12, 90112
    s_waitcnt lgkmcnt(4)
    v_mfma_f32_32x32x16_bf16 v[128:143], v[52:55], a[108:111], v[128:143]
    ds_read_b64_tr_b16 v[48:49], v23 offset:18432
    buffer_load_dwordx4 v16, s[68:71], s97 offen offset:0 lds
    v_mfma_f32_32x32x16_bf16 v[144:159], v[52:55], a[220:223], v[144:159]
    ds_read_b64_tr_b16 v[50:51], v23 offset:18944
    s_waitcnt lgkmcnt(4)
    v_mfma_f32_32x32x16_bf16 v[64:79], v[40:43], a[0:3], 0
    ds_read_b64_tr_b16 v[52:53], v24 offset:18432
    v_mfma_f32_32x32x16_bf16 v[80:95], v[40:43], a[112:115], 0
    ds_read_b64_tr_b16 v[54:55], v24 offset:18944
    buffer_load_dwordx4 v17, s[68:71], s97 offen offset:1024 lds
    s_waitcnt lgkmcnt(4)
    v_mfma_f32_32x32x16_bf16 v[96:111], v[44:47], a[0:3], 0
    ds_read_b64_tr_b16 v[40:41], v23 offset:20480
    s_add_u32 m0, s12, 98304
    v_mfma_f32_32x32x16_bf16 v[112:127], v[44:47], a[112:115], 0
    ds_read_b64_tr_b16 v[42:43], v23 offset:20992
    s_waitcnt lgkmcnt(4)
    v_mfma_f32_32x32x16_bf16 v[64:79], v[48:51], a[4:7], v[64:79]
    ds_read_b64_tr_b16 v[44:45], v24 offset:20480
    v_mul_f32 v128, s16, v128
    v_mul_f32 v129, s16, v129
    v_mul_f32 v130, s16, v130
    v_mul_f32 v131, s16, v131
    v_mfma_f32_32x32x16_bf16 v[80:95], v[48:51], a[116:119], v[80:95]
    ds_read_b64_tr_b16 v[46:47], v24 offset:20992
    v_mul_f32 v132, s16, v132
    v_mul_f32 v133, s16, v133
    v_mul_f32 v134, s16, v134
    s_waitcnt lgkmcnt(4)
    v_mfma_f32_32x32x16_bf16 v[96:111], v[52:55], a[4:7], v[96:111]
    ds_read_b64_tr_b16 v[48:49], v23 offset:22528
    v_mul_f32 v135, s16, v135
    v_mul_f32 v136, s16, v136
    v_mul_f32 v137, s16, v137
    v_mul_f32 v138, s16, v138
    v_mfma_f32_32x32x16_bf16 v[112:127], v[52:55], a[116:119], v[112:127]
    ds_read_b64_tr_b16 v[50:51], v23 offset:23040
    buffer_load_dwordx4 v14, s[64:67], s40 offen offset:0 lds
    v_mul_f32 v139, s16, v139
    v_mul_f32 v140, s16, v140
    s_waitcnt lgkmcnt(4)
    v_mfma_f32_32x32x16_bf16 v[64:79], v[40:43], a[8:11], v[64:79]
    ds_read_b64_tr_b16 v[52:53], v24 offset:22528
    v_mul_f32 v141, s16, v141
    v_mul_f32 v142, s16, v142
    v_mul_f32 v143, s16, v143
    v_cvt_pk_bf16_f32 v128, v128, v129
    v_mfma_f32_32x32x16_bf16 v[80:95], v[40:43], a[120:123], v[80:95]
    ds_read_b64_tr_b16 v[54:55], v24 offset:23040
    v_cvt_pk_bf16_f32 v129, v130, v131
    v_cvt_pk_bf16_f32 v130, v132, v133
    v_cvt_pk_bf16_f32 v131, v134, v135
    s_waitcnt lgkmcnt(4)
    v_mfma_f32_32x32x16_bf16 v[96:111], v[44:47], a[8:11], v[96:111]
    s_waitcnt vmcnt(13)
    s_barrier
    ds_read_b64_tr_b16 v[40:41], v23 offset:32768
    buffer_load_dwordx4 v15, s[64:67], s40 offen offset:1024 lds
    v_mfma_f32_32x32x16_bf16 v[112:127], v[44:47], a[120:123], v[112:127]
    ds_read_b64_tr_b16 v[42:43], v23 offset:33280
    s_add_u32 m0, s12, 106496
    v_cvt_pk_bf16_f32 v132, v136, v137
    v_cvt_pk_bf16_f32 v133, v138, v139
    s_waitcnt lgkmcnt(4)
    v_mfma_f32_32x32x16_bf16 v[64:79], v[48:51], a[12:15], v[64:79]
    ds_read_b64_tr_b16 v[44:45], v24 offset:32768
    buffer_load_dwordx4 v16, s[68:71], s40 offen offset:0 lds
    v_cvt_pk_bf16_f32 v134, v140, v141
    v_cvt_pk_bf16_f32 v135, v142, v143
    v_mul_f32 v144, s16, v144
    v_mfma_f32_32x32x16_bf16 v[80:95], v[48:51], a[124:127], v[80:95]
    ds_read_b64_tr_b16 v[46:47], v24 offset:33280
    v_mul_f32 v145, s16, v145
    v_mul_f32 v146, s16, v146
    v_mul_f32 v147, s16, v147
    s_waitcnt lgkmcnt(4)
    v_mfma_f32_32x32x16_bf16 v[96:111], v[52:55], a[12:15], v[96:111]
    ds_read_b64_tr_b16 v[48:49], v23 offset:34816
    buffer_load_dwordx4 v17, s[68:71], s40 offen offset:1024 lds
    v_mul_f32 v148, s16, v148
    v_mul_f32 v149, s16, v149
    v_mul_f32 v150, s16, v150
    v_mfma_f32_32x32x16_bf16 v[112:127], v[52:55], a[124:127], v[112:127]
    ds_read_b64_tr_b16 v[50:51], v23 offset:35328
    s_add_u32 m0, s12, 114688
    v_mul_f32 v151, s16, v151
    v_mul_f32 v152, s16, v152
    s_waitcnt lgkmcnt(4)
    v_mfma_f32_32x32x16_bf16 v[64:79], v[40:43], a[16:19], v[64:79]
    ds_read_b64_tr_b16 v[52:53], v24 offset:34816
    s_load_dword s9, s[92:93], 0
    v_mul_f32 v153, s16, v153
    v_mul_f32 v154, s16, v154
    v_mul_f32 v155, s16, v155
    v_mfma_f32_32x32x16_bf16 v[80:95], v[40:43], a[128:131], v[80:95]
    ds_read_b64_tr_b16 v[54:55], v24 offset:35328
    buffer_load_dwordx4 v14, s[64:67], s41 offen offset:0 lds
    v_mul_f32 v156, s16, v156
    v_mul_f32 v157, s16, v157
    s_waitcnt lgkmcnt(4)
    v_mfma_f32_32x32x16_bf16 v[96:111], v[44:47], a[16:19], v[96:111]
    ds_read_b64_tr_b16 v[40:41], v23 offset:36864
    buffer_load_dwordx4 v15, s[64:67], s41 offen offset:1024 lds
    v_mul_f32 v158, s16, v158
    v_mul_f32 v159, s16, v159
    v_cvt_pk_bf16_f32 v144, v144, v145
    v_mfma_f32_32x32x16_bf16 v[112:127], v[44:47], a[128:131], v[112:127]
    ds_read_b64_tr_b16 v[42:43], v23 offset:37376
    s_add_u32 m0, s12, 122880
    v_cvt_pk_bf16_f32 v145, v146, v147
    v_cvt_pk_bf16_f32 v146, v148, v149
    s_waitcnt lgkmcnt(4)
    v_mfma_f32_32x32x16_bf16 v[64:79], v[48:51], a[20:23], v[64:79]
    ds_read_b64_tr_b16 v[44:45], v24 offset:36864
    v_cvt_pk_bf16_f32 v147, v150, v151
    v_cvt_pk_bf16_f32 v148, v152, v153
    v_cvt_pk_bf16_f32 v149, v154, v155
    v_cvt_pk_bf16_f32 v150, v156, v157
    v_mfma_f32_32x32x16_bf16 v[80:95], v[48:51], a[132:135], v[80:95]
    ds_read_b64_tr_b16 v[46:47], v24 offset:37376
    buffer_load_dwordx4 v16, s[68:71], s41 offen offset:0 lds
    v_cvt_pk_bf16_f32 v151, v158, v159
    s_waitcnt lgkmcnt(4)
    v_mfma_f32_32x32x16_bf16 v[96:111], v[52:55], a[20:23], v[96:111]
    ds_read_b64_tr_b16 v[48:49], v23 offset:38912
    v_mfma_f32_32x32x16_bf16 v[112:127], v[52:55], a[132:135], v[112:127]
    ds_read_b64_tr_b16 v[50:51], v23 offset:39424
    buffer_load_dwordx4 v17, s[68:71], s41 offen offset:1024 lds
    s_waitcnt lgkmcnt(4)
    v_mfma_f32_32x32x16_bf16 v[64:79], v[40:43], a[24:27], v[64:79]
    ds_read_b64_tr_b16 v[52:53], v24 offset:38912
    buffer_store_dwordx2 v[128:129], v25, s[72:75], s17 offen offset:0 sc1
    v_mfma_f32_32x32x16_bf16 v[80:95], v[40:43], a[136:139], v[80:95]
    ds_read_b64_tr_b16 v[54:55], v24 offset:39424
    buffer_store_dwordx2 v[130:131], v25, s[72:75], s17 offen offset:512 sc1
    s_waitcnt lgkmcnt(4)
    v_mfma_f32_32x32x16_bf16 v[96:111], v[44:47], a[24:27], v[96:111]
    s_waitcnt vmcnt(18)
    s_barrier
    ds_read_b64_tr_b16 v[40:41], v23 offset:49152
    buffer_store_dwordx2 v[132:133], v25, s[72:75], s17 offen offset:1024 sc1
    v_mfma_f32_32x32x16_bf16 v[112:127], v[44:47], a[136:139], v[112:127]
    ds_read_b64_tr_b16 v[42:43], v23 offset:49664
    buffer_store_dwordx2 v[134:135], v25, s[72:75], s17 offen offset:1536 sc1
    s_waitcnt lgkmcnt(4)
    v_mfma_f32_32x32x16_bf16 v[64:79], v[48:51], a[28:31], v[64:79]
    ds_read_b64_tr_b16 v[44:45], v24 offset:49152
    buffer_store_dwordx2 v[144:145], v25, s[72:75], s18 offen offset:0 sc1
    v_mfma_f32_32x32x16_bf16 v[80:95], v[48:51], a[140:143], v[80:95]
    ds_read_b64_tr_b16 v[46:47], v24 offset:49664
    buffer_store_dwordx2 v[146:147], v25, s[72:75], s18 offen offset:512 sc1
    s_waitcnt lgkmcnt(4)
    v_mfma_f32_32x32x16_bf16 v[96:111], v[52:55], a[28:31], v[96:111]
    ds_read_b64_tr_b16 v[48:49], v23 offset:51200
    buffer_store_dwordx2 v[148:149], v25, s[72:75], s18 offen offset:1024 sc1
    v_mfma_f32_32x32x16_bf16 v[112:127], v[52:55], a[140:143], v[112:127]
    ds_read_b64_tr_b16 v[50:51], v23 offset:51712
    buffer_store_dwordx2 v[150:151], v25, s[72:75], s18 offen offset:1536 sc1
    s_waitcnt lgkmcnt(4)
    v_mfma_f32_32x32x16_bf16 v[64:79], v[40:43], a[32:35], v[64:79]
    ds_read_b64_tr_b16 v[52:53], v24 offset:51200
    s_add_u32 m0, s12, 0
    v_add_u32 v14, 128, v14
    v_add_u32 v15, 128, v15
    v_add_u32 v16, 128, v16
    v_add_u32 v17, 128, v17
    v_mfma_f32_32x32x16_bf16 v[80:95], v[40:43], a[144:147], v[80:95]
    ds_read_b64_tr_b16 v[54:55], v24 offset:51712
    s_waitcnt lgkmcnt(4)
    v_mfma_f32_32x32x16_bf16 v[96:111], v[44:47], a[32:35], v[96:111]
    ds_read_b64_tr_b16 v[40:41], v23 offset:53248
    buffer_load_dwordx4 v14, s[64:67], s0 offen offset:0 lds
    v_mfma_f32_32x32x16_bf16 v[112:127], v[44:47], a[144:147], v[112:127]
    ds_read_b64_tr_b16 v[42:43], v23 offset:53760
    s_waitcnt lgkmcnt(4)
    v_mfma_f32_32x32x16_bf16 v[64:79], v[48:51], a[36:39], v[64:79]
    ds_read_b64_tr_b16 v[44:45], v24 offset:53248
    buffer_load_dwordx4 v15, s[64:67], s0 offen offset:1024 lds
    v_mfma_f32_32x32x16_bf16 v[80:95], v[48:51], a[148:151], v[80:95]
    ds_read_b64_tr_b16 v[46:47], v24 offset:53760
    s_add_u32 m0, s12, 8192
    s_waitcnt lgkmcnt(4)
    v_mfma_f32_32x32x16_bf16 v[96:111], v[52:55], a[36:39], v[96:111]
    ds_read_b64_tr_b16 v[48:49], v23 offset:55296
    buffer_load_dwordx4 v16, s[68:71], s0 offen offset:0 lds
    v_mfma_f32_32x32x16_bf16 v[112:127], v[52:55], a[148:151], v[112:127]
    ds_read_b64_tr_b16 v[50:51], v23 offset:55808
    s_waitcnt lgkmcnt(4)
    v_mfma_f32_32x32x16_bf16 v[64:79], v[40:43], a[40:43], v[64:79]
    ds_read_b64_tr_b16 v[52:53], v24 offset:55296
    buffer_load_dwordx4 v17, s[68:71], s0 offen offset:1024 lds
    v_mfma_f32_32x32x16_bf16 v[80:95], v[40:43], a[152:155], v[80:95]
    ds_read_b64_tr_b16 v[54:55], v24 offset:55808
    s_add_u32 m0, s12, 16384
    s_waitcnt lgkmcnt(4)
    v_mfma_f32_32x32x16_bf16 v[96:111], v[44:47], a[40:43], v[96:111]
    s_waitcnt vmcnt(24)
    s_barrier
    v_add_u32 v23, 0x10000, v23
    ds_read_b64_tr_b16 v[40:41], v23 offset:0
    s_waitcnt lgkmcnt(0)
    s_cmp_lt_u32 s9, 16
    s_cbranch_scc1 L_spin_1
L_back_2:
    v_mfma_f32_32x32x16_bf16 v[112:127], v[44:47], a[152:155], v[112:127]
    ds_read_b64_tr_b16 v[42:43], v23 offset:512
    buffer_load_dwordx4 v14, s[64:67], s1 offen offset:0 lds
    v_mfma_f32_32x32x16_bf16 v[64:79], v[48:51], a[44:47], v[64:79]
    v_add_u32 v24, 0x10000, v24
    ds_read_b64_tr_b16 v[44:45], v24 offset:0
    buffer_load_dwordx4 v15, s[64:67], s1 offen offset:1024 lds
    v_mfma_f32_32x32x16_bf16 v[80:95], v[48:51], a[156:159], v[80:95]
    ds_read_b64_tr_b16 v[46:47], v24 offset:512
    s_add_u32 m0, s12, 24576
    v_mfma_f32_32x32x16_bf16 v[96:111], v[52:55], a[44:47], v[96:111]
    ds_read_b64_tr_b16 v[48:49], v23 offset:2048
    buffer_load_dwordx4 v16, s[68:71], s1 offen offset:0 lds
    v_mfma_f32_32x32x16_bf16 v[112:127], v[52:55], a[156:159], v[112:127]
    ds_read_b64_tr_b16 v[50:51], v23 offset:2560
    s_waitcnt lgkmcnt(4)
    v_mfma_f32_32x32x16_bf16 v[64:79], v[40:43], a[48:51], v[64:79]
    ds_read_b64_tr_b16 v[52:53], v24 offset:2048
    v_mfma_f32_32x32x16_bf16 v[80:95], v[40:43], a[160:163], v[80:95]
    ds_read_b64_tr_b16 v[54:55], v24 offset:2560
    s_waitcnt lgkmcnt(4)
    v_mfma_f32_32x32x16_bf16 v[96:111], v[44:47], a[48:51], v[96:111]
    ds_read_b64_tr_b16 v[40:41], v23 offset:4096
    v_mfma_f32_32x32x16_bf16 v[112:127], v[44:47], a[160:163], v[112:127]
    ds_read_b64_tr_b16 v[42:43], v23 offset:4608
    s_waitcnt lgkmcnt(4)
    v_mfma_f32_32x32x16_bf16 v[64:79], v[48:51], a[52:55], v[64:79]
    ds_read_b64_tr_b16 v[44:45], v24 offset:4096
    v_mfma_f32_32x32x16_bf16 v[80:95], v[48:51], a[164:167], v[80:95]
    ds_read_b64_tr_b16 v[46:47], v24 offset:4608
    s_waitcnt lgkmcnt(4)
    v_mfma_f32_32x32x16_bf16 v[96:111], v[52:55], a[52:55], v[96:111]
    ds_read_b64_tr_b16 v[48:49], v23 offset:6144
    v_mfma_f32_32x32x16_bf16 v[112:127], v[52:55], a[164:167], v[112:127]
    ds_read_b64_tr_b16 v[50:51], v23 offset:6656
    s_waitcnt lgkmcnt(4)
    v_mfma_f32_32x32x16_bf16 v[64:79], v[40:43], a[56:59], v[64:79]
    ds_read_b64_tr_b16 v[52:53], v24 offset:6144
    v_mfma_f32_32x32x16_bf16 v[80:95], v[40:43], a[168:171], v[80:95]
    ds_read_b64_tr_b16 v[54:55], v24 offset:6656
    buffer_load_dwordx4 v17, s[68:71], s1 offen offset:1024 lds
    s_waitcnt lgkmcnt(4)
    v_mfma_f32_32x32x16_bf16 v[96:111], v[44:47], a[56:59], v[96:111]
    s_waitcnt vmcnt(24)
    s_barrier
    ds_read_b64_tr_b16 v[40:41], v23 offset:16384
    s_add_u32 m0, s12, 32768
    v_mfma_f32_32x32x16_bf16 v[112:127], v[44:47], a[168:171], v[112:127]
    ds_read_b64_tr_b16 v[42:43], v23 offset:16896
    s_waitcnt lgkmcnt(4)
    v_mfma_f32_32x32x16_bf16 v[64:79], v[48:51], a[60:63], v[64:79]
    ds_read_b64_tr_b16 v[44:45], v24 offset:16384
    v_mfma_f32_32x32x16_bf16 v[80:95], v[48:51], a[172:175], v[80:95]
    ds_read_b64_tr_b16 v[46:47], v24 offset:16896
    s_waitcnt lgkmcnt(4)
    v_mfma_f32_32x32x16_bf16 v[96:111], v[52:55], a[60:63], v[96:111]
    ds_read_b64_tr_b16 v[48:49], v23 offset:18432
    v_mfma_f32_32x32x16_bf16 v[112:127], v[52:55], a[172:175], v[112:127]
    ds_read_b64_tr_b16 v[50:51], v23 offset:18944
    s_waitcnt lgkmcnt(4)
    v_mfma_f32_32x32x16_bf16 v[64:79], v[40:43], a[64:67], v[64:79]
    ds_read_b64_tr_b16 v[52:53], v24 offset:18432
    v_mfma_f32_32x32x16_bf16 v[80:95], v[40:43], a[176:179], v[80:95]
    ds_read_b64_tr_b16 v[54:55], v24 offset:18944
    buffer_load_dwordx4 v14, s[64:67], s3 offen offset:0 lds
    s_waitcnt lgkmcnt(4)
    v_mfma_f32_32x32x16_bf16 v[96:111], v[44:47], a[64:67], v[96:111]
    ds_read_b64_tr_b16 v[40:41], v23 offset:20480
    v_mfma_f32_32x32x16_bf16 v[112:127], v[44:47], a[176:179], v[112:127]
    ds_read_b64_tr_b16 v[42:43], v23 offset:20992
    s_waitcnt lgkmcnt(4)
    v_mfma_f32_32x32x16_bf16 v[64:79], v[48:51], a[68:71], v[64:79]
    ds_read_b64_tr_b16 v[44:45], v24 offset:20480
    v_mfma_f32_32x32x16_bf16 v[80:95], v[48:51], a[180:183], v[80:95]
    ds_read_b64_tr_b16 v[46:47], v24 offset:20992
    s_waitcnt lgkmcnt(4)
    v_mfma_f32_32x32x16_bf16 v[96:111], v[52:55], a[68:71], v[96:111]
    ds_read_b64_tr_b16 v[48:49], v23 offset:22528
    v_mfma_f32_32x32x16_bf16 v[112:127], v[52:55], a[180:183], v[112:127]
    ds_read_b64_tr_b16 v[50:51], v23 offset:23040
    s_waitcnt lgkmcnt(4)
    v_mfma_f32_32x32x16_bf16 v[64:79], v[40:43], a[72:75], v[64:79]
    ds_read_b64_tr_b16 v[52:53], v24 offset:22528
    v_mfma_f32_32x32x16_bf16 v[80:95], v[40:43], a[184:187], v[80:95]
    ds_read_b64_tr_b16 v[54:55], v24 offset:23040
    buffer_load_dwordx4 v15, s[64:67], s3 offen offset:1024 lds
    s_waitcnt lgkmcnt(4)
    v_mfma_f32_32x32x16_bf16 v[96:111], v[44:47], a[72:75], v[96:111]
    s_waitcnt vmcnt(22)
    s_barrier
    ds_read_b64_tr_b16 v[40:41], v23 offset:32768
    s_add_u32 m0, s12, 40960
    v_mfma_f32_32x32x16_bf16 v[112:127], v[44:47], a[184:187], v[112:127]
    ds_read_b64_tr_b16 v[42:43], v23 offset:33280
    s_waitcnt lgkmcnt(4)
    v_mfma_f32_32x32x16_bf16 v[64:79], v[48:51], a[76:79], v[64:79]
    ds_read_b64_tr_b16 v[44:45], v24 offset:32768
    v_mfma_f32_32x32x16_bf16 v[80:95], v[48:51], a[188:191], v[80:95]
    ds_read_b64_tr_b16 v[46:47], v24 offset:33280
    s_waitcnt lgkmcnt(4)
    v_mfma_f32_32x32x16_bf16 v[96:111], v[52:55], a[76:79], v[96:111]
    ds_read_b64_tr_b16 v[48:49], v23 offset:34816
    v_mfma_f32_32x32x16_bf16 v[112:127], v[52:55], a[188:191], v[112:127]
    ds_read_b64_tr_b16 v[50:51], v23 offset:35328
    s_waitcnt lgkmcnt(4)
    v_mfma_f32_32x32x16_bf16 v[64:79], v[40:43], a[80:83], v[64:79]
    ds_read_b64_tr_b16 v[52:53], v24 offset:34816
    v_mfma_f32_32x32x16_bf16 v[80:95], v[40:43], a[192:195], v[80:95]
    ds_read_b64_tr_b16 v[54:55], v24 offset:35328
    buffer_load_dwordx4 v16, s[68:71], s3 offen offset:0 lds
    s_waitcnt lgkmcnt(4)
    v_mfma_f32_32x32x16_bf16 v[96:111], v[44:47], a[80:83], v[96:111]
    ds_read_b64_tr_b16 v[40:41], v23 offset:36864
    v_mfma_f32_32x32x16_bf16 v[112:127], v[44:47], a[192:195], v[112:127]
    ds_read_b64_tr_b16 v[42:43], v23 offset:37376
    buffer_load_dwordx4 v17, s[68:71], s3 offen offset:1024 lds
    s_waitcnt lgkmcnt(4)
    v_mfma_f32_32x32x16_bf16 v[64:79], v[48:51], a[84:87], v[64:79]
    ds_read_b64_tr_b16 v[44:45], v24 offset:36864
    s_waitcnt vmcnt(12)
    s_barrier
    s_mov_b32 s35, 1
    s_atomic_add s35, s[72:73], s21
    v_mfma_f32_32x32x16_bf16 v[80:95], v[48:51], a[196:199], v[80:95]
    ds_read_b64_tr_b16 v[46:47], v24 offset:37376
    s_add_u32 m0, s12, 131072
    s_waitcnt lgkmcnt(4)
    v_mfma_f32_32x32x16_bf16 v[96:111], v[52:55], a[84:87], v[96:111]
    ds_read_b64_tr_b16 v[48:49], v23 offset:38912
    buffer_load_dwordx4 v14, s[64:67], s96 offen offset:0 lds
    v_mfma_f32_32x32x16_bf16 v[112:127], v[52:55], a[196:199], v[112:127]
    ds_read_b64_tr_b16 v[50:51], v23 offset:39424
    buffer_load_dwordx4 v15, s[64:67], s96 offen offset:1024 lds
    s_waitcnt lgkmcnt(4)
    v_mfma_f32_32x32x16_bf16 v[64:79], v[40:43], a[88:91], v[64:79]
    ds_read_b64_tr_b16 v[52:53], v24 offset:38912
    s_add_u32 m0, s12, 139264
    v_mfma_f32_32x32x16_bf16 v[80:95], v[40:43], a[200:203], v[80:95]
    ds_read_b64_tr_b16 v[54:55], v24 offset:39424
    s_waitcnt lgkmcnt(4)
    v_mfma_f32_32x32x16_bf16 v[96:111], v[44:47], a[88:91], v[96:111]
    s_barrier
    ds_read_b64_tr_b16 v[40:41], v23 offset:49152
    buffer_load_dwordx4 v16, s[68:71], s96 offen offset:0 lds
    v_mfma_f32_32x32x16_bf16 v[112:127], v[44:47], a[200:203], v[112:127]
    ds_read_b64_tr_b16 v[42:43], v23 offset:49664
    s_waitcnt lgkmcnt(4)
    v_mfma_f32_32x32x16_bf16 v[64:79], v[48:51], a[92:95], v[64:79]
    ds_read_b64_tr_b16 v[44:45], v24 offset:49152
    buffer_load_dwordx4 v17, s[68:71], s96 offen offset:1024 lds
    v_mfma_f32_32x32x16_bf16 v[80:95], v[48:51], a[204:207], v[80:95]
    ds_read_b64_tr_b16 v[46:47], v24 offset:49664
    s_add_u32 m0, s12, 147456
    s_waitcnt lgkmcnt(4)
    v_mfma_f32_32x32x16_bf16 v[96:111], v[52:55], a[92:95], v[96:111]
    ds_read_b64_tr_b16 v[48:49], v23 offset:51200
    buffer_load_dwordx4 v14, s[64:67], s97 offen offset:0 lds
    v_mfma_f32_32x32x16_bf16 v[112:127], v[52:55], a[204:207], v[112:127]
    ds_read_b64_tr_b16 v[50:51], v23 offset:51712
    s_waitcnt lgkmcnt(4)
    v_mfma_f32_32x32x16_bf16 v[64:79], v[40:43], a[96:99], v[64:79]
    ds_read_b64_tr_b16 v[52:53], v24 offset:51200
    buffer_load_dwordx4 v15, s[64:67], s97 offen offset:1024 lds
    v_mfma_f32_32x32x16_bf16 v[80:95], v[40:43], a[208:211], v[80:95]
    ds_read_b64_tr_b16 v[54:55], v24 offset:51712
    s_add_u32 m0, s12, 155648
    s_waitcnt lgkmcnt(4)
    v_mfma_f32_32x32x16_bf16 v[96:111], v[44:47], a[96:99], v[96:111]
    ds_read_b64_tr_b16 v[40:41], v23 offset:53248
    buffer_load_dwordx4 v16, s[68:71], s97 offen offset:0 lds
    v_mfma_f32_32x32x16_bf16 v[112:127], v[44:47], a[208:211], v[112:127]
    ds_read_b64_tr_b16 v[42:43], v23 offset:53760
    s_waitcnt lgkmcnt(4)
    v_mfma_f32_32x32x16_bf16 v[64:79], v[48:51], a[100:103], v[64:79]
    ds_read_b64_tr_b16 v[44:45], v24 offset:53248
    v_mfma_f32_32x32x16_bf16 v[80:95], v[48:51], a[212:215], v[80:95]
    ds_read_b64_tr_b16 v[46:47], v24 offset:53760
    buffer_load_dwordx4 v17, s[68:71], s97 offen offset:1024 lds
    s_waitcnt lgkmcnt(4)
    v_mfma_f32_32x32x16_bf16 v[96:111], v[52:55], a[100:103], v[96:111]
    ds_read_b64_tr_b16 v[48:49], v23 offset:55296
    s_add_u32 m0, s12, 49152
    v_mfma_f32_32x32x16_bf16 v[112:127], v[52:55], a[212:215], v[112:127]
    ds_read_b64_tr_b16 v[50:51], v23 offset:55808
    buffer_load_dwordx4 v14, s[64:67], s40 offen offset:0 lds
    s_waitcnt lgkmcnt(4)
    v_mfma_f32_32x32x16_bf16 v[64:79], v[40:43], a[104:107], v[64:79]
    ds_read_b64_tr_b16 v[52:53], v24 offset:55296
    v_mfma_f32_32x32x16_bf16 v[80:95], v[40:43], a[216:219], v[80:95]
    ds_read_b64_tr_b16 v[54:55], v24 offset:55808
    buffer_load_dwordx4 v15, s[64:67], s40 offen offset:1024 lds
    s_waitcnt lgkmcnt(4)
    v_mfma_f32_32x32x16_bf16 v[96:111], v[44:47], a[104:107], v[96:111]
    s_waitcnt vmcnt(18)
    s_barrier
    v_add_u32 v23, 0xffff0000, v23
    ds_read_b64_tr_b16 v[40:41], v23 offset:0
    s_add_u32 m0, s12, 57344
    v_mfma_f32_32x32x16_bf16 v[112:127], v[44:47], a[216:219], v[112:127]
    ds_read_b64_tr_b16 v[42:43], v23 offset:512
    buffer_load_dwordx4 v16, s[68:71], s40 offen offset:0 lds
    s_waitcnt lgkmcnt(4)
    v_mfma_f32_32x32x16_bf16 v[64:79], v[48:51], a[108:111], v[64:79]
    v_add_u32 v24, 0xffff0000, v24
    ds_read_b64_tr_b16 v[44:45], v24 offset:0
    v_mfma_f32_32x32x16_bf16 v[80:95], v[48:51], a[220:223], v[80:95]
    ds_read_b64_tr_b16 v[46:47], v24 offset:512
    buffer_load_dwordx4 v17, s[68:71], s40 offen offset:1024 lds
    s_waitcnt lgkmcnt(4)
    v_mfma_f32_32x32x16_bf16 v[96:111], v[52:55], a[108:111], v[96:111]
    ds_read_b64_tr_b16 v[48:49], v23 offset:2048
    s_add_u32 m0, s12, 65536
    v_mfma_f32_32x32x16_bf16 v[112:127], v[52:55], a[220:223], v[112:127]
    ds_read_b64_tr_b16 v[50:51], v23 offset:2560
    buffer_load_dwordx4 v14, s[64:67], s41 offen offset:0 lds
    s_waitcnt lgkmcnt(4)
    v_mfma_f32_32x32x16_bf16 v[160:175], v[40:43], a[0:3], 0
    ds_read_b64_tr_b16 v[52:53], v24 offset:2048
    v_mfma_f32_32x32x16_bf16 v[176:191], v[40:43], a[112:115], 0
    ds_read_b64_tr_b16 v[54:55], v24 offset:2560
    s_waitcnt lgkmcnt(4)
    v_mfma_f32_32x32x16_bf16 v[192:207], v[44:47], a[0:3], 0
    ds_read_b64_tr_b16 v[40:41], v23 offset:4096
    s_mov_b32 s16, 0xbfb8aa3b
    s_mov_b32 s17, 0xbfb8aa3b
    buffer_load_dwordx4 v15, s[64:67], s41 offen offset:1024 lds
    v_mfma_f32_32x32x16_bf16 v[208:223], v[44:47], a[112:115], 0
    ds_read_b64_tr_b16 v[42:43], v23 offset:4608
    s_add_u32 m0, s12, 73728
    s_waitcnt lgkmcnt(4)
    v_mfma_f32_32x32x16_bf16 v[160:175], v[48:51], a[4:7], v[160:175]
    ds_read_b64_tr_b16 v[44:45], v24 offset:4096
    buffer_load_dwordx4 v16, s[68:71], s41 offen offset:0 lds
    v_mul_f32 v64, s16, v64
    v_mul_f32 v65, s16, v65
    v_mul_f32 v66, s16, v66
    v_mul_f32 v67, s16, v67
    v_mfma_f32_32x32x16_bf16 v[176:191], v[48:51], a[116:119], v[176:191]
    ds_read_b64_tr_b16 v[46:47], v24 offset:4608
    v_mul_f32 v68, s16, v68
    v_mul_f32 v69, s16, v69
    v_mul_f32 v70, s16, v70
    v_mul_f32 v71, s16, v71
    s_waitcnt lgkmcnt(4)
    v_mfma_f32_32x32x16_bf16 v[192:207], v[52:55], a[4:7], v[192:207]
    ds_read_b64_tr_b16 v[48:49], v23 offset:6144
    buffer_load_dwordx4 v17, s[68:71], s41 offen offset:1024 lds
    v_exp_f32 v64, v64
    v_exp_f32 v65, v65
    v_mfma_f32_32x32x16_bf16 v[208:223], v[52:55], a[116:119], v[208:223]
    ds_read_b64_tr_b16 v[50:51], v23 offset:6656
    s_add_u32 m0, s12, 81920
    v_exp_f32 v66, v66
    s_waitcnt lgkmcnt(4)
    v_mfma_f32_32x32x16_bf16 v[160:175], v[40:43], a[8:11], v[160:175]
    ds_read_b64_tr_b16 v[52:53], v24 offset:6144
    v_exp_f32 v67, v67
    v_exp_f32 v68, v68
    v_mfma_f32_32x32x16_bf16 v[176:191], v[40:43], a[120:123], v[176:191]
    ds_read_b64_tr_b16 v[54:55], v24 offset:6656
    v_exp_f32 v69, v69
    v_exp_f32 v70, v70
    s_waitcnt lgkmcnt(4)
    v_mfma_f32_32x32x16_bf16 v[192:207], v[44:47], a[8:11], v[192:207]
    s_waitcnt vmcnt(20)
    s_barrier
    ds_read_b64_tr_b16 v[40:41], v23 offset:16384
    v_mfma_f32_32x32x16_bf16 v[208:223], v[44:47], a[120:123], v[208:223]
    ds_read_b64_tr_b16 v[42:43], v23 offset:16896
    v_exp_f32 v71, v71
    v_add_f32 v64, 1.0, v64
    v_add_f32 v65, 1.0, v65
    s_waitcnt lgkmcnt(4)
    v_mfma_f32_32x32x16_bf16 v[160:175], v[48:51], a[12:15], v[160:175]
    ds_read_b64_tr_b16 v[44:45], v24 offset:16384
    v_add_f32 v66, 1.0, v66
    v_add_f32 v67, 1.0, v67
    v_add_f32 v68, 1.0, v68
    v_add_f32 v69, 1.0, v69
    v_add_f32 v70, 1.0, v70
    v_mfma_f32_32x32x16_bf16 v[176:191], v[48:51], a[124:127], v[176:191]
    ds_read_b64_tr_b16 v[46:47], v24 offset:16896
    v_add_f32 v71, 1.0, v71
    v_rcp_f32 v64, v64
    s_waitcnt lgkmcnt(4)
    v_mfma_f32_32x32x16_bf16 v[192:207], v[52:55], a[12:15], v[192:207]
    ds_read_b64_tr_b16 v[48:49], v23 offset:18432
    v_rcp_f32 v65, v65
    v_rcp_f32 v66, v66
    v_mfma_f32_32x32x16_bf16 v[208:223], v[52:55], a[124:127], v[208:223]
    ds_read_b64_tr_b16 v[50:51], v23 offset:18944
    v_rcp_f32 v67, v67
    v_rcp_f32 v68, v68
    s_waitcnt lgkmcnt(4)
    v_mfma_f32_32x32x16_bf16 v[160:175], v[40:43], a[16:19], v[160:175]
    ds_read_b64_tr_b16 v[52:53], v24 offset:18432
    buffer_load_dwordx4 v28, s[76:79], s36 offen offset:0 lds
    v_rcp_f32 v69, v69
    v_rcp_f32 v70, v70
    v_mfma_f32_32x32x16_bf16 v[176:191], v[40:43], a[128:131], v[176:191]
    ds_read_b64_tr_b16 v[54:55], v24 offset:18944
    v_rcp_f32 v71, v71
    v_mul_f32 v64, v64, v72
    v_mul_f32 v65, v65, v73
    s_waitcnt lgkmcnt(4)
    v_mfma_f32_32x32x16_bf16 v[192:207], v[44:47], a[16:19], v[192:207]
    ds_read_b64_tr_b16 v[40:41], v23 offset:20480
    buffer_load_dwordx4 v29, s[76:79], s36 offen offset:1024 lds
    v_readlane_b32 s36, v4, 1
    v_mul_f32 v66, v66, v74
    v_mul_f32 v67, v67, v75
    v_mul_f32 v68, v68, v76
    v_mfma_f32_32x32x16_bf16 v[208:223], v[44:47], a[128:131], v[208:223]
    ds_read_b64_tr_b16 v[42:43], v23 offset:20992
    s_add_u32 m0, s12, 90112
    v_mul_f32 v69, v69, v77
    v_mul_f32 v70, v70, v78
    v_mul_f32 v71, v71, v79
    s_waitcnt lgkmcnt(4)
    v_mfma_f32_32x32x16_bf16 v[160:175], v[48:51], a[20:23], v[160:175]
    ds_read_b64_tr_b16 v[44:45], v24 offset:20480
    buffer_load_dwordx4 v28, s[76:79], s36 offen offset:0 lds
    v_cvt_pk_bf16_f32 v72, v64, v65
    v_cvt_pk_bf16_f32 v73, v66, v67
    v_cvt_pk_bf16_f32 v74, v68, v69
    v_cvt_pk_bf16_f32 v75, v70, v71
    v_mfma_f32_32x32x16_bf16 v[176:191], v[48:51], a[132:135], v[176:191]
    ds_read_b64_tr_b16 v[46:47], v24 offset:20992
    buffer_store_dwordx4 v[72:75], v26, s[72:75], s19 offen offset:0 sc1
    v_mul_f32 v80, s16, v80
    v_mul_f32 v81, s16, v81
    v_mul_f32 v82, s16, v82
    s_waitcnt lgkmcnt(4)
    v_mfma_f32_32x32x16_bf16 v[192:207], v[52:55], a[20:23], v[192:207]
    ds_read_b64_tr_b16 v[48:49], v23 offset:22528
    v_mul_f32 v83, s16, v83
    v_mul_f32 v84, s16, v84
    v_mul_f32 v85, s16, v85
    v_mul_f32 v86, s16, v86
    v_mul_f32 v87, s16, v87
    v_mfma_f32_32x32x16_bf16 v[208:223], v[52:55], a[132:135], v[208:223]
    ds_read_b64_tr_b16 v[50:51], v23 offset:23040
    v_exp_f32 v80, v80
    v_exp_f32 v81, v81
    s_waitcnt lgkmcnt(4)
    v_mfma_f32_32x32x16_bf16 v[160:175], v[40:43], a[24:27], v[160:175]
    ds_read_b64_tr_b16 v[52:53], v24 offset:22528
    buffer_load_dwordx4 v29, s[76:79], s36 offen offset:1024 lds
    v_readlane_b32 s36, v4, 2
    v_exp_f32 v82, v82
    v_mfma_f32_32x32x16_bf16 v[176:191], v[40:43], a[136:139], v[176:191]
    ds_read_b64_tr_b16 v[54:55], v24 offset:23040
    s_add_u32 m0, s12, 98304
    v_exp_f32 v83, v83
    s_waitcnt lgkmcnt(4)
    v_mfma_f32_32x32x16_bf16 v[192:207], v[44:47], a[24:27], v[192:207]
    s_waitcnt vmcnt(21)
    s_barrier
    ds_read_b64_tr_b16 v[40:41], v23 offset:32768
    buffer_load_dwordx4 v28, s[76:79], s36 offen offset:0 lds
    v_mfma_f32_32x32x16_bf16 v[208:223], v[44:47], a[136:139], v[208:223]
    ds_read_b64_tr_b16 v[42:43], v23 offset:33280
    v_exp_f32 v84, v84
    v_exp_f32 v85, v85
    s_waitcnt lgkmcnt(4)
    v_mfma_f32_32x32x16_bf16 v[160:175], v[48:51], a[28:31], v[160:175]
    ds_read_b64_tr_b16 v[44:45], v24 offset:32768
    buffer_load_dwordx4 v29, s[76:79], s36 offen offset:1024 lds
    v_readlane_b32 s36, v4, 3
    v_exp_f32 v86, v86
    v_mfma_f32_32x32x16_bf16 v[176:191], v[48:51], a[140:143], v[176:191]
    ds_read_b64_tr_b16 v[46:47], v24 offset:33280
    s_add_u32 m0, s12, 106496
    v_exp_f32 v87, v87
    v_add_f32 v80, 1.0, v80
    s_waitcnt lgkmcnt(4)
    v_mfma_f32_32x32x16_bf16 v[192:207], v[52:55], a[28:31], v[192:207]
    ds_read_b64_tr_b16 v[48:49], v23 offset:34816
    v_add_f32 v81, 1.0, v81
    v_add_f32 v82, 1.0, v82
    v_add_f32 v83, 1.0, v83
    v_add_f32 v84, 1.0, v84
    v_add_f32 v85, 1.0, v85
    v_mfma_f32_32x32x16_bf16 v[208:223], v[52:55], a[140:143], v[208:223]
    ds_read_b64_tr_b16 v[50:51], v23 offset:35328
    v_add_f32 v86, 1.0, v86
    v_add_f32 v87, 1.0, v87
    v_rcp_f32 v80, v80
    s_waitcnt lgkmcnt(4)
    v_mfma_f32_32x32x16_bf16 v[160:175], v[40:43], a[32:35], v[160:175]
    ds_read_b64_tr_b16 v[52:53], v24 offset:34816
    v_rcp_f32 v81, v81
    v_rcp_f32 v82, v82
    v_mfma_f32_32x32x16_bf16 v[176:191], v[40:43], a[144:147], v[176:191]
    ds_read_b64_tr_b16 v[54:55], v24 offset:35328
    v_rcp_f32 v83, v83
    v_rcp_f32 v84, v84
    s_waitcnt lgkmcnt(4)
    v_mfma_f32_32x32x16_bf16 v[192:207], v[44:47], a[32:35], v[192:207]
    ds_read_b64_tr_b16 v[40:41], v23 offset:36864
    v_rcp_f32 v85, v85
    v_rcp_f32 v86, v86
    v_mfma_f32_32x32x16_bf16 v[208:223], v[44:47], a[144:147], v[208:223]
    ds_read_b64_tr_b16 v[42:43], v23 offset:37376
    v_rcp_f32 v87, v87
    v_mul_f32 v80, v80, v88
    v_mul_f32 v81, v81, v89
    s_waitcnt lgkmcnt(4)
    v_mfma_f32_32x32x16_bf16 v[160:175], v[48:51], a[36:39], v[160:175]
    ds_read_b64_tr_b16 v[44:45], v24 offset:36864
    v_mul_f32 v82, v82, v90
    v_mul_f32 v83, v83, v91
    v_mul_f32 v84, v84, v92
    v_mul_f32 v85, v85, v93
    v_mul_f32 v86, v86, v94
    v_mfma_f32_32x32x16_bf16 v[176:191], v[48:51], a[148:151], v[176:191]
    ds_read_b64_tr_b16 v[46:47], v24 offset:37376
    v_mul_f32 v87, v87, v95
    v_cvt_pk_bf16_f32 v88, v80, v81
    v_cvt_pk_bf16_f32 v89, v82, v83
    v_cvt_pk_bf16_f32 v90, v84, v85
    s_waitcnt lgkmcnt(4)
    v_mfma_f32_32x32x16_bf16 v[192:207], v[52:55], a[36:39], v[192:207]
    ds_read_b64_tr_b16 v[48:49], v23 offset:38912
    v_cvt_pk_bf16_f32 v91, v86, v87
    buffer_store_dwordx4 v[88:91], v26, s[72:75], s20 offen offset:0 sc1
    v_mul_f32 v96, s16, v96
    v_mul_f32 v97, s16, v97
    v_mul_f32 v98, s16, v98
    v_mfma_f32_32x32x16_bf16 v[208:223], v[52:55], a[148:151], v[208:223]
    ds_read_b64_tr_b16 v[50:51], v23 offset:39424
    v_mul_f32 v99, s16, v99
    v_mul_f32 v100, s16, v100
    v_mul_f32 v101, s16, v101
    v_mul_f32 v102, s16, v102
    s_waitcnt lgkmcnt(4)
    v_mfma_f32_32x32x16_bf16 v[160:175], v[40:43], a[40:43], v[160:175]
    ds_read_b64_tr_b16 v[52:53], v24 offset:38912
    v_mul_f32 v103, s16, v103
    v_exp_f32 v96, v96
    v_exp_f32 v97, v97
    v_mfma_f32_32x32x16_bf16 v[176:191], v[40:43], a[152:155], v[176:191]
    ds_read_b64_tr_b16 v[54:55], v24 offset:39424
    v_exp_f32 v98, v98
    v_exp_f32 v99, v99
    s_waitcnt lgkmcnt(4)
    v_mfma_f32_32x32x16_bf16 v[192:207], v[44:47], a[40:43], v[192:207]
    s_waitcnt vmcnt(20)
    s_barrier
    v_add_u32 v23, 0x20000, v23
    ds_read_b64_tr_b16 v[40:41], v23 offset:0
    buffer_load_dwordx4 v28, s[76:79], s36 offen offset:0 lds
    v_mfma_f32_32x32x16_bf16 v[208:223], v[44:47], a[152:155], v[208:223]
    ds_read_b64_tr_b16 v[42:43], v23 offset:512
    v_exp_f32 v100, v100
    v_exp_f32 v101, v101
    s_waitcnt lgkmcnt(4)
    v_mfma_f32_32x32x16_bf16 v[160:175], v[48:51], a[44:47], v[160:175]
    v_add_u32 v24, 0x20000, v24
    ds_read_b64_tr_b16 v[44:45], v24 offset:0
    buffer_load_dwordx4 v29, s[76:79], s36 offen offset:1024 lds
    v_readlane_b32 s36, v4, 4
    v_exp_f32 v102, v102
    v_mfma_f32_32x32x16_bf16 v[176:191], v[48:51], a[156:159], v[176:191]
    ds_read_b64_tr_b16 v[46:47], v24 offset:512
    s_add_u32 m0, s12, 114688
    v_exp_f32 v103, v103
    v_add_f32 v96, 1.0, v96
    s_waitcnt lgkmcnt(4)
    v_mfma_f32_32x32x16_bf16 v[192:207], v[52:55], a[44:47], v[192:207]
    ds_read_b64_tr_b16 v[48:49], v23 offset:2048
    v_add_f32 v97, 1.0, v97
    v_add_f32 v98, 1.0, v98
    v_add_f32 v99, 1.0, v99
    v_add_f32 v100, 1.0, v100
    v_add_f32 v101, 1.0, v101
    v_mfma_f32_32x32x16_bf16 v[208:223], v[52:55], a[156:159], v[208:223]
    ds_read_b64_tr_b16 v[50:51], v23 offset:2560
    buffer_load_dwordx4 v28, s[76:79], s36 offen offset:0 lds
    v_add_f32 v102, 1.0, v102
    v_add_f32 v103, 1.0, v103
    s_waitcnt lgkmcnt(4)
    v_mfma_f32_32x32x16_bf16 v[160:175], v[40:43], a[48:51], v[160:175]
    ds_read_b64_tr_b16 v[52:53], v24 offset:2048
    v_rcp_f32 v96, v96
    v_rcp_f32 v97, v97
    v_mfma_f32_32x32x16_bf16 v[176:191], v[40:43], a[160:163], v[176:191]
    ds_read_b64_tr_b16 v[54:55], v24 offset:2560
    buffer_load_dwordx4 v29, s[76:79], s36 offen offset:1024 lds
    v_readlane_b32 s36, v4, 5
    v_rcp_f32 v98, v98
    s_waitcnt lgkmcnt(4)
    v_mfma_f32_32x32x16_bf16 v[192:207], v[44:47], a[48:51], v[192:207]
    ds_read_b64_tr_b16 v[40:41], v23 offset:4096
    s_add_u32 m0, s12, 122880
    v_rcp_f32 v99, v99
    v_rcp_f32 v100, v100
    v_mfma_f32_32x32x16_bf16 v[208:223], v[44:47], a[160:163], v[208:223]
    ds_read_b64_tr_b16 v[42:43], v23 offset:4608
    buffer_load_dwordx4 v28, s[76:79], s36 offen offset:0 lds
    v_rcp_f32 v101, v101
    s_waitcnt lgkmcnt(4)
    v_mfma_f32_32x32x16_bf16 v[160:175], v[48:51], a[52:55], v[160:175]
    ds_read_b64_tr_b16 v[44:45], v24 offset:4096
    v_rcp_f32 v102, v102
    v_rcp_f32 v103, v103
    v_mul_f32 v96, v96, v104
    v_mfma_f32_32x32x16_bf16 v[176:191], v[48:51], a[164:167], v[176:191]
    ds_read_b64_tr_b16 v[46:47], v24 offset:4608
    v_mul_f32 v97, v97, v105
    v_mul_f32 v98, v98, v106
    v_mul_f32 v99, v99, v107
    v_mul_f32 v100, v100, v108
    s_waitcnt lgkmcnt(4)
    v_mfma_f32_32x32x16_bf16 v[192:207], v[52:55], a[52:55], v[192:207]
    ds_read_b64_tr_b16 v[48:49], v23 offset:6144
    buffer_load_dwordx4 v29, s[76:79], s36 offen offset:1024 lds
    v_readlane_b32 s36, v4, 6
    v_mul_f32 v101, v101, v109
    v_mul_f32 v102, v102, v110
    v_mul_f32 v103, v103, v111
    v_mfma_f32_32x32x16_bf16 v[208:223], v[52:55], a[164:167], v[208:223]
    ds_read_b64_tr_b16 v[50:51], v23 offset:6656
    v_cvt_pk_bf16_f32 v104, v96, v97
    v_cvt_pk_bf16_f32 v105, v98, v99
    v_cvt_pk_bf16_f32 v106, v100, v101
    v_cvt_pk_bf16_f32 v107, v102, v103
    s_waitcnt lgkmcnt(4)
    v_mfma_f32_32x32x16_bf16 v[160:175], v[40:43], a[56:59], v[160:175]
    ds_read_b64_tr_b16 v[52:53], v24 offset:6144
    buffer_store_dwordx4 v[104:107], v26, s[72:75], s19 offen offset:1024 sc1
    v_mul_f32 v112, s16, v112
    v_mul_f32 v113, s16, v113
    v_mul_f32 v114, s16, v114
    v_mul_f32 v115, s16, v115
    v_mfma_f32_32x32x16_bf16 v[176:191], v[40:43], a[168:171], v[176:191]
    ds_read_b64_tr_b16 v[54:55], v24 offset:6656
    s_sub_i32 s29, s5, 0
    s_max_i32 s29, s29, 0
    s_lshl_b32 s29, s29, 11
    s_add_u32 s29, s29, 17039360
    s_load_dword s9, s[72:73], s29
    s_sub_i32 s29, s5, 1
    s_max_i32 s29, s29, 0
    s_lshl_b32 s29, s29, 11
    s_add_u32 s29, s29, 17039360
    s_load_dword s10, s[72:73], s29
    s_sub_i32 s29, s5, 2
    s_max_i32 s29, s29, 0
    s_lshl_b32 s29, s29, 11
    s_add_u32 s29, s29, 17039360
    s_load_dword s11, s[72:73], s29
    s_waitcnt lgkmcnt(4)
    v_mfma_f32_32x32x16_bf16 v[192:207], v[44:47], a[56:59], v[192:207]
    s_waitcnt vmcnt(23)
    s_barrier
    ds_read_b64_tr_b16 v[40:41], v23 offset:16384
    v_mfma_f32_32x32x16_bf16 v[208:223], v[44:47], a[168:171], v[208:223]
    ds_read_b64_tr_b16 v[42:43], v23 offset:16896
    v_mul_f32 v116, s16, v116
    v_mul_f32 v117, s16, v117
    v_mul_f32 v118, s16, v118
    v_mul_f32 v119, s16, v119
    s_waitcnt lgkmcnt(4)
    v_mfma_f32_32x32x16_bf16 v[160:175], v[48:51], a[60:63], v[160:175]
    ds_read_b64_tr_b16 v[44:45], v24 offset:16384
    v_exp_f32 v112, v112
    v_exp_f32 v113, v113
    v_mfma_f32_32x32x16_bf16 v[176:191], v[48:51], a[172:175], v[176:191]
    ds_read_b64_tr_b16 v[46:47], v24 offset:16896
    v_exp_f32 v114, v114
    v_exp_f32 v115, v115
    s_waitcnt lgkmcnt(4)
    v_mfma_f32_32x32x16_bf16 v[192:207], v[52:55], a[60:63], v[192:207]
    ds_read_b64_tr_b16 v[48:49], v23 offset:18432
    v_exp_f32 v116, v116
    v_exp_f32 v117, v117
    v_mfma_f32_32x32x16_bf16 v[208:223], v[52:55], a[172:175], v[208:223]
    ds_read_b64_tr_b16 v[50:51], v23 offset:18944
    v_exp_f32 v118, v118
    v_exp_f32 v119, v119
    s_waitcnt lgkmcnt(4)
    v_mfma_f32_32x32x16_bf16 v[160:175], v[40:43], a[64:67], v[160:175]
    ds_read_b64_tr_b16 v[52:53], v24 offset:18432
    v_add_f32 v112, 1.0, v112
    v_add_f32 v113, 1.0, v113
    v_add_f32 v114, 1.0, v114
    v_add_f32 v115, 1.0, v115
    v_add_f32 v116, 1.0, v116
    v_mfma_f32_32x32x16_bf16 v[176:191], v[40:43], a[176:179], v[176:191]
    ds_read_b64_tr_b16 v[54:55], v24 offset:18944
    v_add_f32 v117, 1.0, v117
    v_add_f32 v118, 1.0, v118
    v_add_f32 v119, 1.0, v119
    s_waitcnt lgkmcnt(4)
    v_mfma_f32_32x32x16_bf16 v[192:207], v[44:47], a[64:67], v[192:207]
    ds_read_b64_tr_b16 v[40:41], v23 offset:20480
    v_rcp_f32 v112, v112
    v_rcp_f32 v113, v113
    v_mfma_f32_32x32x16_bf16 v[208:223], v[44:47], a[176:179], v[208:223]
    ds_read_b64_tr_b16 v[42:43], v23 offset:20992
    v_rcp_f32 v114, v114
    v_rcp_f32 v115, v115
    s_waitcnt lgkmcnt(4)
    v_mfma_f32_32x32x16_bf16 v[160:175], v[48:51], a[68:71], v[160:175]
    ds_read_b64_tr_b16 v[44:45], v24 offset:20480
    v_mov_b32 v8, 0x3f803f80
    v_mov_b32 v9, v8
    v_mov_b32 v10, v8
    v_mov_b32 v11, v8
    v_and_b32 v2, 3, v1
    v_bfe_u32 v3, v1, 2, 1
    v_lshlrev_b32 v3, 9, v3
    v_lshl_add_u32 v2, v2, 4, v3
    v_lshrrev_b32 v3, 3, v1
    v_lshl_add_u32 v2, v3, 10, v2
    s_min_u32 s29, s4, 2
    s_lshl_b32 s29, s29, 13
    v_add_u32 v2, s29, v2
    ds_write_b128 v2, v[8:11] offset:25024
    v_lshrrev_b32 v3, 4, v1
    v_min_u32 v3, 2, v3
    v_lshl_add_u32 v7, v3, 2, s22
    v_cmp_gt_u32 vcc, 8, v7
    v_and_b32 v2, 15, v1
    v_lshlrev_b32 v2, 4, v2
    v_lshl_add_u32 v2, v3, 13, v2
    v_mov_b32 v3, 0x3f80
    v_cndmask_b32 v18, 0, v3, vcc
    v_mov_b32 v19, 0
    v_mov_b32 v20, v18
    v_mov_b32 v21, 0
    v_add_u32 v2, s12, v2
    ds_write_b128 v2, v[18:21] offset:1792
    v_mfma_f32_32x32x16_bf16 v[176:191], v[48:51], a[180:183], v[176:191]
    ds_read_b64_tr_b16 v[46:47], v24 offset:20992
    v_rcp_f32 v116, v116
    v_rcp_f32 v117, v117
    s_waitcnt lgkmcnt(6)
    v_mfma_f32_32x32x16_bf16 v[192:207], v[52:55], a[68:71], v[192:207]
    ds_read_b64_tr_b16 v[48:49], v23 offset:22528
    v_rcp_f32 v118, v118
    v_rcp_f32 v119, v119
    v_mul_f32 v112, v112, v120
    v_mfma_f32_32x32x16_bf16 v[208:223], v[52:55], a[180:183], v[208:223]
    ds_read_b64_tr_b16 v[50:51], v23 offset:23040
    v_mul_f32 v113, v113, v121
    v_mul_f32 v114, v114, v122
    v_mul_f32 v115, v115, v123
    v_mul_f32 v116, v116, v124
    s_waitcnt lgkmcnt(6)
    v_mfma_f32_32x32x16_bf16 v[160:175], v[40:43], a[72:75], v[160:175]
    ds_read_b64_tr_b16 v[52:53], v24 offset:22528
    v_mul_f32 v117, v117, v125
    v_mul_f32 v118, v118, v126
    v_mul_f32 v119, v119, v127
    v_cvt_pk_bf16_f32 v120, v112, v113
    v_cvt_pk_bf16_f32 v121, v114, v115
    v_mfma_f32_32x32x16_bf16 v[176:191], v[40:43], a[184:187], v[176:191]
    ds_read_b64_tr_b16 v[54:55], v24 offset:23040
    v_cvt_pk_bf16_f32 v122, v116, v117
    v_cvt_pk_bf16_f32 v123, v118, v119
    buffer_store_dwordx4 v[120:123], v26, s[72:75], s20 offen offset:1024 sc1
    s_waitcnt lgkmcnt(4)
    v_mfma_f32_32x32x16_bf16 v[192:207], v[44:47], a[72:75], v[192:207]
    s_waitcnt vmcnt(20)
    s_barrier
    v_add_u32 v23, 0xfffe8000, v23
    ds_read_b64_tr_b16 v[40:41], v23 offset:16384
    s_add_u32 m0, s12, 131072
    v_mfma_f32_32x32x16_bf16 v[208:223], v[44:47], a[184:187], v[208:223]
    ds_read_b64_tr_b16 v[42:43], v23 offset:16896
    buffer_load_dwordx4 v28, s[76:79], s36 offen offset:0 lds
    s_waitcnt lgkmcnt(4)
    v_mfma_f32_32x32x16_bf16 v[160:175], v[48:51], a[76:79], v[160:175]
    v_add_u32 v24, 0xfffe8000, v24
    ds_read_b64_tr_b16 v[44:45], v24 offset:16384
    v_add_u32 v13, 13312, v27
    v_and_b32 v18, 31, v1
    v_lshlrev_b32 v18, 2, v18
    v_add_u32 v19, s39, v18
    s_and_b32 s29, s6, 1
    s_lshl1_add_u32 s29, s8, s29
    s_lshr_b32 s30, s6, 3
    s_lshl1_add_u32 s29, s29, s30
    s_lshl_b32 s29, s29, 7
    s_lshl_b32 s3, s5, 11
    s_add_u32 s3, s3, s29
    s_add_u32 s3, s3, 17039872
    buffer_load_dwordx4 v29, s[76:79], s36 offen offset:1024 lds
    v_readlane_b32 s36, v4, 7
    v_mfma_f32_32x32x16_bf16 v[176:191], v[48:51], a[188:191], v[176:191]
    ds_read_b64_tr_b16 v[46:47], v24 offset:16896
    s_add_u32 m0, s12, 139264
    s_waitcnt lgkmcnt(4)
    v_mfma_f32_32x32x16_bf16 v[192:207], v[52:55], a[76:79], v[192:207]
    ds_read_b64_tr_b16 v[48:49], v23 offset:18432
    s_waitcnt lgkmcnt(0)
    s_min_u32 s9, s9, s10
    s_min_u32 s9, s9, s11
    s_cmp_lt_u32 s9, 14
    s_cbranch_scc1 L_spin_3
L_back_4:
    v_mfma_f32_32x32x16_bf16 v[208:223], v[52:55], a[188:191], v[208:223]
    ds_read_b64_tr_b16 v[50:51], v23 offset:18944
    buffer_load_dwordx4 v28, s[76:79], s36 offen offset:0 lds
    v_mfma_f32_32x32x16_bf16 v[160:175], v[40:43], a[80:83], v[160:175]
    ds_read_b64_tr_b16 v[52:53], v24 offset:18432
    buffer_load_dwordx4 v29, s[76:79], s36 offen offset:1024 lds
    v_readlane_b32 s36, v4, 8
    v_mfma_f32_32x32x16_bf16 v[176:191], v[40:43], a[192:195], v[176:191]
    ds_read_b64_tr_b16 v[54:55], v24 offset:18944
    s_mul_i32 s33, s6, 1792
    s_add_u32 s33, s33, 0
    s_mul_i32 s14, s22, 57344
    s_add_u32 s14, s14, s33
    buffer_load_dwordx2 v[56:57], v25, s[72:75], s14 offen offset:0 sc1
    buffer_load_dwordx2 v[58:59], v25, s[72:75], s14 offen offset:512 sc1
    buffer_load_dwordx2 v[60:61], v25, s[72:75], s14 offen offset:1024 sc1
    buffer_load_dwordx2 v[62:63], v25, s[72:75], s14 offen offset:1536 sc1
    v_mfma_f32_32x32x16_bf16 v[192:207], v[44:47], a[80:83], v[192:207]
    ds_read_b64_tr_b16 v[40:41], v23 offset:20480
    v_mfma_f32_32x32x16_bf16 v[208:223], v[44:47], a[192:195], v[208:223]
    ds_read_b64_tr_b16 v[42:43], v23 offset:20992
    s_waitcnt lgkmcnt(4)
    v_mfma_f32_32x32x16_bf16 v[160:175], v[48:51], a[84:87], v[160:175]
    ds_read_b64_tr_b16 v[44:45], v24 offset:20480
    v_mfma_f32_32x32x16_bf16 v[176:191], v[48:51], a[196:199], v[176:191]
    ds_read_b64_tr_b16 v[46:47], v24 offset:20992
    s_waitcnt lgkmcnt(4)
    v_mfma_f32_32x32x16_bf16 v[192:207], v[52:55], a[84:87], v[192:207]
    ds_read_b64_tr_b16 v[48:49], v23 offset:22528
    v_mfma_f32_32x32x16_bf16 v[208:223], v[52:55], a[196:199], v[208:223]
    ds_read_b64_tr_b16 v[50:51], v23 offset:23040
    s_waitcnt lgkmcnt(4)
    v_mfma_f32_32x32x16_bf16 v[160:175], v[40:43], a[88:91], v[160:175]
    ds_read_b64_tr_b16 v[52:53], v24 offset:22528
    v_mfma_f32_32x32x16_bf16 v[176:191], v[40:43], a[200:203], v[176:191]
    ds_read_b64_tr_b16 v[54:55], v24 offset:23040
    s_waitcnt lgkmcnt(4)
    v_mfma_f32_32x32x16_bf16 v[192:207], v[44:47], a[88:91], v[192:207]
    s_waitcnt vmcnt(24)
    s_barrier
    ds_read_b64_tr_b16 v[40:41], v23 offset:32768
    v_mfma_f32_32x32x16_bf16 v[208:223], v[44:47], a[200:203], v[208:223]
    ds_read_b64_tr_b16 v[42:43], v23 offset:33280
    s_waitcnt lgkmcnt(4)
    v_mfma_f32_32x32x16_bf16 v[160:175], v[48:51], a[92:95], v[160:175]
    ds_read_b64_tr_b16 v[44:45], v24 offset:32768
    v_mfma_f32_32x32x16_bf16 v[176:191], v[48:51], a[204:207], v[176:191]
    ds_read_b64_tr_b16 v[46:47], v24 offset:33280
    s_add_i32 s29, s22, -8
    s_max_i32 s29, s29, 0
    s_mul_i32 s29, s29, 57344
    s_add_u32 s14, s29, s33
    s_add_u32 m0, s12, 0
    s_add_u32 s14, s14, 28672
    buffer_load_dwordx4 v26, s[72:75], s14 offen sc1 lds
    s_mov_b32 exec_hi, 0xffff
    buffer_load_dwordx4 v26, s[72:75], s14 offen offset:1024 sc1 lds
    s_mov_b32 exec_hi, -1
    s_waitcnt lgkmcnt(4)
    v_mfma_f32_32x32x16_bf16 v[192:207], v[52:55], a[92:95], v[192:207]
    ds_read_b64_tr_b16 v[48:49], v23 offset:34816
    s_waitcnt vmcnt(10)
    s_barrier
    s_mov_b32 s35, 1
    s_add_u32 s29, s21, 256
    s_atomic_add s35, s[72:73], s29
    v_mfma_f32_32x32x16_bf16 v[208:223], v[52:55], a[204:207], v[208:223]
    ds_read_b64_tr_b16 v[50:51], v23 offset:35328
    s_waitcnt lgkmcnt(4)
    v_mfma_f32_32x32x16_bf16 v[160:175], v[40:43], a[96:99], v[160:175]
    ds_read_b64_tr_b16 v[52:53], v24 offset:34816
    s_add_i32 s29, s22, -4
    s_max_i32 s29, s29, 0
    s_mul_i32 s29, s29, 57344
    s_add_u32 s14, s29, s33
    s_add_u32 m0, s12, 8192
    s_add_u32 s14, s14, 28672
    buffer_load_dwordx4 v26, s[72:75], s14 offen sc1 lds
    s_mov_b32 exec_hi, 0xffff
    buffer_load_dwordx4 v26, s[72:75], s14 offen offset:1024 sc1 lds
    s_mov_b32 exec_hi, -1
    v_mfma_f32_32x32x16_bf16 v[176:191], v[40:43], a[208:211], v[176:191]
    ds_read_b64_tr_b16 v[54:55], v24 offset:35328
    s_waitcnt lgkmcnt(4)
    v_mfma_f32_32x32x16_bf16 v[192:207], v[44:47], a[96:99], v[192:207]
    ds_read_b64_tr_b16 v[40:41], v23 offset:36864
    s_add_i32 s29, s22, 0
    s_max_i32 s29, s29, 0
    s_mul_i32 s29, s29, 57344
    s_add_u32 s14, s29, s33
    s_add_u32 m0, s12, 16384
    s_add_u32 s14, s14, 28672
    buffer_load_dwordx4 v26, s[72:75], s14 offen sc1 lds
    s_mov_b32 exec_hi, 0xffff
    buffer_load_dwordx4 v26, s[72:75], s14 offen offset:1024 sc1 lds
    s_mov_b32 exec_hi, -1
    v_mfma_f32_32x32x16_bf16 v[208:223], v[44:47], a[208:211], v[208:223]
    ds_read_b64_tr_b16 v[42:43], v23 offset:37376
    s_add_u32 m0, s12, 147456
    s_waitcnt lgkmcnt(4)
    v_mfma_f32_32x32x16_bf16 v[160:175], v[48:51], a[100:103], v[160:175]
    ds_read_b64_tr_b16 v[44:45], v24 offset:36864
    v_mfma_f32_32x32x16_bf16 v[176:191], v[48:51], a[212:215], v[176:191]
    ds_read_b64_tr_b16 v[46:47], v24 offset:37376
    s_waitcnt lgkmcnt(4)
    v_mfma_f32_32x32x16_bf16 v[192:207], v[52:55], a[100:103], v[192:207]
    ds_read_b64_tr_b16 v[48:49], v23 offset:38912
    v_mfma_f32_32x32x16_bf16 v[208:223], v[52:55], a[212:215], v[208:223]
    ds_read_b64_tr_b16 v[50:51], v23 offset:39424
    s_waitcnt lgkmcnt(4)
    v_mfma_f32_32x32x16_bf16 v[160:175], v[40:43], a[104:107], v[160:175]
    ds_read_b64_tr_b16 v[52:53], v24 offset:38912
    v_mfma_f32_32x32x16_bf16 v[176:191], v[40:43], a[216:219], v[176:191]
    ds_read_b64_tr_b16 v[54:55], v24 offset:39424
    s_waitcnt lgkmcnt(4)
    v_mfma_f32_32x32x16_bf16 v[192:207], v[44:47], a[104:107], v[192:207]
    v_mfma_f32_32x32x16_bf16 v[208:223], v[44:47], a[216:219], v[208:223]
    buffer_load_dwordx4 v28, s[76:79], s36 offen offset:0 lds
    s_waitcnt lgkmcnt(2)
    v_mfma_f32_32x32x16_bf16 v[160:175], v[48:51], a[108:111], v[160:175]
    v_mfma_f32_32x32x16_bf16 v[176:191], v[48:51], a[220:223], v[176:191]
    s_waitcnt lgkmcnt(0)
    v_mfma_f32_32x32x16_bf16 v[192:207], v[52:55], a[108:111], v[192:207]
    v_mfma_f32_32x32x16_bf16 v[208:223], v[52:55], a[220:223], v[208:223]
    s_add_u32 s19, s19, 4096
    s_add_u32 s20, s20, 4096
    s_barrier
    buffer_load_dwordx4 v29, s[76:79], s36 offen offset:1024 lds
    v_readlane_b32 s36, v4, 9
    s_nop 2
    v_pk_mul_f32 v[160:161], v[160:161], s[16:17]
    s_add_u32 m0, s12, 155648
    v_pk_mul_f32 v[162:163], v[162:163], s[16:17]
    buffer_load_dwordx4 v28, s[76:79], s36 offen offset:0 lds
    v_pk_mul_f32 v[164:165], v[164:165], s[16:17]
    v_pk_mul_f32 v[166:167], v[166:167], s[16:17]
    v_exp_f32 v160, v160
    v_exp_f32 v161, v161
    v_exp_f32 v162, v162
    v_exp_f32 v163, v163
    v_exp_f32 v164, v164
    v_exp_f32 v165, v165
    buffer_load_dwordx4 v29, s[76:79], s36 offen offset:1024 lds
    v_readlane_b32 s36, v4, 10
    v_exp_f32 v166, v166
    s_add_u32 m0, s12, 49152
    v_exp_f32 v167, v167
    s_nop 1
    buffer_load_dwordx4 v28, s[76:79], s36 offen offset:0 lds
    v_pk_add_f32 v[160:161], v[160:161], 1.0 op_sel_hi:[1,0]
    v_pk_add_f32 v[162:163], v[162:163], 1.0 op_sel_hi:[1,0]
    v_pk_add_f32 v[164:165], v[164:165], 1.0 op_sel_hi:[1,0]
    v_pk_add_f32 v[166:167], v[166:167], 1.0 op_sel_hi:[1,0]
    v_rcp_f32 v160, v160
    v_rcp_f32 v161, v161
    v_rcp_f32 v162, v162
    v_rcp_f32 v163, v163
    v_rcp_f32 v164, v164
    buffer_load_dwordx4 v29, s[76:79], s36 offen offset:1024 lds
    v_readlane_b32 s36, v4, 11
    v_rcp_f32 v165, v165
    s_add_u32 m0, s12, 57344
    v_rcp_f32 v166, v166
    s_nop 1
    buffer_load_dwordx4 v28, s[76:79], s36 offen offset:0 lds
    v_rcp_f32 v167, v167
    v_pk_mul_f32 v[160:161], v[160:161], v[168:169]
    v_pk_mul_f32 v[162:163], v[162:163], v[170:171]
    v_pk_mul_f32 v[164:165], v[164:165], v[172:173]
    v_pk_mul_f32 v[166:167], v[166:167], v[174:175]
    v_cvt_pk_bf16_f32 v168, v160, v161
    v_cvt_pk_bf16_f32 v169, v162, v163
    v_cvt_pk_bf16_f32 v170, v164, v165
    v_cvt_pk_bf16_f32 v171, v166, v167
    buffer_store_dwordx4 v[168:171], v26, s[72:75], s19 offen offset:0 sc1
    v_pk_mul_f32 v[176:177], v[176:177], s[16:17]
    v_pk_mul_f32 v[178:179], v[178:179], s[16:17]
    buffer_load_dwordx4 v29, s[76:79], s36 offen offset:1024 lds
    v_readlane_b32 s36, v4, 12
    v_pk_mul_f32 v[180:181], v[180:181], s[16:17]
    s_add_u32 m0, s12, 65536
    v_pk_mul_f32 v[182:183], v[182:183], s[16:17]
    s_nop 1
    buffer_load_dwordx4 v28, s[76:79], s36 offen offset:0 lds
    v_exp_f32 v176, v176
    v_exp_f32 v177, v177
    v_exp_f32 v178, v178
    v_exp_f32 v179, v179
    v_exp_f32 v180, v180
    v_exp_f32 v181, v181
    v_exp_f32 v182, v182
    buffer_load_dwordx4 v29, s[76:79], s36 offen offset:1024 lds
    v_readlane_b32 s36, v4, 13
    v_exp_f32 v183, v183
    s_add_u32 m0, s12, 73728
    v_pk_add_f32 v[176:177], v[176:177], 1.0 op_sel_hi:[1,0]
    s_nop 1
    buffer_load_dwordx4 v28, s[76:79], s36 offen offset:0 lds
    v_pk_add_f32 v[178:179], v[178:179], 1.0 op_sel_hi:[1,0]
    s_sub_i32 s29, s5, 0
    s_max_i32 s29, s29, 0
    s_lshl_b32 s29, s29, 11
    s_add_u32 s29, s29, 17039488
    s_load_dword s9, s[72:73], s29
    s_sub_i32 s29, s5, 1
    s_max_i32 s29, s29, 0
    s_lshl_b32 s29, s29, 11
    s_add_u32 s29, s29, 17039488
    s_load_dword s10, s[72:73], s29
    s_sub_i32 s29, s5, 2
    s_max_i32 s29, s29, 0
    s_lshl_b32 s29, s29, 11
    s_add_u32 s29, s29, 17039488
    s_load_dword s11, s[72:73], s29
    v_pk_add_f32 v[180:181], v[180:181], 1.0 op_sel_hi:[1,0]
    buffer_load_dwordx4 v29, s[76:79], s36 offen offset:1024 lds
    v_readlane_b32 s36, v4, 14
    v_pk_add_f32 v[182:183], v[182:183], 1.0 op_sel_hi:[1,0]
    v_rcp_f32 v176, v176
    v_rcp_f32 v177, v177
    v_rcp_f32 v178, v178
    v_rcp_f32 v179, v179
    v_rcp_f32 v180, v180
    v_rcp_f32 v181, v181
    v_rcp_f32 v182, v182
    v_rcp_f32 v183, v183
    v_pk_mul_f32 v[176:177], v[176:177], v[184:185]
    v_pk_mul_f32 v[178:179], v[178:179], v[186:187]
    v_pk_mul_f32 v[180:181], v[180:181], v[188:189]
    v_pk_mul_f32 v[182:183], v[182:183], v[190:191]
    v_cvt_pk_bf16_f32 v184, v176, v177
    v_cvt_pk_bf16_f32 v185, v178, v179
    v_cvt_pk_bf16_f32 v186, v180, v181
    v_cvt_pk_bf16_f32 v187, v182, v183
    buffer_store_dwordx4 v[184:187], v26, s[72:75], s20 offen offset:0 sc1
    v_pk_mul_f32 v[192:193], v[192:193], s[16:17]
    v_pk_mul_f32 v[194:195], v[194:195], s[16:17]
    v_pk_mul_f32 v[196:197], v[196:197], s[16:17]
    v_pk_mul_f32 v[198:199], v[198:199], s[16:17]
    v_exp_f32 v192, v192
    v_exp_f32 v193, v193
    v_exp_f32 v194, v194
    v_exp_f32 v195, v195
    v_exp_f32 v196, v196
    v_exp_f32 v197, v197
    v_exp_f32 v198, v198
    v_exp_f32 v199, v199
    v_pk_add_f32 v[192:193], v[192:193], 1.0 op_sel_hi:[1,0]
    v_pk_add_f32 v[194:195], v[194:195], 1.0 op_sel_hi:[1,0]
    v_pk_add_f32 v[196:197], v[196:197], 1.0 op_sel_hi:[1,0]
    v_pk_add_f32 v[198:199], v[198:199], 1.0 op_sel_hi:[1,0]
    v_rcp_f32 v192, v192
    v_rcp_f32 v193, v193
    v_rcp_f32 v194, v194
    v_rcp_f32 v195, v195
    v_rcp_f32 v196, v196
    v_rcp_f32 v197, v197
    v_rcp_f32 v198, v198
    v_rcp_f32 v199, v199
    v_pk_mul_f32 v[192:193], v[192:193], v[200:201]
    v_pk_mul_f32 v[194:195], v[194:195], v[202:203]
    v_pk_mul_f32 v[196:197], v[196:197], v[204:205]
    v_pk_mul_f32 v[198:199], v[198:199], v[206:207]
    v_cvt_pk_bf16_f32 v200, v192, v193
    v_cvt_pk_bf16_f32 v201, v194, v195
    v_cvt_pk_bf16_f32 v202, v196, v197
    v_cvt_pk_bf16_f32 v203, v198, v199
    buffer_store_dwordx4 v[200:203], v26, s[72:75], s19 offen offset:1024 sc1
    v_pk_mul_f32 v[208:209], v[208:209], s[16:17]
    v_pk_mul_f32 v[210:211], v[210:211], s[16:17]
    v_pk_mul_f32 v[212:213], v[212:213], s[16:17]
    v_pk_mul_f32 v[214:215], v[214:215], s[16:17]
    v_exp_f32 v208, v208
    v_exp_f32 v209, v209
    v_exp_f32 v210, v210
    v_exp_f32 v211, v211
    v_exp_f32 v212, v212
    v_exp_f32 v213, v213
    v_exp_f32 v214, v214
    v_exp_f32 v215, v215
    v_pk_add_f32 v[208:209], v[208:209], 1.0 op_sel_hi:[1,0]
    v_pk_add_f32 v[210:211], v[210:211], 1.0 op_sel_hi:[1,0]
    v_pk_add_f32 v[212:213], v[212:213], 1.0 op_sel_hi:[1,0]
    v_pk_add_f32 v[214:215], v[214:215], 1.0 op_sel_hi:[1,0]
    v_rcp_f32 v208, v208
    v_rcp_f32 v209, v209
    v_rcp_f32 v210, v210
    v_rcp_f32 v211, v211
    v_rcp_f32 v212, v212
    v_rcp_f32 v213, v213
    v_rcp_f32 v214, v214
    v_rcp_f32 v215, v215
    v_pk_mul_f32 v[208:209], v[208:209], v[216:217]
    v_pk_mul_f32 v[210:211], v[210:211], v[218:219]
    v_pk_mul_f32 v[212:213], v[212:213], v[220:221]
    v_pk_mul_f32 v[214:215], v[214:215], v[222:223]
    v_cvt_pk_bf16_f32 v216, v208, v209
    v_cvt_pk_bf16_f32 v217, v210, v211
    v_cvt_pk_bf16_f32 v218, v212, v213
    v_cvt_pk_bf16_f32 v219, v214, v215
    buffer_store_dwordx4 v[216:219], v26, s[72:75], s20 offen offset:1024 sc1
    s_waitcnt vmcnt(16)
    s_barrier
L_shared:
    v_add_u32 v12, s12, v25
    v_add_u32 v6, s12, v26
    ds_read2st64_b64 a[112:115], v12 offset0:0 offset1:1
    ds_read2st64_b64 a[116:119], v12 offset0:2 offset1:3
    ds_read2st64_b64 a[120:123], v12 offset0:4 offset1:5
    ds_read2st64_b64 a[124:127], v12 offset0:6 offset1:7
    ds_read2st64_b64 a[128:131], v12 offset0:8 offset1:9
    ds_read2st64_b64 a[132:135], v12 offset0:10 offset1:11
    v_cmp_gt_u32 vcc, 32, v1
    v_mov_b32 v3, 0xf149
    v_mov_b32 v14, 0xf149f2ca
    v_cndmask_b32 v62, v3, v62, vcc
    v_cndmask_b32 v63, 0, v63, vcc
    s_waitcnt lgkmcnt(4)
    v_mfma_f32_32x32x16_bf16 v[64:79], a[112:115], v[56:59], v[240:255]
    ds_read2st64_b64 a[136:139], v12 offset0:12 offset1:13
    s_add_u32 s29, s28, 256
    s_load_dword s26, s[72:73], s29
    s_add_u32 s29, s28, 128
    s_load_dword s27, s[72:73], s29
    v_mfma_f32_32x32x16_bf16 v[64:79], a[116:119], v[60:63], v[64:79]
    ds_read2st64_b64 a[140:143], v12 offset0:14 offset1:15
    v_mov_b32 v40, 0
    v_mov_b32 v41, 0
    v_mov_b32 v42, 0
    s_waitcnt lgkmcnt(4)
    v_mfma_f32_32x32x16_bf16 v[80:95], a[120:123], v[56:59], 0
    ds_read2st64_b64 a[144:147], v12 offset0:16 offset1:17
    v_mov_b32 v43, 0
    v_mov_b32 v44, 0
    v_mov_b32 v45, 0
    v_mov_b32 v46, 0
    v_mfma_f32_32x32x16_bf16 v[80:95], a[124:127], v[60:63], v[80:95]
    ds_read2st64_b64 a[148:151], v12 offset0:18 offset1:19
    v_mov_b32 v47, 0
    v_mov_b32 v48, 0
    v_mov_b32 v49, 0
    s_waitcnt lgkmcnt(4)
    v_mfma_f32_32x32x16_bf16 v[96:111], a[128:131], v[56:59], 0
    ds_read2st64_b64 a[152:155], v12 offset0:20 offset1:21
    v_mov_b32 v50, 0
    v_mov_b32 v51, 0
    v_mov_b32 v52, 0
    v_mov_b32 v53, 0
    v_mfma_f32_32x32x16_bf16 v[96:111], a[132:135], v[60:63], v[96:111]
    ds_read2st64_b64 a[156:159], v12 offset0:22 offset1:23
    s_waitcnt lgkmcnt(0)
    s_min_u32 s9, s9, s10
    s_min_u32 s9, s9, s11
    s_cmp_lt_u32 s9, 2
    s_cselect_b32 s0, 0x40000000, 0
    v_add_u32 v27, s0, v27
    v_add_u32 v13, s0, v13
    v_add_u32 v18, s0, v18
    v_mfma_f32_32x32x16_bf16 v[112:127], a[136:139], v[56:59], 0
    ds_read2st64_b64 a[160:163], v12 offset0:24 offset1:25
    s_mul_i32 s33, s6, 448
    s_add_u32 s33, s33, 4194304
    s_lshl_b32 s29, s22, 7
    s_add_u32 s29, s29, 16777216
    buffer_load_dword v34, v18, s[72:75], s29 offen sc1
    v_mfma_f32_32x32x16_bf16 v[112:127], a[140:143], v[60:63], v[112:127]
    ds_read2st64_b64 a[164:167], v12 offset0:26 offset1:27
    s_add_i32 s29, s22, -8
    s_max_i32 s29, s29, 0
    s_mul_i32 s29, s29, 28672
    s_add_u32 s14, s29, s33
    s_add_u32 m0, s12, 24576
    s_mov_b32 exec_lo, 0x0fffffff
    s_mov_b32 exec_hi, 0x0fffffff
    buffer_load_dwordx4 v27, s[72:75], s14 offen sc1 lds
    buffer_load_dwordx4 v13, s[72:75], s14 offen offset:1024 sc1 lds
    s_mov_b64 exec, -1
    v_mfma_f32_32x32x16_bf16 v[128:143], a[144:147], v[56:59], 0
    ds_read2st64_b64 a[168:171], v12 offset0:28 offset1:29
    s_add_i32 s29, s22, -4
    s_max_i32 s29, s29, 0
    s_mul_i32 s29, s29, 28672
    s_add_u32 s14, s29, s33
    s_add_u32 m0, s12, 32768
    s_mov_b32 exec_lo, 0x0fffffff
    s_mov_b32 exec_hi, 0x0fffffff
    buffer_load_dwordx4 v27, s[72:75], s14 offen sc1 lds
    buffer_load_dwordx4 v13, s[72:75], s14 offen offset:1024 sc1 lds
    s_mov_b64 exec, -1
    v_mfma_f32_32x32x16_bf16 v[128:143], a[148:151], v[60:63], v[128:143]
    ds_read2st64_b64 a[172:175], v12 offset0:30 offset1:31
    s_add_i32 s29, s22, 0
    s_max_i32 s29, s29, 0
    s_mul_i32 s29, s29, 28672
    s_add_u32 s14, s29, s33
    s_add_u32 m0, s12, 40960
    s_mov_b32 exec_lo, 0x0fffffff
    s_mov_b32 exec_hi, 0x0fffffff
    buffer_load_dwordx4 v27, s[72:75], s14 offen sc1 lds
    buffer_load_dwordx4 v13, s[72:75], s14 offen offset:1024 sc1 lds
    s_mov_b64 exec, -1
    v_mfma_f32_32x32x16_bf16 v[144:159], a[152:155], v[56:59], 0
    ds_read2st64_b64 a[176:179], v12 offset0:32 offset1:33
    v_mov_b32 v54, 0
    v_mov_b32 v55, 0
    v_max3_f32 v14, v64, v65, v14
    v_max3_f32 v14, v66, v67, v14
    v_mfma_f32_32x32x16_bf16 v[144:159], a[156:159], v[60:63], v[144:159]
    ds_read2st64_b64 a[180:183], v12 offset0:34 offset1:35
    v_max3_f32 v14, v68, v69, v14
    v_max3_f32 v14, v70, v71, v14
    v_max3_f32 v14, v72, v73, v14
    s_waitcnt lgkmcnt(4)
    v_mfma_f32_32x32x16_bf16 v[160:175], a[160:163], v[56:59], 0
    v_max3_f32 v14, v74, v75, v14
    v_max3_f32 v14, v76, v77, v14
    v_max3_f32 v14, v78, v79, v14
    v_max3_f32 v14, v80, v81, v14
    v_max3_f32 v14, v82, v83, v14
    v_mfma_f32_32x32x16_bf16 v[160:175], a[164:167], v[60:63], v[160:175]
    v_max3_f32 v14, v84, v85, v14
    v_max3_f32 v14, v86, v87, v14
    v_max3_f32 v14, v88, v89, v14
    v_max3_f32 v14, v90, v91, v14
    s_waitcnt lgkmcnt(2)
    v_mfma_f32_32x32x16_bf16 v[176:191], a[168:171], v[56:59], 0
    v_max3_f32 v14, v92, v93, v14
    v_max3_f32 v14, v94, v95, v14
    v_max3_f32 v14, v96, v97, v14
    v_max3_f32 v14, v98, v99, v14
    v_max3_f32 v14, v100, v101, v14
    v_mfma_f32_32x32x16_bf16 v[176:191], a[172:175], v[60:63], v[176:191]
    v_max3_f32 v14, v102, v103, v14
    v_max3_f32 v14, v104, v105, v14
    v_max3_f32 v14, v106, v107, v14
    v_max3_f32 v14, v108, v109, v14
    s_waitcnt lgkmcnt(0)
    v_mfma_f32_32x32x16_bf16 v[192:207], a[176:179], v[56:59], v[224:239]
    v_max3_f32 v14, v110, v111, v14
    v_max3_f32 v14, v112, v113, v14
    v_max3_f32 v14, v114, v115, v14
    v_max3_f32 v14, v116, v117, v14
    v_max3_f32 v14, v118, v119, v14
    v_mfma_f32_32x32x16_bf16 v[192:207], a[180:183], v[60:63], v[192:207]
    v_max3_f32 v14, v120, v121, v14
    v_max3_f32 v14, v122, v123, v14
    v_max3_f32 v14, v124, v125, v14
    v_max3_f32 v14, v126, v127, v14
    v_max3_f32 v14, v128, v129, v14
    v_max3_f32 v14, v130, v131, v14
    v_max3_f32 v14, v132, v133, v14
    v_max3_f32 v14, v134, v135, v14
    v_max3_f32 v14, v136, v137, v14
    v_max3_f32 v14, v138, v139, v14
    v_max3_f32 v14, v140, v141, v14
    v_max3_f32 v14, v142, v143, v14
    v_max3_f32 v14, v144, v145, v14
    v_max3_f32 v14, v146, v147, v14
    v_max3_f32 v14, v148, v149, v14
    v_max3_f32 v14, v150, v151, v14
    v_max3_f32 v14, v152, v153, v14
    v_max3_f32 v14, v154, v155, v14
    v_max3_f32 v14, v156, v157, v14
    v_max3_f32 v14, v158, v159, v14
    v_max3_f32 v14, v160, v161, v14
    v_max3_f32 v14, v162, v163, v14
    v_max3_f32 v14, v164, v165, v14
    v_max3_f32 v14, v166, v167, v14
    v_max3_f32 v14, v168, v169, v14
    v_max3_f32 v14, v170, v171, v14
    v_max3_f32 v14, v172, v173, v14
    s_waitcnt lgkmcnt(0)
    s_mul_i32 s27, s27, 7
    s_min_u32 s26, s26, s27
    s_max_u32 s26, s26, s39
    s_cmp_lt_u32 s26, 14
    s_cbranch_scc1 L_spin_5
L_back_6:
    v_max3_f32 v14, v174, v175, v14
    s_lshl1_add_u32 s29, s23, s8
    s_lshl_b32 s29, s29, 7
    s_add_u32 s29, s29, 16777216
    buffer_load_dword v8, v19, s[72:75], s29 offen sc1
    v_max3_f32 v14, v176, v177, v14
    v_max3_f32 v14, v178, v179, v14
    v_max3_f32 v14, v180, v181, v14
    v_max3_f32 v14, v182, v183, v14
    v_max3_f32 v14, v184, v185, v14
    v_max3_f32 v14, v186, v187, v14
    v_max3_f32 v14, v188, v189, v14
    v_max3_f32 v14, v190, v191, v14
    v_max3_f32 v14, v192, v193, v14
    v_max3_f32 v14, v194, v195, v14
    v_max3_f32 v14, v196, v197, v14
    v_max3_f32 v14, v198, v199, v14
    v_max3_f32 v14, v200, v201, v14
    buffer_load_dwordx4 a[0:3], v32, s[72:75], s38 offen sc1
    v_max3_f32 v14, v202, v203, v14
    v_max3_f32 v14, v204, v205, v14
    v_max3_f32 v14, v206, v207, v14
    v_mov_b32 v3, v14
    s_nop 1
    v_permlane32_swap_b32 v3, v14
    s_nop 1
    v_max_f32 v14, v3, v14
    v_pk_add_f32 v[64:65], v[64:65], v[14:15] op_sel_hi:[1,0] neg_lo:[0,1] neg_hi:[0,1]
    v_pk_add_f32 v[66:67], v[66:67], v[14:15] op_sel_hi:[1,0] neg_lo:[0,1] neg_hi:[0,1]
    v_pk_add_f32 v[68:69], v[68:69], v[14:15] op_sel_hi:[1,0] neg_lo:[0,1] neg_hi:[0,1]
    buffer_load_dwordx4 a[4:7], v33, s[72:75], s38 offen sc1
    v_readlane_b32 s38, v5, 1
    v_pk_add_f32 v[70:71], v[70:71], v[14:15] op_sel_hi:[1,0] neg_lo:[0,1] neg_hi:[0,1]
    v_pk_add_f32 v[72:73], v[72:73], v[14:15] op_sel_hi:[1,0] neg_lo:[0,1] neg_hi:[0,1]
    v_pk_add_f32 v[74:75], v[74:75], v[14:15] op_sel_hi:[1,0] neg_lo:[0,1] neg_hi:[0,1]
    v_pk_add_f32 v[76:77], v[76:77], v[14:15] op_sel_hi:[1,0] neg_lo:[0,1] neg_hi:[0,1]
    v_pk_add_f32 v[78:79], v[78:79], v[14:15] op_sel_hi:[1,0] neg_lo:[0,1] neg_hi:[0,1]
    v_exp_f32 v64, v64
    v_exp_f32 v65, v65
    v_exp_f32 v66, v66
    v_exp_f32 v67, v67
    buffer_load_dwordx4 a[8:11], v32, s[72:75], s38 offen sc1
    v_exp_f32 v68, v68
    v_exp_f32 v69, v69
    v_exp_f32 v70, v70
    v_exp_f32 v71, v71
    v_exp_f32 v72, v72
    v_exp_f32 v73, v73
    v_exp_f32 v74, v74
    buffer_load_dwordx4 a[12:15], v33, s[72:75], s38 offen sc1
    v_readlane_b32 s38, v5, 2
    v_exp_f32 v75, v75
    v_exp_f32 v76, v76
    v_exp_f32 v77, v77
    v_exp_f32 v78, v78
    v_exp_f32 v79, v79
    v_cvt_pk_bf16_f32 v64, v64, v65
    v_cvt_pk_bf16_f32 v65, v66, v67
    v_cvt_pk_bf16_f32 v66, v68, v69
    buffer_load_dwordx4 a[16:19], v32, s[72:75], s38 offen sc1
    v_cvt_pk_bf16_f32 v67, v70, v71
    v_cvt_pk_bf16_f32 v68, v72, v73
    v_cvt_pk_bf16_f32 v69, v74, v75
    v_cvt_pk_bf16_f32 v70, v76, v77
    v_cvt_pk_bf16_f32 v71, v78, v79
    v_pk_add_f32 v[80:81], v[80:81], v[14:15] op_sel_hi:[1,0] neg_lo:[0,1] neg_hi:[0,1]
    v_pk_add_f32 v[82:83], v[82:83], v[14:15] op_sel_hi:[1,0] neg_lo:[0,1] neg_hi:[0,1]
    v_pk_add_f32 v[84:85], v[84:85], v[14:15] op_sel_hi:[1,0] neg_lo:[0,1] neg_hi:[0,1]
    v_pk_add_f32 v[86:87], v[86:87], v[14:15] op_sel_hi:[1,0] neg_lo:[0,1] neg_hi:[0,1]
    v_pk_add_f32 v[88:89], v[88:89], v[14:15] op_sel_hi:[1,0] neg_lo:[0,1] neg_hi:[0,1]
    v_pk_add_f32 v[90:91], v[90:91], v[14:15] op_sel_hi:[1,0] neg_lo:[0,1] neg_hi:[0,1]
    v_pk_add_f32 v[92:93], v[92:93], v[14:15] op_sel_hi:[1,0] neg_lo:[0,1] neg_hi:[0,1]
    v_pk_add_f32 v[94:95], v[94:95], v[14:15] op_sel_hi:[1,0] neg_lo:[0,1] neg_hi:[0,1]
    buffer_load_dwordx4 a[20:23], v33, s[72:75], s38 offen sc1
    v_readlane_b32 s38, v5, 3
    v_exp_f32 v80, v80
    v_exp_f32 v81, v81
    s_waitcnt vmcnt(14)
    s_barrier
    s_mov_b32 s35, 1
    s_add_u32 s29, s21, 384
    s_atomic_add s35, s[72:73], s29
    v_exp_f32 v82, v82
    buffer_load_dwordx4 a[24:27], v32, s[72:75], s38 offen sc1
    v_exp_f32 v83, v83
    v_exp_f32 v84, v84
    v_exp_f32 v85, v85
    v_exp_f32 v86, v86
    v_exp_f32 v87, v87
    v_exp_f32 v88, v88
    v_exp_f32 v89, v89
    buffer_load_dwordx4 a[28:31], v33, s[72:75], s38 offen sc1
    v_readlane_b32 s38, v5, 4
    v_exp_f32 v90, v90
    v_exp_f32 v91, v91
    v_exp_f32 v92, v92
    v_exp_f32 v93, v93
    v_exp_f32 v94, v94
    v_exp_f32 v95, v95
    v_cvt_pk_bf16_f32 v80, v80, v81
    buffer_load_dwordx4 a[32:35], v32, s[72:75], s38 offen sc1
    v_cvt_pk_bf16_f32 v81, v82, v83
    v_cvt_pk_bf16_f32 v82, v84, v85
    v_cvt_pk_bf16_f32 v83, v86, v87
    v_cvt_pk_bf16_f32 v84, v88, v89
    v_cvt_pk_bf16_f32 v85, v90, v91
    v_cvt_pk_bf16_f32 v86, v92, v93
    v_cvt_pk_bf16_f32 v87, v94, v95
    v_pk_add_f32 v[96:97], v[96:97], v[14:15] op_sel_hi:[1,0] neg_lo:[0,1] neg_hi:[0,1]
    v_pk_add_f32 v[98:99], v[98:99], v[14:15] op_sel_hi:[1,0] neg_lo:[0,1] neg_hi:[0,1]
    v_pk_add_f32 v[100:101], v[100:101], v[14:15] op_sel_hi:[1,0] neg_lo:[0,1] neg_hi:[0,1]
    v_pk_add_f32 v[102:103], v[102:103], v[14:15] op_sel_hi:[1,0] neg_lo:[0,1] neg_hi:[0,1]
    v_pk_add_f32 v[104:105], v[104:105], v[14:15] op_sel_hi:[1,0] neg_lo:[0,1] neg_hi:[0,1]
    v_pk_add_f32 v[106:107], v[106:107], v[14:15] op_sel_hi:[1,0] neg_lo:[0,1] neg_hi:[0,1]
    buffer_load_dwordx4 a[36:39], v33, s[72:75], s38 offen sc1
    v_readlane_b32 s38, v5, 5
    v_pk_add_f32 v[108:109], v[108:109], v[14:15] op_sel_hi:[1,0] neg_lo:[0,1] neg_hi:[0,1]
    v_pk_add_f32 v[110:111], v[110:111], v[14:15] op_sel_hi:[1,0] neg_lo:[0,1] neg_hi:[0,1]
    v_exp_f32 v96, v96
    v_exp_f32 v97, v97
    v_exp_f32 v98, v98
    v_exp_f32 v99, v99
    v_exp_f32 v100, v100
    v_exp_f32 v101, v101
    buffer_load_dwordx4 a[40:43], v32, s[72:75], s38 offen sc1
    v_exp_f32 v102, v102
    v_exp_f32 v103, v103
    v_exp_f32 v104, v104
    v_exp_f32 v105, v105
    v_exp_f32 v106, v106
    v_exp_f32 v107, v107
    v_exp_f32 v108, v108
    buffer_load_dwordx4 a[44:47], v33, s[72:75], s38 offen sc1
    v_readlane_b32 s38, v5, 6
    v_exp_f32 v109, v109
    v_exp_f32 v110, v110
    v_exp_f32 v111, v111
    v_cvt_pk_bf16_f32 v96, v96, v97
    v_cvt_pk_bf16_f32 v97, v98, v99
    v_cvt_pk_bf16_f32 v98, v100, v101
    v_cvt_pk_bf16_f32 v99, v102, v103
    v_cvt_pk_bf16_f32 v100, v104, v105
    v_cvt_pk_bf16_f32 v101, v106, v107
    v_cvt_pk_bf16_f32 v102, v108, v109
    buffer_load_dwordx4 a[48:51], v32, s[72:75], s38 offen sc1
    v_cvt_pk_bf16_f32 v103, v110, v111
    v_pk_add_f32 v[112:113], v[112:113], v[14:15] op_sel_hi:[1,0] neg_lo:[0,1] neg_hi:[0,1]
    v_pk_add_f32 v[114:115], v[114:115], v[14:15] op_sel_hi:[1,0] neg_lo:[0,1] neg_hi:[0,1]
    v_pk_add_f32 v[116:117], v[116:117], v[14:15] op_sel_hi:[1,0] neg_lo:[0,1] neg_hi:[0,1]
    v_pk_add_f32 v[118:119], v[118:119], v[14:15] op_sel_hi:[1,0] neg_lo:[0,1] neg_hi:[0,1]
    v_pk_add_f32 v[120:121], v[120:121], v[14:15] op_sel_hi:[1,0] neg_lo:[0,1] neg_hi:[0,1]
    v_pk_add_f32 v[122:123], v[122:123], v[14:15] op_sel_hi:[1,0] neg_lo:[0,1] neg_hi:[0,1]
    v_pk_add_f32 v[124:125], v[124:125], v[14:15] op_sel_hi:[1,0] neg_lo:[0,1] neg_hi:[0,1]
    v_pk_add_f32 v[126:127], v[126:127], v[14:15] op_sel_hi:[1,0] neg_lo:[0,1] neg_hi:[0,1]
    v_exp_f32 v112, v112
    v_exp_f32 v113, v113
    buffer_load_dwordx4 a[52:55], v33, s[72:75], s38 offen sc1
    v_readlane_b32 s38, v5, 7
    v_exp_f32 v114, v114
    v_exp_f32 v115, v115
    v_exp_f32 v116, v116
    v_exp_f32 v117, v117
    v_exp_f32 v118, v118
    v_exp_f32 v119, v119
    v_exp_f32 v120, v120
    buffer_load_dwordx4 a[56:59], v32, s[72:75], s38 offen sc1
    v_exp_f32 v121, v121
    v_exp_f32 v122, v122
    v_exp_f32 v123, v123
    v_exp_f32 v124, v124
    v_exp_f32 v125, v125
    v_exp_f32 v126, v126
    v_exp_f32 v127, v127
    buffer_load_dwordx4 a[60:63], v33, s[72:75], s38 offen sc1
    v_readlane_b32 s38, v5, 8
    v_cvt_pk_bf16_f32 v112, v112, v113
    s_cmp_lg_u32 s0, 0
    s_cbranch_scc1 L_vfix_7
L_vfixb_8:
    s_waitcnt vmcnt(17)
    s_barrier
    v_cvt_pk_bf16_f32 v113, v114, v115
    v_cvt_pk_bf16_f32 v114, v116, v117
    v_cvt_pk_bf16_f32 v115, v118, v119
    v_cvt_pk_bf16_f32 v116, v120, v121
    buffer_load_dwordx4 a[64:67], v32, s[72:75], s38 offen sc1
    v_cvt_pk_bf16_f32 v117, v122, v123
    v_cvt_pk_bf16_f32 v118, v124, v125
    v_cvt_pk_bf16_f32 v119, v126, v127
    v_pk_add_f32 v[128:129], v[128:129], v[14:15] op_sel_hi:[1,0] neg_lo:[0,1] neg_hi:[0,1]
    v_pk_add_f32 v[130:131], v[130:131], v[14:15] op_sel_hi:[1,0] neg_lo:[0,1] neg_hi:[0,1]
    v_pk_add_f32 v[132:133], v[132:133], v[14:15] op_sel_hi:[1,0] neg_lo:[0,1] neg_hi:[0,1]
    v_pk_add_f32 v[134:135], v[134:135], v[14:15] op_sel_hi:[1,0] neg_lo:[0,1] neg_hi:[0,1]
    v_pk_add_f32 v[136:137], v[136:137], v[14:15] op_sel_hi:[1,0] neg_lo:[0,1] neg_hi:[0,1]
    v_pk_add_f32 v[138:139], v[138:139], v[14:15] op_sel_hi:[1,0] neg_lo:[0,1] neg_hi:[0,1]
    v_pk_add_f32 v[140:141], v[140:141], v[14:15] op_sel_hi:[1,0] neg_lo:[0,1] neg_hi:[0,1]
    v_pk_add_f32 v[142:143], v[142:143], v[14:15] op_sel_hi:[1,0] neg_lo:[0,1] neg_hi:[0,1]
    v_exp_f32 v128, v128
    ds_read_b128 a[184:187], v6 offset:24576
    buffer_load_dwordx4 a[68:71], v33, s[72:75], s38 offen sc1
    v_readlane_b32 s38, v5, 9
    v_exp_f32 v129, v129
    ds_read_b128 a[188:191], v6 offset:25600
    v_exp_f32 v130, v130
    ds_read_b128 a[192:195], v6 offset:26624
    v_exp_f32 v131, v131
    ds_read_b128 a[196:199], v6 offset:27648
    v_exp_f32 v132, v132
    ds_read_b128 a[200:203], v6 offset:28672
    v_exp_f32 v133, v133
    ds_read_b128 a[204:207], v6 offset:29696
    buffer_load_dwordx4 a[72:75], v32, s[72:75], s38 offen sc1
    v_exp_f32 v134, v134
    v_exp_f32 v135, v135
    v_exp_f32 v136, v136
    v_exp_f32 v137, v137
    v_exp_f32 v138, v138
    s_waitcnt lgkmcnt(5)
    v_mfma_f32_32x32x16_bf16 v[40:55], a[184:187], v[64:67], v[40:55]
    buffer_load_dwordx4 a[76:79], v33, s[72:75], s38 offen sc1
    v_readlane_b32 s38, v5, 10
    v_exp_f32 v139, v139
    ds_read_b128 a[208:211], v6 offset:30720
    v_exp_f32 v140, v140
    s_waitcnt lgkmcnt(5)
    v_mfma_f32_32x32x16_bf16 v[40:55], a[188:191], v[68:71], v[40:55]
    v_exp_f32 v141, v141
    ds_read_b128 a[212:215], v6 offset:31744
    v_exp_f32 v142, v142
    s_waitcnt lgkmcnt(5)
    v_mfma_f32_32x32x16_bf16 v[40:55], a[192:195], v[80:83], v[40:55]
    buffer_load_dwordx4 a[80:83], v32, s[72:75], s38 offen sc1
    v_exp_f32 v143, v143
    ds_read_b128 a[216:219], v6 offset:32768
    v_cvt_pk_bf16_f32 v128, v128, v129
    v_cvt_pk_bf16_f32 v129, v130, v131
    v_cvt_pk_bf16_f32 v130, v132, v133
    v_cvt_pk_bf16_f32 v131, v134, v135
    v_cvt_pk_bf16_f32 v132, v136, v137
    v_cvt_pk_bf16_f32 v133, v138, v139
    v_cvt_pk_bf16_f32 v134, v140, v141
    v_cvt_pk_bf16_f32 v135, v142, v143
    v_pk_add_f32 v[144:145], v[144:145], v[14:15] op_sel_hi:[1,0] neg_lo:[0,1] neg_hi:[0,1]
    v_pk_add_f32 v[146:147], v[146:147], v[14:15] op_sel_hi:[1,0] neg_lo:[0,1] neg_hi:[0,1]
    buffer_load_dwordx4 a[84:87], v33, s[72:75], s38 offen sc1
    v_readlane_b32 s38, v5, 11
    v_pk_add_f32 v[148:149], v[148:149], v[14:15] op_sel_hi:[1,0] neg_lo:[0,1] neg_hi:[0,1]
    v_pk_add_f32 v[150:151], v[150:151], v[14:15] op_sel_hi:[1,0] neg_lo:[0,1] neg_hi:[0,1]
    v_pk_add_f32 v[152:153], v[152:153], v[14:15] op_sel_hi:[1,0] neg_lo:[0,1] neg_hi:[0,1]
    v_pk_add_f32 v[154:155], v[154:155], v[14:15] op_sel_hi:[1,0] neg_lo:[0,1] neg_hi:[0,1]
    v_pk_add_f32 v[156:157], v[156:157], v[14:15] op_sel_hi:[1,0] neg_lo:[0,1] neg_hi:[0,1]
    v_pk_add_f32 v[158:159], v[158:159], v[14:15] op_sel_hi:[1,0] neg_lo:[0,1] neg_hi:[0,1]
    v_exp_f32 v144, v144
    s_waitcnt lgkmcnt(5)
    v_mfma_f32_32x32x16_bf16 v[40:55], a[196:199], v[84:87], v[40:55]
    v_exp_f32 v145, v145
    ds_read_b128 a[220:223], v6 offset:33792
    buffer_load_dwordx4 a[88:91], v32, s[72:75], s38 offen sc1
    v_exp_f32 v146, v146
    s_waitcnt lgkmcnt(5)
    v_mfma_f32_32x32x16_bf16 v[40:55], a[200:203], v[96:99], v[40:55]
    v_exp_f32 v147, v147
    ds_read_b128 a[224:227], v6 offset:34816
    v_exp_f32 v148, v148
    s_waitcnt lgkmcnt(5)
    v_mfma_f32_32x32x16_bf16 v[40:55], a[204:207], v[100:103], v[40:55]
    buffer_load_dwordx4 a[92:95], v33, s[72:75], s38 offen sc1
    v_readlane_b32 s38, v5, 12
    v_exp_f32 v149, v149
    ds_read_b128 a[228:231], v6 offset:35840
    v_exp_f32 v150, v150
    s_waitcnt lgkmcnt(5)
    v_mfma_f32_32x32x16_bf16 v[40:55], a[208:211], v[112:115], v[40:55]
    v_exp_f32 v151, v151
    ds_read_b128 a[232:235], v6 offset:36864
    v_exp_f32 v152, v152
    s_waitcnt lgkmcnt(5)
    v_mfma_f32_32x32x16_bf16 v[40:55], a[212:215], v[116:119], v[40:55]
    buffer_load_dwordx4 a[96:99], v32, s[72:75], s38 offen sc1
    v_exp_f32 v153, v153
    ds_read_b128 a[236:239], v6 offset:37888
    v_exp_f32 v154, v154
    s_waitcnt lgkmcnt(5)
    v_mfma_f32_32x32x16_bf16 v[40:55], a[216:219], v[128:131], v[40:55]
    v_exp_f32 v155, v155
    ds_read_b128 a[240:243], v6 offset:38912
    v_exp_f32 v156, v156
    s_waitcnt lgkmcnt(5)
    v_mfma_f32_32x32x16_bf16 v[40:55], a[220:223], v[132:135], v[40:55]
    buffer_load_dwordx4 a[100:103], v33, s[72:75], s38 offen sc1
    v_readlane_b32 s38, v5, 13
    v_exp_f32 v157, v157
    ds_read_b128 a[244:247], v6 offset:39936
    v_exp_f32 v158, v158
    v_exp_f32 v159, v159
    v_cvt_pk_bf16_f32 v144, v144, v145
    v_cvt_pk_bf16_f32 v145, v146, v147
    v_cvt_pk_bf16_f32 v146, v148, v149
    v_cvt_pk_bf16_f32 v147, v150, v151
    v_cvt_pk_bf16_f32 v148, v152, v153
    v_cvt_pk_bf16_f32 v149, v154, v155
    buffer_load_dwordx4 a[104:107], v32, s[72:75], s38 offen sc1
    v_cvt_pk_bf16_f32 v150, v156, v157
    v_cvt_pk_bf16_f32 v151, v158, v159
    v_pk_add_f32 v[160:161], v[160:161], v[14:15] op_sel_hi:[1,0] neg_lo:[0,1] neg_hi:[0,1]
    v_pk_add_f32 v[162:163], v[162:163], v[14:15] op_sel_hi:[1,0] neg_lo:[0,1] neg_hi:[0,1]
    v_pk_add_f32 v[164:165], v[164:165], v[14:15] op_sel_hi:[1,0] neg_lo:[0,1] neg_hi:[0,1]
    v_pk_add_f32 v[166:167], v[166:167], v[14:15] op_sel_hi:[1,0] neg_lo:[0,1] neg_hi:[0,1]
    v_pk_add_f32 v[168:169], v[168:169], v[14:15] op_sel_hi:[1,0] neg_lo:[0,1] neg_hi:[0,1]
    v_pk_add_f32 v[170:171], v[170:171], v[14:15] op_sel_hi:[1,0] neg_lo:[0,1] neg_hi:[0,1]
    v_pk_add_f32 v[172:173], v[172:173], v[14:15] op_sel_hi:[1,0] neg_lo:[0,1] neg_hi:[0,1]
    v_pk_add_f32 v[174:175], v[174:175], v[14:15] op_sel_hi:[1,0] neg_lo:[0,1] neg_hi:[0,1]
    v_exp_f32 v160, v160
    s_waitcnt lgkmcnt(5)
    v_mfma_f32_32x32x16_bf16 v[40:55], a[224:227], v[144:147], v[40:55]
    buffer_load_dwordx4 a[108:111], v33, s[72:75], s38 offen sc1
    v_readlane_b32 s38, v5, 14
    v_exp_f32 v161, v161
    ds_read_b128 a[248:251], v6 offset:40960
    s_add_u32 m0, s12, 0
    v_exp_f32 v162, v162
    s_waitcnt lgkmcnt(5)
    v_mfma_f32_32x32x16_bf16 v[40:55], a[228:231], v[148:151], v[40:55]
    buffer_load_dwordx4 v28, s[76:79], s36 offen offset:0 lds
    v_exp_f32 v163, v163
    ds_read_b128 a[252:255], v6 offset:41984
    v_exp_f32 v164, v164
    v_exp_f32 v165, v165
    v_exp_f32 v166, v166
    v_exp_f32 v167, v167
    v_exp_f32 v168, v168
    buffer_load_dwordx4 v29, s[76:79], s36 offen offset:1024 lds
    v_readlane_b32 s36, v4, 15
    v_exp_f32 v169, v169
    s_add_u32 m0, s12, 8192
    v_exp_f32 v170, v170
    s_nop 1
    buffer_load_dwordx4 v28, s[76:79], s36 offen offset:0 lds
    v_exp_f32 v171, v171
    s_waitcnt lgkmcnt(0)
    s_barrier
    v_exp_f32 v172, v172
    v_exp_f32 v173, v173
    v_exp_f32 v174, v174
    buffer_load_dwordx4 v29, s[76:79], s36 offen offset:1024 lds
    v_readlane_b32 s36, v4, 16
    v_exp_f32 v175, v175
    s_add_u32 m0, s12, 16384
    v_cvt_pk_bf16_f32 v160, v160, v161
    s_nop 1
    buffer_load_dwordx4 v28, s[76:79], s36 offen offset:0 lds
    v_cvt_pk_bf16_f32 v161, v162, v163
    v_cvt_pk_bf16_f32 v162, v164, v165
    v_cvt_pk_bf16_f32 v163, v166, v167
    v_cvt_pk_bf16_f32 v164, v168, v169
    v_cvt_pk_bf16_f32 v165, v170, v171
    v_cvt_pk_bf16_f32 v166, v172, v173
    v_cvt_pk_bf16_f32 v167, v174, v175
    v_pk_add_f32 v[176:177], v[176:177], v[14:15] op_sel_hi:[1,0] neg_lo:[0,1] neg_hi:[0,1]
    v_pk_add_f32 v[178:179], v[178:179], v[14:15] op_sel_hi:[1,0] neg_lo:[0,1] neg_hi:[0,1]
    v_pk_add_f32 v[180:181], v[180:181], v[14:15] op_sel_hi:[1,0] neg_lo:[0,1] neg_hi:[0,1]
    v_pk_add_f32 v[182:183], v[182:183], v[14:15] op_sel_hi:[1,0] neg_lo:[0,1] neg_hi:[0,1]
    v_pk_add_f32 v[184:185], v[184:185], v[14:15] op_sel_hi:[1,0] neg_lo:[0,1] neg_hi:[0,1]
    v_pk_add_f32 v[186:187], v[186:187], v[14:15] op_sel_hi:[1,0] neg_lo:[0,1] neg_hi:[0,1]
    buffer_load_dwordx4 v29, s[76:79], s36 offen offset:1024 lds
    v_readlane_b32 s36, v4, 17
    v_pk_add_f32 v[188:189], v[188:189], v[14:15] op_sel_hi:[1,0] neg_lo:[0,1] neg_hi:[0,1]
    s_add_u32 m0, s12, 24576
    v_pk_add_f32 v[190:191], v[190:191], v[14:15] op_sel_hi:[1,0] neg_lo:[0,1] neg_hi:[0,1]
    s_nop 1
    buffer_load_dwordx4 v28, s[76:79], s36 offen offset:0 lds
    v_exp_f32 v176, v176
    v_mfma_f32_32x32x16_bf16 v[40:55], a[232:235], v[160:163], v[40:55]
    v_exp_f32 v177, v177
    v_exp_f32 v178, v178
    v_exp_f32 v179, v179
    v_mfma_f32_32x32x16_bf16 v[40:55], a[236:239], v[164:167], v[40:55]
    s_add_u32 s29, s28, 384
    s_load_dword s9, s[72:73], s29
    v_exp_f32 v180, v180
    buffer_load_dwordx4 v29, s[76:79], s36 offen offset:1024 lds
    v_readlane_b32 s36, v4, 18
    v_exp_f32 v181, v181
    s_add_u32 m0, s12, 32768
    v_exp_f32 v182, v182
    s_nop 1
    buffer_load_dwordx4 v28, s[76:79], s36 offen offset:0 lds
    v_exp_f32 v183, v183
    v_exp_f32 v184, v184
    v_exp_f32 v185, v185
    v_exp_f32 v186, v186
    v_exp_f32 v187, v187
    v_exp_f32 v188, v188
    v_exp_f32 v189, v189
    buffer_load_dwordx4 v29, s[76:79], s36 offen offset:1024 lds
    v_readlane_b32 s36, v4, 19
    v_exp_f32 v190, v190
    s_add_u32 m0, s12, 40960
    v_exp_f32 v191, v191
    s_nop 1
    buffer_load_dwordx4 v28, s[76:79], s36 offen offset:0 lds
    v_cvt_pk_bf16_f32 v176, v176, v177
    v_cvt_pk_bf16_f32 v177, v178, v179
    v_cvt_pk_bf16_f32 v178, v180, v181
    v_cvt_pk_bf16_f32 v179, v182, v183
    v_cvt_pk_bf16_f32 v180, v184, v185
    v_cvt_pk_bf16_f32 v181, v186, v187
    v_cvt_pk_bf16_f32 v182, v188, v189
    v_cvt_pk_bf16_f32 v183, v190, v191
    v_pk_add_f32 v[192:193], v[192:193], v[14:15] op_sel_hi:[1,0] neg_lo:[0,1] neg_hi:[0,1]
    v_pk_add_f32 v[194:195], v[194:195], v[14:15] op_sel_hi:[1,0] neg_lo:[0,1] neg_hi:[0,1]
    v_pk_add_f32 v[196:197], v[196:197], v[14:15] op_sel_hi:[1,0] neg_lo:[0,1] neg_hi:[0,1]
    v_pk_add_f32 v[198:199], v[198:199], v[14:15] op_sel_hi:[1,0] neg_lo:[0,1] neg_hi:[0,1]
    v_pk_add_f32 v[200:201], v[200:201], v[14:15] op_sel_hi:[1,0] neg_lo:[0,1] neg_hi:[0,1]
    buffer_load_dwordx4 v29, s[76:79], s36 offen offset:1024 lds
    v_readlane_b32 s36, v4, 20
    v_pk_add_f32 v[202:203], v[202:203], v[14:15] op_sel_hi:[1,0] neg_lo:[0,1] neg_hi:[0,1]
    v_pk_add_f32 v[204:205], v[204:205], v[14:15] op_sel_hi:[1,0] neg_lo:[0,1] neg_hi:[0,1]
    v_pk_add_f32 v[206:207], v[206:207], v[14:15] op_sel_hi:[1,0] neg_lo:[0,1] neg_hi:[0,1]
    v_exp_f32 v192, v192
    v_mfma_f32_32x32x16_bf16 v[40:55], a[240:243], v[176:179], v[40:55]
    v_exp_f32 v193, v193
    v_exp_f32 v194, v194
    v_exp_f32 v195, v195
    v_mfma_f32_32x32x16_bf16 v[40:55], a[244:247], v[180:183], v[40:55]
    v_exp_f32 v196, v196
    v_exp_f32 v197, v197
    v_exp_f32 v198, v198
    v_exp_f32 v199, v199
    v_exp_f32 v200, v200
    v_exp_f32 v201, v201
    v_exp_f32 v202, v202
    v_exp_f32 v203, v203
    v_exp_f32 v204, v204
    v_exp_f32 v205, v205
    v_exp_f32 v206, v206
    v_exp_f32 v207, v207
    v_cvt_pk_bf16_f32 v192, v192, v193
    v_cvt_pk_bf16_f32 v193, v194, v195
    v_cvt_pk_bf16_f32 v194, v196, v197
    v_cvt_pk_bf16_f32 v195, v198, v199
    v_cvt_pk_bf16_f32 v196, v200, v201
    v_cvt_pk_bf16_f32 v197, v202, v203
    v_cvt_pk_bf16_f32 v198, v204, v205
    v_cvt_pk_bf16_f32 v199, v206, v207
    s_mul_i32 s29, s22, 147456
    s_lshl_b32 s30, s6, 11
    s_add_u32 s29, s29, s30
    s_add_u32 s33, s29, 6406144
    v_mfma_f32_32x32x16_bf16 v[40:55], a[248:251], v[192:195], v[40:55]
    s_waitcnt vmcnt(38)
    v_add_u32 v30, 0x10000, v30
    ds_read_b64_tr_b16 v[136:137], v30 offset:16384
    ds_read_b64_tr_b16 v[138:139], v30 offset:17408
    v_mfma_f32_32x32x16_bf16 v[40:55], a[252:255], v[196:199], v[40:55]
    v_add_u32 v31, 0x10000, v31
    ds_read_b64_tr_b16 v[140:141], v31 offset:16384
    ds_read_b64_tr_b16 v[142:143], v31 offset:17408
    s_waitcnt vmcnt(36)
    ds_read_b64_tr_b16 v[152:153], v30 offset:24576
    ds_read_b64_tr_b16 v[154:155], v30 offset:25600
    ds_read_b64_tr_b16 v[156:157], v31 offset:24576
    ds_read_b64_tr_b16 v[158:159], v31 offset:25600
    s_waitcnt lgkmcnt(4)
    v_mfma_f32_32x32x16_bf16 v[64:79], v[136:139], a[0:3], 0
    s_waitcnt vmcnt(34)
    ds_read_b64_tr_b16 v[168:169], v30 offset:32768
    s_add_u32 m0, s12, 81920
    v_mfma_f32_32x32x16_bf16 v[96:111], v[136:139], a[4:7], 0
    ds_read_b64_tr_b16 v[170:171], v30 offset:33792
    buffer_load_dwordx4 v28, s[76:79], s36 offen offset:0 lds
    v_mfma_f32_32x32x16_bf16 v[80:95], v[140:143], a[0:3], 0
    ds_read_b64_tr_b16 v[172:173], v31 offset:32768
    v_cmp_gt_u32 vcc, 32, v1
    v_mov_b32 v2, v52
    v_mov_b32 v3, v52
    s_nop 0
    s_nop 0
    v_permlane32_swap_b32 v2, v3
    s_nop 0
    v_rcp_f32 v3, v3
    v_mfma_f32_32x32x16_bf16 v[112:127], v[140:143], a[4:7], 0
    ds_read_b64_tr_b16 v[174:175], v31 offset:33792
    buffer_load_dwordx4 v29, s[76:79], s36 offen offset:1024 lds
    v_readlane_b32 s36, v4, 21
    s_nop 0
    v_mul_f32 v2, v3, v34
    v_pk_mul_f32 v[40:41], v[40:41], v[2:3] op_sel_hi:[1,0]
    v_pk_mul_f32 v[42:43], v[42:43], v[2:3] op_sel_hi:[1,0]
    s_waitcnt lgkmcnt(4)
    v_mfma_f32_32x32x16_bf16 v[64:79], v[152:155], a[8:11], v[64:79]
    s_waitcnt vmcnt(34)
    ds_read_b64_tr_b16 v[136:137], v30 offset:40960
    s_add_u32 m0, s12, 90112
    v_pk_mul_f32 v[44:45], v[44:45], v[2:3] op_sel_hi:[1,0]
    v_pk_mul_f32 v[46:47], v[46:47], v[2:3] op_sel_hi:[1,0]
    v_pk_mul_f32 v[48:49], v[48:49], v[2:3] op_sel_hi:[1,0]
    v_pk_mul_f32 v[50:51], v[50:51], v[2:3] op_sel_hi:[1,0]
    v_pk_mul_f32 v[52:53], v[52:53], v[2:3] op_sel_hi:[1,0]
    v_mfma_f32_32x32x16_bf16 v[96:111], v[152:155], a[12:15], v[96:111]
    ds_read_b64_tr_b16 v[138:139], v30 offset:41984
    buffer_load_dwordx4 v28, s[76:79], s36 offen offset:0 lds
    v_pk_mul_f32 v[54:55], v[54:55], v[2:3] op_sel_hi:[1,0]
    v_cvt_pk_bf16_f32 v40, v40, v41
    v_cvt_pk_bf16_f32 v41, v42, v43
    v_cvt_pk_bf16_f32 v42, v44, v45
    v_cvt_pk_bf16_f32 v43, v46, v47
    v_cvt_pk_bf16_f32 v44, v48, v49
    v_mfma_f32_32x32x16_bf16 v[80:95], v[156:159], a[8:11], v[80:95]
    ds_read_b64_tr_b16 v[140:141], v31 offset:40960
    v_cvt_pk_bf16_f32 v45, v50, v51
    v_cvt_pk_bf16_f32 v46, v52, v53
    v_cvt_pk_bf16_f32 v47, v54, v55
    v_cndmask_b32 v46, 0, v46, vcc
    v_cndmask_b32 v47, 0, v47, vcc
    v_mfma_f32_32x32x16_bf16 v[112:127], v[156:159], a[12:15], v[112:127]
    ds_read_b64_tr_b16 v[142:143], v31 offset:41984
    buffer_load_dwordx4 v29, s[76:79], s36 offen offset:1024 lds
    v_readlane_b32 s36, v4, 22
    buffer_store_dwordx4 v[40:43], v26, s[72:75], s33 offen offset:0 sc1
    s_waitcnt lgkmcnt(4)
    v_mfma_f32_32x32x16_bf16 v[64:79], v[168:171], a[16:19], v[64:79]
    s_waitcnt vmcnt(35)
    ds_read_b64_tr_b16 v[152:153], v30 offset:49152
    s_add_u32 m0, s12, 98304
    buffer_store_dwordx4 v[44:47], v26, s[72:75], s33 offen offset:1024 sc1
    v_mfma_f32_32x32x16_bf16 v[96:111], v[168:171], a[20:23], v[96:111]
    ds_read_b64_tr_b16 v[154:155], v30 offset:50176
    s_waitcnt lgkmcnt(0)
    s_cmp_lt_u32 s9, 14
    s_cbranch_scc1 L_spin_9
L_back_10:
    v_mfma_f32_32x32x16_bf16 v[80:95], v[172:175], a[16:19], v[80:95]
    ds_read_b64_tr_b16 v[156:157], v31 offset:49152
    buffer_load_dwordx4 a[112:115], v32, s[72:75], s38 offen sc1
    s_cmp_ge_u32 s2, 224
    s_cbranch_scc1 L_idle
    v_mfma_f32_32x32x16_bf16 v[112:127], v[172:175], a[20:23], v[112:127]
    ds_read_b64_tr_b16 v[158:159], v31 offset:50176
    v_mfma_f32_32x32x16_bf16 v[64:79], v[136:139], a[24:27], v[64:79]
    s_waitcnt vmcnt(35)
    ds_read_b64_tr_b16 v[168:169], v30 offset:57344
    buffer_load_dwordx4 a[116:119], v33, s[72:75], s38 offen sc1
    v_readlane_b32 s38, v5, 15
    v_mfma_f32_32x32x16_bf16 v[96:111], v[136:139], a[28:31], v[96:111]
    ds_read_b64_tr_b16 v[170:171], v30 offset:58368
    v_mfma_f32_32x32x16_bf16 v[80:95], v[140:143], a[24:27], v[80:95]
    ds_read_b64_tr_b16 v[172:173], v31 offset:57344
    s_nop 0
    buffer_load_dwordx4 a[120:123], v32, s[72:75], s38 offen sc1
    v_mfma_f32_32x32x16_bf16 v[112:127], v[140:143], a[28:31], v[112:127]
    ds_read_b64_tr_b16 v[174:175], v31 offset:58368
    s_waitcnt lgkmcnt(4)
    v_mfma_f32_32x32x16_bf16 v[64:79], v[152:155], a[32:35], v[64:79]
    s_waitcnt vmcnt(35)
    v_add_u32 v30, 0x10000, v30
    ds_read_b64_tr_b16 v[136:137], v30 offset:0
    buffer_load_dwordx4 a[124:127], v33, s[72:75], s38 offen sc1
    v_readlane_b32 s38, v5, 16
    v_mfma_f32_32x32x16_bf16 v[96:111], v[152:155], a[36:39], v[96:111]
    ds_read_b64_tr_b16 v[138:139], v30 offset:1024
    v_mfma_f32_32x32x16_bf16 v[80:95], v[156:159], a[32:35], v[80:95]
    v_add_u32 v31, 0x10000, v31
    ds_read_b64_tr_b16 v[140:141], v31 offset:0
    buffer_load_dwordx4 a[128:131], v32, s[72:75], s38 offen sc1
    v_mfma_f32_32x32x16_bf16 v[112:127], v[156:159], a[36:39], v[112:127]
    ds_read_b64_tr_b16 v[142:143], v31 offset:1024
    s_waitcnt lgkmcnt(4)
    v_mfma_f32_32x32x16_bf16 v[64:79], v[168:171], a[40:43], v[64:79]
    s_waitcnt vmcnt(35)
    ds_read_b64_tr_b16 v[152:153], v30 offset:8192
    buffer_load_dwordx4 a[132:135], v33, s[72:75], s38 offen sc1
    v_readlane_b32 s38, v5, 17
    v_mfma_f32_32x32x16_bf16 v[96:111], v[168:171], a[44:47], v[96:111]
    ds_read_b64_tr_b16 v[154:155], v30 offset:9216
    v_mfma_f32_32x32x16_bf16 v[80:95], v[172:175], a[40:43], v[80:95]
    ds_read_b64_tr_b16 v[156:157], v31 offset:8192
    v_mfma_f32_32x32x16_bf16 v[112:127], v[172:175], a[44:47], v[112:127]
    ds_read_b64_tr_b16 v[158:159], v31 offset:9216
    buffer_load_dwordx4 a[136:139], v32, s[72:75], s38 offen sc1
    s_waitcnt lgkmcnt(4)
    v_mfma_f32_32x32x16_bf16 v[64:79], v[136:139], a[48:51], v[64:79]
    s_waitcnt vmcnt(35)
    ds_read_b64_tr_b16 v[168:169], v30 offset:16384
    v_mfma_f32_32x32x16_bf16 v[96:111], v[136:139], a[52:55], v[96:111]
    ds_read_b64_tr_b16 v[170:171], v30 offset:17408
    buffer_load_dwordx4 a[140:143], v33, s[72:75], s38 offen sc1
    v_readlane_b32 s38, v5, 18
    v_mfma_f32_32x32x16_bf16 v[80:95], v[140:143], a[48:51], v[80:95]
    ds_read_b64_tr_b16 v[172:173], v31 offset:16384
    v_mfma_f32_32x32x16_bf16 v[112:127], v[140:143], a[52:55], v[112:127]
    ds_read_b64_tr_b16 v[174:175], v31 offset:17408
    s_nop 0
    buffer_load_dwordx4 a[144:147], v32, s[72:75], s38 offen sc1
    s_waitcnt lgkmcnt(4)
    v_mfma_f32_32x32x16_bf16 v[64:79], v[152:155], a[56:59], v[64:79]
    s_waitcnt vmcnt(35)
    ds_read_b64_tr_b16 v[136:137], v30 offset:24576
    v_mfma_f32_32x32x16_bf16 v[96:111], v[152:155], a[60:63], v[96:111]
    ds_read_b64_tr_b16 v[138:139], v30 offset:25600
    buffer_load_dwordx4 a[148:151], v33, s[72:75], s38 offen sc1
    v_readlane_b32 s38, v5, 19
    v_mfma_f32_32x32x16_bf16 v[80:95], v[156:159], a[56:59], v[80:95]
    ds_read_b64_tr_b16 v[140:141], v31 offset:24576
    v_mfma_f32_32x32x16_bf16 v[112:127], v[156:159], a[60:63], v[112:127]
    ds_read_b64_tr_b16 v[142:143], v31 offset:25600
    s_waitcnt lgkmcnt(4)
    v_mfma_f32_32x32x16_bf16 v[64:79], v[168:171], a[64:67], v[64:79]
    s_waitcnt vmcnt(34)
    v_add_u32 v30, 0xfffe8000, v30
    ds_read_b64_tr_b16 v[152:153], v30 offset:16384
    buffer_load_dwordx4 a[152:155], v32, s[72:75], s38 offen sc1
    v_mfma_f32_32x32x16_bf16 v[96:111], v[168:171], a[68:71], v[96:111]
    ds_read_b64_tr_b16 v[154:155], v30 offset:17408
    v_mfma_f32_32x32x16_bf16 v[80:95], v[172:175], a[64:67], v[80:95]
    v_add_u32 v31, 0xfffe8000, v31
    ds_read_b64_tr_b16 v[156:157], v31 offset:16384
    buffer_load_dwordx4 a[156:159], v33, s[72:75], s38 offen sc1
    v_readlane_b32 s38, v5, 20
    v_mfma_f32_32x32x16_bf16 v[112:127], v[172:175], a[68:71], v[112:127]
    ds_read_b64_tr_b16 v[158:159], v31 offset:17408
    s_waitcnt lgkmcnt(4)
    v_mfma_f32_32x32x16_bf16 v[64:79], v[136:139], a[72:75], v[64:79]
    s_waitcnt vmcnt(34)
    ds_read_b64_tr_b16 v[168:169], v30 offset:24576
    buffer_load_dwordx4 a[160:163], v32, s[72:75], s38 offen sc1
    v_mfma_f32_32x32x16_bf16 v[96:111], v[136:139], a[76:79], v[96:111]
    ds_read_b64_tr_b16 v[170:171], v30 offset:25600
    v_mfma_f32_32x32x16_bf16 v[80:95], v[140:143], a[72:75], v[80:95]
    ds_read_b64_tr_b16 v[172:173], v31 offset:24576
    v_mfma_f32_32x32x16_bf16 v[112:127], v[140:143], a[76:79], v[112:127]
    ds_read_b64_tr_b16 v[174:175], v31 offset:25600
    buffer_load_dwordx4 a[164:167], v33, s[72:75], s38 offen sc1
    v_readlane_b32 s38, v5, 21
    s_waitcnt lgkmcnt(4)
    v_mfma_f32_32x32x16_bf16 v[64:79], v[152:155], a[80:83], v[64:79]
    s_waitcnt vmcnt(34)
    ds_read_b64_tr_b16 v[136:137], v30 offset:32768
    s_waitcnt vmcnt(14)
    s_mov_b32 s35, 1
    s_atomic_add s35, s[72:73], s3
    v_mfma_f32_32x32x16_bf16 v[96:111], v[152:155], a[84:87], v[96:111]
    ds_read_b64_tr_b16 v[138:139], v30 offset:33792
    buffer_load_dwordx4 a[168:171], v32, s[72:75], s38 offen sc1
    v_mfma_f32_32x32x16_bf16 v[80:95], v[156:159], a[80:83], v[80:95]
    ds_read_b64_tr_b16 v[140:141], v31 offset:32768
    v_mfma_f32_32x32x16_bf16 v[112:127], v[156:159], a[84:87], v[112:127]
    ds_read_b64_tr_b16 v[142:143], v31 offset:33792
    buffer_load_dwordx4 a[172:175], v33, s[72:75], s38 offen sc1
    v_readlane_b32 s38, v5, 22
    s_waitcnt lgkmcnt(4)
    v_mfma_f32_32x32x16_bf16 v[64:79], v[168:171], a[88:91], v[64:79]
    ds_read_b64_tr_b16 v[152:153], v30 offset:40960
    v_mfma_f32_32x32x16_bf16 v[96:111], v[168:171], a[92:95], v[96:111]
    ds_read_b64_tr_b16 v[154:155], v30 offset:41984
    buffer_load_dwordx4 v28, s[76:79], s36 offen offset:0 lds
    v_mfma_f32_32x32x16_bf16 v[80:95], v[172:175], a[88:91], v[80:95]
    ds_read_b64_tr_b16 v[156:157], v31 offset:40960
    v_mfma_f32_32x32x16_bf16 v[112:127], v[172:175], a[92:95], v[112:127]
    ds_read_b64_tr_b16 v[158:159], v31 offset:41984
    s_waitcnt lgkmcnt(4)
    v_mfma_f32_32x32x16_bf16 v[64:79], v[136:139], a[96:99], v[64:79]
    s_waitcnt vmcnt(15)
    v_add_u32 v30, 0xffff8000, v30
    ds_read_b64_tr_b16 v[168:169], v30 offset:0
    buffer_load_dwordx4 v29, s[76:79], s36 offen offset:1024 lds
    v_readlane_b32 s36, v4, 23
    v_mfma_f32_32x32x16_bf16 v[96:111], v[136:139], a[100:103], v[96:111]
    ds_read_b64_tr_b16 v[170:171], v30 offset:1024
    v_mfma_f32_32x32x16_bf16 v[80:95], v[140:143], a[96:99], v[80:95]
    v_add_u32 v31, 0xffff8000, v31
    ds_read_b64_tr_b16 v[172:173], v31 offset:0
    buffer_load_dwordx4 a[176:179], v32, s[72:75], s38 offen sc1
    v_mfma_f32_32x32x16_bf16 v[112:127], v[140:143], a[100:103], v[112:127]
    ds_read_b64_tr_b16 v[174:175], v31 offset:1024
    s_waitcnt lgkmcnt(4)
    v_mfma_f32_32x32x16_bf16 v[64:79], v[152:155], a[104:107], v[64:79]
    s_waitcnt vmcnt(15)
    ds_read_b64_tr_b16 v[136:137], v30 offset:8192
    buffer_load_dwordx4 a[180:183], v33, s[72:75], s38 offen sc1
    v_readlane_b32 s38, v5, 23
    v_mfma_f32_32x32x16_bf16 v[96:111], v[152:155], a[108:111], v[96:111]
    ds_read_b64_tr_b16 v[138:139], v30 offset:9216
    s_add_u32 m0, s12, 106496
    v_mfma_f32_32x32x16_bf16 v[80:95], v[156:159], a[104:107], v[80:95]
    ds_read_b64_tr_b16 v[140:141], v31 offset:8192
    buffer_load_dwordx4 v28, s[76:79], s36 offen offset:0 lds
    v_mfma_f32_32x32x16_bf16 v[112:127], v[156:159], a[108:111], v[112:127]
    ds_read_b64_tr_b16 v[142:143], v31 offset:9216
    s_waitcnt lgkmcnt(4)
    v_mfma_f32_32x32x16_bf16 v[64:79], v[168:171], a[112:115], v[64:79]
    s_waitcnt vmcnt(15)
    ds_read_b64_tr_b16 v[152:153], v30 offset:16384
    buffer_load_dwordx4 v29, s[76:79], s36 offen offset:1024 lds
    v_readlane_b32 s36, v4, 24
    v_mfma_f32_32x32x16_bf16 v[96:111], v[168:171], a[116:119], v[96:111]
    ds_read_b64_tr_b16 v[154:155], v30 offset:17408
    v_mfma_f32_32x32x16_bf16 v[80:95], v[172:175], a[112:115], v[80:95]
    ds_read_b64_tr_b16 v[156:157], v31 offset:16384
    v_mfma_f32_32x32x16_bf16 v[112:127], v[172:175], a[116:119], v[112:127]
    ds_read_b64_tr_b16 v[158:159], v31 offset:17408
    buffer_load_dwordx4 a[184:187], v32, s[72:75], s38 offen sc1
    s_waitcnt lgkmcnt(4)
    v_mfma_f32_32x32x16_bf16 v[64:79], v[136:139], a[120:123], v[64:79]
    s_waitcnt vmcnt(15)
    ds_read_b64_tr_b16 v[168:169], v30 offset:24576
    v_mfma_f32_32x32x16_bf16 v[96:111], v[136:139], a[124:127], v[96:111]
    ds_read_b64_tr_b16 v[170:171], v30 offset:25600
    buffer_load_dwordx4 a[188:191], v33, s[72:75], s38 offen sc1
    v_readlane_b32 s38, v5, 24
    v_mfma_f32_32x32x16_bf16 v[80:95], v[140:143], a[120:123], v[80:95]
    ds_read_b64_tr_b16 v[172:173], v31 offset:24576
    s_add_u32 m0, s12, 114688
    v_mfma_f32_32x32x16_bf16 v[112:127], v[140:143], a[124:127], v[112:127]
    ds_read_b64_tr_b16 v[174:175], v31 offset:25600
    buffer_load_dwordx4 v28, s[76:79], s36 offen offset:0 lds
    s_waitcnt lgkmcnt(4)
    v_mfma_f32_32x32x16_bf16 v[64:79], v[152:155], a[128:131], v[64:79]
    s_waitcnt vmcnt(15)
    ds_read_b64_tr_b16 v[136:137], v30 offset:32768
    v_mfma_f32_32x32x16_bf16 v[96:111], v[152:155], a[132:135], v[96:111]
    ds_read_b64_tr_b16 v[138:139], v30 offset:33792
    buffer_load_dwordx4 v29, s[76:79], s36 offen offset:1024 lds
    v_readlane_b32 s36, v4, 25
    v_mfma_f32_32x32x16_bf16 v[80:95], v[156:159], a[128:131], v[80:95]
    ds_read_b64_tr_b16 v[140:141], v31 offset:32768
    v_mfma_f32_32x32x16_bf16 v[112:127], v[156:159], a[132:135], v[112:127]
    ds_read_b64_tr_b16 v[142:143], v31 offset:33792
    s_waitcnt lgkmcnt(4)
    v_mfma_f32_32x32x16_bf16 v[64:79], v[168:171], a[136:139], v[64:79]
    s_waitcnt vmcnt(14)
    ds_read_b64_tr_b16 v[152:153], v30 offset:40960
    buffer_load_dwordx4 a[192:195], v32, s[72:75], s38 offen sc1
    v_mfma_f32_32x32x16_bf16 v[96:111], v[168:171], a[140:143], v[96:111]
    ds_read_b64_tr_b16 v[154:155], v30 offset:41984
    v_mfma_f32_32x32x16_bf16 v[80:95], v[172:175], a[136:139], v[80:95]
    ds_read_b64_tr_b16 v[156:157], v31 offset:40960
    buffer_load_dwordx4 a[196:199], v33, s[72:75], s38 offen sc1
    v_readlane_b32 s38, v5, 25
    v_mfma_f32_32x32x16_bf16 v[112:127], v[172:175], a[140:143], v[112:127]
    ds_read_b64_tr_b16 v[158:159], v31 offset:41984
    s_add_u32 m0, s12, 122880
    s_waitcnt lgkmcnt(4)
    v_mfma_f32_32x32x16_bf16 v[64:79], v[136:139], a[144:147], v[64:79]
    s_waitcnt vmcnt(14)
    v_add_u32 v30, 0x10000, v30
    ds_read_b64_tr_b16 v[168:169], v30 offset:16384
    buffer_load_dwordx4 v28, s[76:79], s36 offen offset:0 lds
    v_mfma_f32_32x32x16_bf16 v[96:111], v[136:139], a[148:151], v[96:111]
    ds_read_b64_tr_b16 v[170:171], v30 offset:17408
    v_mfma_f32_32x32x16_bf16 v[80:95], v[140:143], a[144:147], v[80:95]
    v_add_u32 v31, 0x10000, v31
    ds_read_b64_tr_b16 v[172:173], v31 offset:16384
    buffer_load_dwordx4 v29, s[76:79], s36 offen offset:1024 lds
    v_readlane_b32 s36, v4, 26
    v_mfma_f32_32x32x16_bf16 v[112:127], v[140:143], a[148:151], v[112:127]
    ds_read_b64_tr_b16 v[174:175], v31 offset:17408
    s_waitcnt lgkmcnt(4)
    v_mfma_f32_32x32x16_bf16 v[64:79], v[152:155], a[152:155], v[64:79]
    s_waitcnt vmcnt(14)
    ds_read_b64_tr_b16 v[136:137], v30 offset:24576
    buffer_load_dwordx4 a[200:203], v32, s[72:75], s38 offen sc1
    v_mfma_f32_32x32x16_bf16 v[96:111], v[152:155], a[156:159], v[96:111]
    ds_read_b64_tr_b16 v[138:139], v30 offset:25600
    v_mfma_f32_32x32x16_bf16 v[80:95], v[156:159], a[152:155], v[80:95]
    ds_read_b64_tr_b16 v[140:141], v31 offset:24576
    v_mfma_f32_32x32x16_bf16 v[112:127], v[156:159], a[156:159], v[112:127]
    ds_read_b64_tr_b16 v[142:143], v31 offset:25600
    buffer_load_dwordx4 a[204:207], v33, s[72:75], s38 offen sc1
    v_readlane_b32 s38, v5, 26
    s_waitcnt lgkmcnt(4)
    v_mfma_f32_32x32x16_bf16 v[64:79], v[168:171], a[160:163], v[64:79]
    s_waitcnt vmcnt(12)
    ds_read_b64_tr_b16 v[152:153], v30 offset:32768
    s_add_u32 m0, s12, 131072
    v_mfma_f32_32x32x16_bf16 v[96:111], v[168:171], a[164:167], v[96:111]
    ds_read_b64_tr_b16 v[154:155], v30 offset:33792
    buffer_load_dwordx4 v28, s[76:79], s36 offen offset:0 lds
    v_mfma_f32_32x32x16_bf16 v[80:95], v[172:175], a[160:163], v[80:95]
    ds_read_b64_tr_b16 v[156:157], v31 offset:32768
    v_mfma_f32_32x32x16_bf16 v[112:127], v[172:175], a[164:167], v[112:127]
    ds_read_b64_tr_b16 v[158:159], v31 offset:33792
    buffer_load_dwordx4 v29, s[76:79], s36 offen offset:1024 lds
    v_readlane_b32 s36, v4, 27
    s_waitcnt lgkmcnt(4)
    v_mfma_f32_32x32x16_bf16 v[64:79], v[136:139], a[168:171], v[64:79]
    buffer_load_dwordx4 a[208:211], v32, s[72:75], s38 offen sc1
    buffer_load_dwordx4 a[212:215], v33, s[72:75], s38 offen sc1
    v_readlane_b32 s38, v5, 27
    s_add_u32 m0, s12, 139264
    s_nop 0
    buffer_load_dwordx4 v28, s[76:79], s36 offen offset:0 lds
    s_waitcnt vmcnt(13)
    ds_read_b64_tr_b16 v[168:169], v30 offset:40960
    v_mfma_f32_32x32x16_bf16 v[96:111], v[136:139], a[172:175], v[96:111]
    ds_read_b64_tr_b16 v[170:171], v30 offset:41984
    v_mfma_f32_32x32x16_bf16 v[80:95], v[140:143], a[168:171], v[80:95]
    ds_read_b64_tr_b16 v[172:173], v31 offset:40960
    buffer_load_dwordx4 v29, s[76:79], s36 offen offset:1024 lds
    v_readlane_b32 s36, v4, 28
    v_lshrrev_b32 v2, 5, v1
    v_mul_u32_u24 v2, s7, v2
    v_lshl_add_u32 v29, v2, 30, v29
    v_mfma_f32_32x32x16_bf16 v[112:127], v[140:143], a[172:175], v[112:127]
    ds_read_b64_tr_b16 v[174:175], v31 offset:41984
    s_barrier
    s_waitcnt lgkmcnt(4)
    v_mfma_f32_32x32x16_bf16 v[64:79], v[152:155], a[176:179], v[64:79]
    buffer_load_dwordx4 a[216:219], v32, s[72:75], s38 offen sc1
    buffer_load_dwordx4 a[220:223], v33, s[72:75], s38 offen sc1
    v_readlane_b32 s38, v5, 28
    s_add_u32 m0, s12, 147456
    s_nop 0
    buffer_load_dwordx4 v28, s[80:83], s36 offen offset:0 lds
    s_waitcnt vmcnt(13)
    ds_read_b64_tr_b16 v[136:137], v30 offset:49152
    v_mfma_f32_32x32x16_bf16 v[96:111], v[152:155], a[180:183], v[96:111]
    ds_read_b64_tr_b16 v[138:139], v30 offset:50176
    v_mfma_f32_32x32x16_bf16 v[80:95], v[156:159], a[176:179], v[80:95]
    ds_read_b64_tr_b16 v[140:141], v31 offset:49152
    buffer_load_dwordx4 v29, s[80:83], s36 offen offset:1024 lds
    v_readlane_b32 s36, v4, 29
    v_mfma_f32_32x32x16_bf16 v[112:127], v[156:159], a[180:183], v[112:127]
    ds_read_b64_tr_b16 v[142:143], v31 offset:50176
    s_add_u32 m0, s12, 155648
    s_waitcnt lgkmcnt(4)
    v_mfma_f32_32x32x16_bf16 v[64:79], v[168:171], a[184:187], v[64:79]
    buffer_load_dwordx4 v28, s[80:83], s36 offen offset:0 lds
    buffer_load_dwordx4 v29, s[80:83], s36 offen offset:1024 lds
    v_readlane_b32 s36, v4, 30
    s_add_u32 m0, s12, 49152
    s_nop 3
    buffer_load_dwordx4 v28, s[80:83], s36 offen offset:0 lds
    s_waitcnt vmcnt(13)
    ds_read_b64_tr_b16 v[152:153], v30 offset:57344
    v_mfma_f32_32x32x16_bf16 v[96:111], v[168:171], a[188:191], v[96:111]
    ds_read_b64_tr_b16 v[154:155], v30 offset:58368
    s_and_b32 s29, s23, 1
    s_lshl1_add_u32 s29, s29, s8
    s_lshl_b32 s29, s29, 8
    s_add_u32 s29, s29, s28
    s_add_u32 s29, s29, 512
    s_load_dword s9, s[72:73], s29
    s_add_u32 s29, s29, 128
    s_load_dword s10, s[72:73], s29
    v_mfma_f32_32x32x16_bf16 v[80:95], v[172:175], a[184:187], v[80:95]
    ds_read_b64_tr_b16 v[156:157], v31 offset:57344
    buffer_load_dwordx4 v29, s[80:83], s36 offen offset:1024 lds
    v_readlane_b32 s36, v4, 31
    v_mfma_f32_32x32x16_bf16 v[112:127], v[172:175], a[188:191], v[112:127]
    ds_read_b64_tr_b16 v[158:159], v31 offset:58368
    s_add_u32 m0, s12, 57344
    s_waitcnt lgkmcnt(4)
    v_mfma_f32_32x32x16_bf16 v[64:79], v[136:139], a[192:195], v[64:79]
    buffer_load_dwordx4 v28, s[80:83], s36 offen offset:0 lds
    buffer_load_dwordx4 v29, s[80:83], s36 offen offset:1024 lds
    v_readlane_b32 s36, v4, 32
    s_add_u32 m0, s12, 65536
    s_nop 3
    buffer_load_dwordx4 v28, s[80:83], s36 offen offset:0 lds
    s_waitcnt vmcnt(13)
    v_add_u32 v30, 0x10000, v30
    ds_read_b64_tr_b16 v[168:169], v30 offset:0
    v_mfma_f32_32x32x16_bf16 v[96:111], v[136:139], a[196:199], v[96:111]
    ds_read_b64_tr_b16 v[170:171], v30 offset:1024
    v_mfma_f32_32x32x16_bf16 v[80:95], v[140:143], a[192:195], v[80:95]
    v_add_u32 v31, 0x10000, v31
    ds_read_b64_tr_b16 v[172:173], v31 offset:0
    buffer_load_dwordx4 v29, s[80:83], s36 offen offset:1024 lds
    v_readlane_b32 s36, v4, 33
    v_mfma_f32_32x32x16_bf16 v[112:127], v[140:143], a[196:199], v[112:127]
    ds_read_b64_tr_b16 v[174:175], v31 offset:1024
    s_add_u32 m0, s12, 73728
    s_waitcnt lgkmcnt(4)
    v_mfma_f32_32x32x16_bf16 v[64:79], v[152:155], a[200:203], v[64:79]
    buffer_load_dwordx4 v28, s[80:83], s36 offen offset:0 lds
    buffer_load_dwordx4 v29, s[80:83], s36 offen offset:1024 lds
    v_readlane_b32 s36, v4, 34
    s_add_u32 m0, s12, 81920
    s_nop 3
    buffer_load_dwordx4 v28, s[80:83], s36 offen offset:0 lds
    s_waitcnt vmcnt(13)
    ds_read_b64_tr_b16 v[136:137], v30 offset:8192
    v_mfma_f32_32x32x16_bf16 v[96:111], v[152:155], a[204:207], v[96:111]
    ds_read_b64_tr_b16 v[138:139], v30 offset:9216
    v_mfma_f32_32x32x16_bf16 v[80:95], v[156:159], a[200:203], v[80:95]
    ds_read_b64_tr_b16 v[140:141], v31 offset:8192
    buffer_load_dwordx4 v29, s[80:83], s36 offen offset:1024 lds
    v_readlane_b32 s36, v4, 35
    v_mfma_f32_32x32x16_bf16 v[112:127], v[156:159], a[204:207], v[112:127]
    ds_read_b64_tr_b16 v[142:143], v31 offset:9216
    s_waitcnt lgkmcnt(0)
    s_min_u32 s9, s9, s10
    s_cmp_lt_u32 s9, 8
    s_cbranch_scc1 L_spin_11
L_back_12:
    v_mfma_f32_32x32x16_bf16 v[64:79], v[168:171], a[208:211], v[64:79]
    buffer_load_dwordx4 a[0:3], v32, s[72:75], s38 offen sc1
    buffer_load_dwordx4 a[4:7], v33, s[72:75], s38 offen sc1
    v_readlane_b32 s38, v5, 29
    s_nop 4
    buffer_load_dwordx4 a[8:11], v32, s[72:75], s38 offen sc1
    buffer_load_dwordx4 a[12:15], v33, s[72:75], s38 offen sc1
    v_readlane_b32 s38, v5, 30
    s_nop 4
    buffer_load_dwordx4 a[16:19], v32, s[72:75], s38 offen sc1
    buffer_load_dwordx4 a[20:23], v33, s[72:75], s38 offen sc1
    v_readlane_b32 s38, v5, 31
    s_nop 4
    buffer_load_dwordx4 a[24:27], v32, s[72:75], s38 offen sc1
    buffer_load_dwordx4 a[28:31], v33, s[72:75], s38 offen sc1
    v_readlane_b32 s38, v5, 32
    s_nop 4
    buffer_load_dwordx4 a[32:35], v32, s[72:75], s38 offen sc1
    buffer_load_dwordx4 a[36:39], v33, s[72:75], s38 offen sc1
    v_readlane_b32 s38, v5, 33
    s_nop 4
    buffer_load_dwordx4 a[40:43], v32, s[72:75], s38 offen sc1
    buffer_load_dwordx4 a[44:47], v33, s[72:75], s38 offen sc1
    v_readlane_b32 s38, v5, 34
    s_nop 4
    buffer_load_dwordx4 a[48:51], v32, s[72:75], s38 offen sc1
    buffer_load_dwordx4 a[52:55], v33, s[72:75], s38 offen sc1
    v_readlane_b32 s38, v5, 35
    s_add_u32 m0, s12, 90112
    s_nop 0
    buffer_load_dwordx4 v28, s[80:83], s36 offen offset:0 lds
    s_waitcnt vmcnt(13)
    ds_read_b64_tr_b16 v[152:153], v30 offset:16384
    v_mfma_f32_32x32x16_bf16 v[96:111], v[168:171], a[212:215], v[96:111]
    ds_read_b64_tr_b16 v[154:155], v30 offset:17408
    v_mfma_f32_32x32x16_bf16 v[80:95], v[172:175], a[208:211], v[80:95]
    ds_read_b64_tr_b16 v[156:157], v31 offset:16384
    buffer_load_dwordx4 v29, s[80:83], s36 offen offset:1024 lds
    v_mfma_f32_32x32x16_bf16 v[112:127], v[172:175], a[212:215], v[112:127]
    ds_read_b64_tr_b16 v[158:159], v31 offset:17408
    v_mfma_f32_32x32x16_bf16 v[64:79], v[136:139], a[216:219], v[64:79]
    s_waitcnt vmcnt(12)
    ds_read_b64_tr_b16 v[168:169], v30 offset:24576
    buffer_load_dwordx4 a[56:59], v32, s[72:75], s38 offen sc1
    v_mfma_f32_32x32x16_bf16 v[96:111], v[136:139], a[220:223], v[96:111]
    ds_read_b64_tr_b16 v[170:171], v30 offset:25600
    v_mfma_f32_32x32x16_bf16 v[80:95], v[140:143], a[216:219], v[80:95]
    ds_read_b64_tr_b16 v[172:173], v31 offset:24576
    v_mfma_f32_32x32x16_bf16 v[112:127], v[140:143], a[220:223], v[112:127]
    ds_read_b64_tr_b16 v[174:175], v31 offset:25600
    buffer_load_dwordx4 a[60:63], v33, s[72:75], s38 offen sc1
    s_waitcnt lgkmcnt(4)
    v_mfma_f32_32x32x16_bf16 v[64:79], v[152:155], a[0:3], v[64:79]
    s_waitcnt vmcnt(12)
    v_add_u32 v30, 0xfffe8000, v30
    ds_read_b64_tr_b16 v[136:137], v30 offset:16384
    v_mfma_f32_32x32x16_bf16 v[96:111], v[152:155], a[4:7], v[96:111]
    ds_read_b64_tr_b16 v[138:139], v30 offset:17408
    v_mfma_f32_32x32x16_bf16 v[80:95], v[156:159], a[0:3], v[80:95]
    v_add_u32 v31, 0xfffe8000, v31
    ds_read_b64_tr_b16 v[140:141], v31 offset:16384
    v_mfma_f32_32x32x16_bf16 v[112:127], v[156:159], a[4:7], v[112:127]
    ds_read_b64_tr_b16 v[142:143], v31 offset:17408
    s_waitcnt lgkmcnt(4)
    v_mfma_f32_32x32x16_bf16 v[64:79], v[168:171], a[8:11], v[64:79]
    s_waitcnt vmcnt(10)
    ds_read_b64_tr_b16 v[152:153], v30 offset:24576
    v_mfma_f32_32x32x16_bf16 v[96:111], v[168:171], a[12:15], v[96:111]
    ds_read_b64_tr_b16 v[154:155], v30 offset:25600
    v_mfma_f32_32x32x16_bf16 v[80:95], v[172:175], a[8:11], v[80:95]
    ds_read_b64_tr_b16 v[156:157], v31 offset:24576
    v_mfma_f32_32x32x16_bf16 v[112:127], v[172:175], a[12:15], v[112:127]
    ds_read_b64_tr_b16 v[158:159], v31 offset:25600
    s_waitcnt lgkmcnt(4)
    v_mfma_f32_32x32x16_bf16 v[64:79], v[136:139], a[16:19], v[64:79]
    s_xor_b32 s29, s4, 1
    s_mul_i32 s29, s29, 12288
    v_add_u32 v10, s29, v26
    s_xor_b32 s29, s4, 2
    s_mul_i32 s29, s29, 12288
    v_add_u32 v11, s29, v26
    s_waitcnt vmcnt(8)
    ds_read_b64_tr_b16 v[168:169], v30 offset:32768
    v_mfma_f32_32x32x16_bf16 v[96:111], v[136:139], a[20:23], v[96:111]
    ds_read_b64_tr_b16 v[170:171], v30 offset:33792
    s_xor_b32 s29, s4, 3
    s_mul_i32 s29, s29, 12288
    v_add_u32 v12, s29, v26
    v_mfma_f32_32x32x16_bf16 v[80:95], v[140:143], a[16:19], v[80:95]
    ds_read_b64_tr_b16 v[172:173], v31 offset:32768
    s_mul_i32 s29, s4, 12288
    v_add_u32 v13, s29, v26
    s_lshl1_add_u32 s33, s23, s8
    s_mul_i32 s33, s33, 28672
    v_mfma_f32_32x32x16_bf16 v[112:127], v[140:143], a[20:23], v[112:127]
    ds_read_b64_tr_b16 v[174:175], v31 offset:33792
    s_lshl1_add_u32 s29, s24, s7
    s_lshl_b32 s29, s29, 6
    s_add_u32 s33, s33, s29
    s_waitcnt lgkmcnt(4)
    v_mfma_f32_32x32x16_bf16 v[64:79], v[152:155], a[24:27], v[64:79]
    v_and_b32 v14, 31, v1
    v_mul_u32_u24 v14, 896, v14
    v_lshrrev_b32 v7, 5, v1
    v_lshl_add_u32 v14, v7, 4, v14
    v_add_f32 v8, 1.0, v8
    v_rcp_f32 v8, v8
    s_waitcnt vmcnt(6)
    ds_read_b64_tr_b16 v[136:137], v30 offset:40960
    v_mfma_f32_32x32x16_bf16 v[96:111], v[152:155], a[28:31], v[96:111]
    ds_read_b64_tr_b16 v[138:139], v30 offset:41984
    v_mfma_f32_32x32x16_bf16 v[80:95], v[156:159], a[24:27], v[80:95]
    ds_read_b64_tr_b16 v[140:141], v31 offset:40960
    v_mfma_f32_32x32x16_bf16 v[112:127], v[156:159], a[28:31], v[112:127]
    ds_read_b64_tr_b16 v[142:143], v31 offset:41984
    s_waitcnt lgkmcnt(4)
    v_mfma_f32_32x32x16_bf16 v[64:79], v[168:171], a[32:35], v[64:79]
    s_waitcnt vmcnt(4)
    ds_read_b64_tr_b16 v[152:153], v30 offset:49152
    v_mfma_f32_32x32x16_bf16 v[96:111], v[168:171], a[36:39], v[96:111]
    ds_read_b64_tr_b16 v[154:155], v30 offset:50176
    v_mfma_f32_32x32x16_bf16 v[80:95], v[172:175], a[32:35], v[80:95]
    ds_read_b64_tr_b16 v[156:157], v31 offset:49152
    v_mfma_f32_32x32x16_bf16 v[112:127], v[172:175], a[36:39], v[112:127]
    ds_read_b64_tr_b16 v[158:159], v31 offset:50176
    s_waitcnt lgkmcnt(4)
    v_mfma_f32_32x32x16_bf16 v[64:79], v[136:139], a[40:43], v[64:79]
    s_waitcnt vmcnt(0)
    ds_read_b64_tr_b16 v[168:169], v30 offset:57344
    v_mfma_f32_32x32x16_bf16 v[96:111], v[136:139], a[44:47], v[96:111]
    ds_read_b64_tr_b16 v[170:171], v30 offset:58368
    v_mfma_f32_32x32x16_bf16 v[80:95], v[140:143], a[40:43], v[80:95]
    ds_read_b64_tr_b16 v[172:173], v31 offset:57344
    v_mfma_f32_32x32x16_bf16 v[112:127], v[140:143], a[44:47], v[112:127]
    ds_read_b64_tr_b16 v[174:175], v31 offset:58368
    s_waitcnt lgkmcnt(4)
    v_mfma_f32_32x32x16_bf16 v[64:79], v[152:155], a[48:51], v[64:79]
    v_mfma_f32_32x32x16_bf16 v[96:111], v[152:155], a[52:55], v[96:111]
    v_mfma_f32_32x32x16_bf16 v[80:95], v[156:159], a[48:51], v[80:95]
    v_mfma_f32_32x32x16_bf16 v[112:127], v[156:159], a[52:55], v[112:127]
    s_waitcnt lgkmcnt(0)
    v_mfma_f32_32x32x16_bf16 v[112:127], v[172:175], a[60:63], v[112:127]
    v_mfma_f32_32x32x16_bf16 v[80:95], v[172:175], a[56:59], v[80:95]
    v_mfma_f32_32x32x16_bf16 v[96:111], v[168:171], a[60:63], v[96:111]
    v_mfma_f32_32x32x16_bf16 v[64:79], v[168:171], a[56:59], v[64:79]
    s_nop 8
    ds_write_b128 v12, v[112:115] offset:8192
    ds_write_b128 v12, v[116:119] offset:9216
    ds_write_b128 v12, v[120:123] offset:10240
    ds_write_b128 v12, v[124:127] offset:11264
    ds_write_b128 v10, v[80:83] offset:0
    ds_write_b128 v10, v[84:87] offset:1024
    ds_write_b128 v10, v[88:91] offset:2048
    ds_write_b128 v10, v[92:95] offset:3072
    ds_write_b128 v11, v[96:99] offset:4096
    ds_write_b128 v11, v[100:103] offset:5120
    ds_write_b128 v11, v[104:107] offset:6144
    ds_write_b128 v11, v[108:111] offset:7168
    s_waitcnt lgkmcnt(0)
    s_barrier
    ds_read_b128 v[176:179], v13 offset:0
    ds_read_b128 v[180:183], v13 offset:1024
    ds_read_b128 v[184:187], v13 offset:2048
    ds_read_b128 v[188:191], v13 offset:3072
    ds_read_b128 v[192:195], v13 offset:4096
    ds_read_b128 v[196:199], v13 offset:5120
    ds_read_b128 v[200:203], v13 offset:6144
    ds_read_b128 v[204:207], v13 offset:7168
    ds_read_b128 v[208:211], v13 offset:8192
    ds_read_b128 v[212:215], v13 offset:9216
    ds_read_b128 v[216:219], v13 offset:10240
    ds_read_b128 v[220:223], v13 offset:11264
    s_waitcnt lgkmcnt(8)
    v_pk_add_f32 v[64:65], v[64:65], v[176:177]
    v_pk_add_f32 v[66:67], v[66:67], v[178:179]
    v_pk_add_f32 v[68:69], v[68:69], v[180:181]
    v_pk_add_f32 v[70:71], v[70:71], v[182:183]
    v_pk_add_f32 v[72:73], v[72:73], v[184:185]
    v_pk_add_f32 v[74:75], v[74:75], v[186:187]
    v_pk_add_f32 v[76:77], v[76:77], v[188:189]
    v_pk_add_f32 v[78:79], v[78:79], v[190:191]
    s_waitcnt lgkmcnt(4)
    v_pk_add_f32 v[64:65], v[64:65], v[192:193]
    v_pk_add_f32 v[66:67], v[66:67], v[194:195]
    v_pk_add_f32 v[68:69], v[68:69], v[196:197]
    v_pk_add_f32 v[70:71], v[70:71], v[198:199]
    v_pk_add_f32 v[72:73], v[72:73], v[200:201]
    v_pk_add_f32 v[74:75], v[74:75], v[202:203]
    v_pk_add_f32 v[76:77], v[76:77], v[204:205]
    v_pk_add_f32 v[78:79], v[78:79], v[206:207]
    s_waitcnt lgkmcnt(0)
    v_pk_add_f32 v[64:65], v[64:65], v[208:209]
    v_pk_add_f32 v[66:67], v[66:67], v[210:211]
    v_pk_add_f32 v[68:69], v[68:69], v[212:213]
    v_pk_add_f32 v[70:71], v[70:71], v[214:215]
    v_pk_add_f32 v[72:73], v[72:73], v[216:217]
    v_pk_add_f32 v[74:75], v[74:75], v[218:219]
    v_pk_add_f32 v[76:77], v[76:77], v[220:221]
    v_pk_add_f32 v[78:79], v[78:79], v[222:223]
    v_pk_mul_f32 v[64:65], v[64:65], v[8:9] op_sel_hi:[1,0]
    v_pk_mul_f32 v[66:67], v[66:67], v[8:9] op_sel_hi:[1,0]
    v_pk_mul_f32 v[68:69], v[68:69], v[8:9] op_sel_hi:[1,0]
    v_pk_mul_f32 v[70:71], v[70:71], v[8:9] op_sel_hi:[1,0]
    v_pk_mul_f32 v[72:73], v[72:73], v[8:9] op_sel_hi:[1,0]
    v_pk_mul_f32 v[74:75], v[74:75], v[8:9] op_sel_hi:[1,0]
    v_pk_mul_f32 v[76:77], v[76:77], v[8:9] op_sel_hi:[1,0]
    v_pk_mul_f32 v[78:79], v[78:79], v[8:9] op_sel_hi:[1,0]
    v_cvt_pk_bf16_f32 v176, v64, v65
    v_cvt_pk_bf16_f32 v177, v66, v67
    v_cvt_pk_bf16_f32 v178, v68, v69
    v_cvt_pk_bf16_f32 v179, v70, v71
    v_cvt_pk_bf16_f32 v180, v72, v73
    v_cvt_pk_bf16_f32 v181, v74, v75
    v_cvt_pk_bf16_f32 v182, v76, v77
    v_cvt_pk_bf16_f32 v183, v78, v79
    s_nop 1
    v_permlane32_swap_b32 v176, v178
    v_permlane32_swap_b32 v177, v179
    v_permlane32_swap_b32 v180, v182
    v_permlane32_swap_b32 v181, v183
    buffer_store_dwordx4 v[176:179], v14, s[84:87], s33 offen offset:0
    buffer_store_dwordx4 v[180:183], v14, s[84:87], s33 offen offset:32
L_end:
    s_endpgm
L_typeB:
    s_cmp_eq_u32 s6, 15
    s_cbranch_scc1 L_typeB15
    s_add_u32 m0, s13, 0
    s_lshl1_add_u32 s15, s0, s9
    buffer_load_dwordx4 v8, s[56:59], s15 offen offset:0 lds
    buffer_load_dwordx4 v9, s[56:59], s15 offen offset:1024 lds
    buffer_load_dwordx4 v10, s[56:59], s15 offen offset:2048 lds
    buffer_load_dwordx4 v11, s[56:59], s15 offen offset:3072 lds
    v_and_b32 v6, 1, v4
    s_lshl_b32 s12, s4, 11
    s_mul_i32 s29, s4, 43008
    s_lshl_b32 s10, s6, 7
    s_cmp_eq_u32 s6, 15
    s_cselect_b32 s30, 384, 0
    s_add_u32 s10, s10, s30
    s_add_u32 s10, s10, s29
    v_lshlrev_b32 v7, 2, v6
    v_xor_b32 v7, v7, v3
    v_mul_u32_u24 v5, 2688, v2
    v_lshl_add_u32 v12, v7, 4, v5
    v_add_u32 v13, 20480, v12
    s_mov_b32 s60, s38
    s_and_b32 s61, s39, 0xffff
    s_mov_b32 s62, 1204224
    s_mov_b32 s63, 0x20000
    s_add_u32 s1, s0, 64
    s_cmp_eq_u32 s1, 448
    s_cselect_b32 s1, 0, s1
    s_add_u32 m0, s12, 16384
    s_mul_i32 s15, s0, 2688
    s_add_u32 s15, s15, s10
    buffer_load_dwordx4 v12, s[60:63], s15 offen offset:0 lds
    buffer_load_dwordx4 v13, s[60:63], s15 offen offset:1024 lds
    v_lshlrev_b32 v7, 1, v6
    v_xor_b32 v7, v7, v3
    v_mul_u32_u24 v5, 3584, v2
    v_lshl_add_u32 v14, v7, 4, v5
    v_add_u32 v15, 27648, v14
    v_lshlrev_b32 v7, 1, v6
    v_xor_b32 v7, v7, v3
    v_xor_b32 v7, 4, v7
    v_mul_u32_u24 v5, 3584, v2
    v_lshl_add_u32 v16, v7, 4, v5
    v_add_u32 v17, 27648, v16
    v_lshlrev_b32 v7, 2, v6
    v_xor_b32 v7, v7, v3
    v_mul_u32_u24 v5, 896, v2
    v_lshl_add_u32 v28, v7, 4, v5
    v_add_u32 v29, 6144, v28
    s_and_b32 s7, s4, 1
    s_lshr_b32 s8, s4, 1
    s_lshl_b32 s11, s6, 8
    s_mul_i32 s29, s4, 57344
    s_add_u32 s11, s11, s29
    s_mov_b32 s64, s44
    s_and_b32 s65, s45, 0xffff
    s_mov_b32 s66, 1605632
    s_mov_b32 s67, 0x20000
    s_mov_b32 s68, s46
    s_and_b32 s69, s47, 0xffff
    s_mov_b32 s70, 1605632
    s_mov_b32 s71, 0x20000
    s_mov_b32 s72, s96
    s_and_b32 s73, s97, 0xffff
    s_mov_b32 s74, 18874368
    s_mov_b32 s75, 0x20000
    s_mov_b32 s80, s40
    s_and_b32 s81, s41, 0xffff
    s_mov_b32 s82, 401408
    s_mov_b32 s83, 0x20000
    s_mov_b32 s76, s48
    s_and_b32 s77, s49, 0xffff
    s_mov_b32 s78, 1605632
    s_mov_b32 s79, 0x20000
    s_mov_b32 s84, s52
    s_and_b32 s85, s53, 0xffff
    s_mov_b32 s86, 1835008
    s_mov_b32 s87, 0x20000
    s_mov_b32 s88, s50
    s_and_b32 s89, s51, 0xffff
    s_mov_b32 s90, 896
    s_mov_b32 s91, 0x20000
    s_mov_b32 s92, s54
    s_and_b32 s93, s55, 0xffff
    s_mov_b32 s94, 256
    s_mov_b32 s95, 0x20000
    s_add_u32 s3, s1, 64
    s_cmp_eq_u32 s3, 448
    s_cselect_b32 s3, 0, s3
    s_add_u32 s96, s3, 64
    s_cmp_eq_u32 s96, 448
    s_cselect_b32 s96, 0, s96
    s_add_u32 s97, s96, 64
    s_cmp_eq_u32 s97, 448
    s_cselect_b32 s97, 0, s97
    s_add_u32 s40, s97, 64
    s_cmp_eq_u32 s40, 448
    s_cselect_b32 s40, 0, s40
    s_add_u32 s41, s40, 64
    s_cmp_eq_u32 s41, 448
    s_cselect_b32 s41, 0, s41
    s_add_u32 s37, s10, 256
    v_and_b32 v2, 31, v1
    v_lshrrev_b32 v3, 5, v1
    v_bfe_u32 v4, v1, 1, 3
    v_xor_b32 v4, v4, v3
    v_lshlrev_b32 v4, 4, v4
    v_lshlrev_b32 v5, 7, v2
    s_lshl_b32 s29, s7, 13
    v_add_u32 v5, s29, v5
    v_xor_b32 v6, 0, v4
    v_add_u32 v18, v5, v6
    v_xor_b32 v6, 32, v4
    v_add_u32 v19, v5, v6
    v_xor_b32 v6, 64, v4
    v_add_u32 v20, v5, v6
    v_xor_b32 v6, 96, v4
    v_add_u32 v21, v5, v6
    v_mul_u32_u24 v6, 7168, v3
    v_lshl_add_u32 v27, v2, 4, v6
    v_bfe_u32 v2, v1, 2, 2
    v_and_b32 v6, 3, v1
    v_bfe_u32 v4, v1, 4, 1
    v_lshl_add_u32 v5, v3, 3, v2
    v_lshlrev_b32 v5, 7, v5
    v_lshl_add_u32 v5, v6, 3, v5
    v_lshl_add_u32 v3, v3, 2, v2
    v_lshlrev_b32 v3, 7, v3
    v_lshl_add_u32 v3, v6, 3, v3
    v_lshrrev_b32 v6, 1, v2
    v_xor_b32 v7, s8, v6
    v_lshlrev_b32 v7, 6, v7
    v_lshl_add_u32 v7, v4, 5, v7
    v_add_u32 v22, v5, v7
    v_add_u32 v3, s12, v3
    v_xor_b32 v7, s7, v6
    v_lshlrev_b32 v7, 6, v7
    v_lshl_add_u32 v7, v4, 5, v7
    v_add_u32 v30, v3, v7
    v_xor_b32 v7, 64, v7
    v_add_u32 v31, v3, v7
    v_lshl_add_u32 v6, v4, 1, v6
    v_lshl_add_u32 v5, v4, 13, v5
    s_lshl_b32 s29, s8, 1
    v_xor_b32 v7, s29, v6
    v_lshl_add_u32 v23, v7, 5, v5
    v_xor_b32 v7, 1, v7
    v_lshl_add_u32 v24, v7, 5, v5
    v_lshlrev_b32 v25, 3, v1
    v_lshlrev_b32 v26, 4, v1
    s_lshl_b32 s29, s5, 11
    s_lshl_b32 s30, s2, 9
    s_add_u32 s30, s30, 65536
    s_cmp_eq_u32 s4, 0
    s_cselect_b32 s21, s29, s30
    s_add_u32 s21, s21, 17039360
    s_add_u32 m0, s12, 24576
    s_add_u32 s15, s15, 128
    buffer_load_dwordx4 v12, s[60:63], s15 offen offset:0 lds
    buffer_load_dwordx4 v13, s[60:63], s15 offen offset:1024 lds
    s_add_u32 m0, s13, 32768
    s_lshl1_add_u32 s15, s1, s9
    buffer_load_dwordx4 v8, s[56:59], s15 offen offset:0 lds
    buffer_load_dwordx4 v9, s[56:59], s15 offen offset:1024 lds
    buffer_load_dwordx4 v10, s[56:59], s15 offen offset:2048 lds
    buffer_load_dwordx4 v11, s[56:59], s15 offen offset:3072 lds
    s_add_u32 m0, s12, 49152
    s_mul_i32 s15, s1, 2688
    s_add_u32 s15, s15, s10
    buffer_load_dwordx4 v12, s[60:63], s15 offen offset:0 lds
    s_lshr_b32 s29, s2, 3
    s_min_u32 s29, s29, 27
    s_mul_i32 s30, s29, 37
    s_lshr_b32 s30, s30, 8
    s_mul_i32 s31, s30, 7
    s_sub_u32 s24, s29, s31
    s_and_b32 s29, s2, 7
    s_lshl_b32 s29, s29, 2
    s_add_u32 s23, s29, s30
    s_mul_i32 s25, s23, 294912
    s_lshl_b32 s29, s4, 10
    s_add_u32 s25, s25, s29
    s_add_u32 s25, s25, 6291456
    s_lshl_b32 s29, s24, 7
    s_mul_i32 s26, s4, 14336
    s_add_u32 s26, s26, s29
    s_mul_i32 s30, s8, 25088
    s_mul_i32 s31, s7, 14336
    s_add_u32 s27, s30, s31
    s_add_u32 s27, s27, s29
    s_lshr_b32 s28, s23, 1
    s_lshl_b32 s28, s28, 11
    s_add_u32 s28, s28, 17039360
    s_mul_i32 s29, s8, 147456
    v_add_u32 v32, s29, v26
    s_sub_u32 s29, 147456, s29
    v_add_u32 v33, s29, v26
    v_and_b32 v2, 31, v1
    v_lshrrev_b32 v3, 5, v1
    v_lshlrev_b32 v3, 2, v3
    v_sub_u32 v2, v2, v3
    v_mov_b32 v3, 0xf149f2ca
    v_cmp_le_i32 vcc, 0, v2
    v_cmp_le_i32 s[30:31], 1, v2
    s_nop 0
    v_cndmask_b32_e64 v224, v3, 0, vcc
    v_cndmask_b32 v240, 0, v3, vcc
    v_cndmask_b32_e64 v225, v3, 0, s[30:31]
    v_cndmask_b32_e64 v241, 0, v3, s[30:31]
    v_cmp_le_i32 vcc, 2, v2
    v_cmp_le_i32 s[30:31], 3, v2
    s_nop 0
    v_cndmask_b32_e64 v226, v3, 0, vcc
    v_cndmask_b32 v242, 0, v3, vcc
    v_cndmask_b32_e64 v227, v3, 0, s[30:31]
    v_cndmask_b32_e64 v243, 0, v3, s[30:31]
    v_cmp_le_i32 vcc, 8, v2
    v_cmp_le_i32 s[30:31], 9, v2
    s_nop 0
    v_cndmask_b32_e64 v228, v3, 0, vcc
    v_cndmask_b32 v244, 0, v3, vcc
    v_cndmask_b32_e64 v229, v3, 0, s[30:31]
    v_cndmask_b32_e64 v245, 0, v3, s[30:31]
    v_cmp_le_i32 vcc, 10, v2
    v_cmp_le_i32 s[30:31], 11, v2
    s_nop 0
    v_cndmask_b32_e64 v230, v3, 0, vcc
    v_cndmask_b32 v246, 0, v3, vcc
    v_cndmask_b32_e64 v231, v3, 0, s[30:31]
    v_cndmask_b32_e64 v247, 0, v3, s[30:31]
    v_cmp_le_i32 vcc, 16, v2
    v_cmp_le_i32 s[30:31], 17, v2
    s_nop 0
    v_cndmask_b32_e64 v232, v3, 0, vcc
    v_cndmask_b32 v248, 0, v3, vcc
    v_cndmask_b32_e64 v233, v3, 0, s[30:31]
    v_cndmask_b32_e64 v249, 0, v3, s[30:31]
    v_cmp_le_i32 vcc, 18, v2
    v_cmp_le_i32 s[30:31], 19, v2
    s_nop 0
    v_cndmask_b32_e64 v234, v3, 0, vcc
    v_cndmask_b32 v250, 0, v3, vcc
    v_cndmask_b32_e64 v235, v3, 0, s[30:31]
    v_cndmask_b32_e64 v251, 0, v3, s[30:31]
    v_cmp_le_i32 vcc, 24, v2
    v_cmp_le_i32 s[30:31], 25, v2
    s_nop 0
    v_cndmask_b32_e64 v236, v3, 0, vcc
    v_cndmask_b32 v252, 0, v3, vcc
    v_cndmask_b32_e64 v237, v3, 0, s[30:31]
    v_cndmask_b32_e64 v253, 0, v3, s[30:31]
    buffer_load_dwordx4 v13, s[60:63], s15 offen offset:1024 lds
    s_add_u32 m0, s12, 57344
    s_add_u32 s15, s15, 128
    v_cmp_le_i32 vcc, 26, v2
    v_cmp_le_i32 s[30:31], 27, v2
    s_nop 0
    v_cndmask_b32_e64 v238, v3, 0, vcc
    v_cndmask_b32 v254, 0, v3, vcc
    v_cndmask_b32_e64 v239, v3, 0, s[30:31]
    v_cndmask_b32_e64 v255, 0, v3, s[30:31]
    s_lshl_b32 s29, s5, 2
    s_lshl_b32 s30, s7, 1
    s_add_u32 s29, s29, s30
    s_mul_i32 s17, s29, 28672
    s_lshl_b32 s30, s8, 9
    s_add_u32 s17, s17, s30
    s_add_u32 s17, s17, 4194304
    s_add_u32 s18, s17, 14336
    s_add_u32 s19, s17, 28672
    s_add_u32 s20, s18, 28672
    s_lshl_b32 s16, s29, 7
    s_add_u32 s16, s16, 16777216
    s_and_b32 s29, s23, 3
    s_mul_i32 s30, s29, 7
    s_lshr_b32 s30, s30, 1
    s_lshl1_add_u32 s30, s24, s30
    s_lshl1_add_u32 s29, s29, s24
    v_add_u32 v2, s30, v1
    v_mul_u32_u24 v3, 4682, v2
    v_lshrrev_b32 v3, 16, v3
    v_mul_u32_u24 v3, 14, v3
    v_sub_u32 v2, v2, v3
    v_lshlrev_b32 v2, 1, v2
    v_cmp_lt_u32 vcc, 13, v1
    v_add_u32 v3, s29, v1
    v_add_u32 v3, 4, v3
    v_addc_co_u32 v2, vcc, 0, v2, vcc
    v_and_b32 v3, 7, v3
    v_cmp_lt_u32 vcc, 27, v1
    v_mul_u32_u24 v6, 57344, v2
    v_add_u32 v6, s26, v6
    v_mul_u32_u24 v7, 50176, v3
    v_add_u32 v7, s27, v7
    v_cndmask_b32 v4, v6, v7, vcc
    v_add_u32 v3, 28, v3
    v_cndmask_b32 v2, v2, v3, vcc
    v_lshlrev_b32 v2, 12, v2
    v_add_u32 v5, s25, v2
    v_readlane_b32 s36, v4, 0
    v_readlane_b32 s38, v5, 0
    s_cmp_ge_u32 s2, 224
    s_cselect_b32 s39, 0x40000000, 0
    v_add_u32 v28, s39, v28
    v_add_u32 v29, s39, v29
    v_add_u32 v32, s39, v32
    buffer_load_dwordx4 v12, s[60:63], s15 offen offset:0 lds
    v_add_u32 v33, s39, v33
    v_lshrrev_b32 v6, 5, v1
    v_lshlrev_b32 v6, 4, v6
    buffer_load_dwordx4 v13, s[60:63], s15 offen offset:1024 lds
    s_add_u32 m0, s13, 65536
    s_lshl1_add_u32 s15, s3, s9
    buffer_load_dwordx4 v8, s[56:59], s15 offen offset:0 lds
    buffer_load_dwordx4 v9, s[56:59], s15 offen offset:1024 lds
    buffer_load_dwordx4 v10, s[56:59], s15 offen offset:2048 lds
    buffer_load_dwordx4 v11, s[56:59], s15 offen offset:3072 lds
    s_add_u32 m0, s12, 81920
    s_mul_i32 s15, s3, 2688
    s_add_u32 s15, s15, s10
    buffer_load_dwordx4 v12, s[60:63], s15 offen offset:0 lds
    s_waitcnt vmcnt(13)
    s_barrier
    ds_read_b64_tr_b16 v[40:41], v22 offset:16384
    ds_read_b128 a[0:3], v18 offset:0
    ds_read_b64_tr_b16 v[42:43], v22 offset:16896
    ds_read_b128 a[112:115], v18 offset:4096
    ds_read_b64_tr_b16 v[44:45], v22 offset:24576
    ds_read_b64_tr_b16 v[46:47], v22 offset:25088
    ds_read_b64_tr_b16 v[48:49], v22 offset:18432
    ds_read_b128 a[4:7], v19 offset:0
    ds_read_b64_tr_b16 v[50:51], v22 offset:18944
    ds_read_b128 a[116:119], v19 offset:4096
    s_waitcnt lgkmcnt(6)
    v_mfma_f32_32x32x16_bf16 v[64:79], a[0:3], v[40:43], 0
    ds_read_b64_tr_b16 v[52:53], v22 offset:26624
    v_mfma_f32_32x32x16_bf16 v[80:95], a[112:115], v[40:43], 0
    ds_read_b64_tr_b16 v[54:55], v22 offset:27136
    buffer_load_dwordx4 v13, s[60:63], s15 offen offset:1024 lds
    s_waitcnt lgkmcnt(6)
    v_mfma_f32_32x32x16_bf16 v[96:111], a[0:3], v[44:47], 0
    ds_read_b64_tr_b16 v[40:41], v22 offset:20480
    ds_read_b128 a[8:11], v20 offset:0
    s_add_u32 m0, s12, 90112
    s_add_u32 s15, s15, 128
    v_mfma_f32_32x32x16_bf16 v[112:127], a[112:115], v[44:47], 0
    ds_read_b64_tr_b16 v[42:43], v22 offset:20992
    ds_read_b128 a[120:123], v20 offset:4096
    s_waitcnt lgkmcnt(6)
    v_mfma_f32_32x32x16_bf16 v[64:79], a[4:7], v[48:51], v[64:79]
    ds_read_b64_tr_b16 v[44:45], v22 offset:28672
    v_mfma_f32_32x32x16_bf16 v[80:95], a[116:119], v[48:51], v[80:95]
    ds_read_b64_tr_b16 v[46:47], v22 offset:29184
    s_waitcnt lgkmcnt(6)
    v_mfma_f32_32x32x16_bf16 v[96:111], a[4:7], v[52:55], v[96:111]
    ds_read_b64_tr_b16 v[48:49], v22 offset:22528
    ds_read_b128 a[12:15], v21 offset:0
    v_mfma_f32_32x32x16_bf16 v[112:127], a[116:119], v[52:55], v[112:127]
    ds_read_b64_tr_b16 v[50:51], v22 offset:23040
    ds_read_b128 a[124:127], v21 offset:4096
    s_waitcnt lgkmcnt(6)
    v_mfma_f32_32x32x16_bf16 v[64:79], a[8:11], v[40:43], v[64:79]
    ds_read_b64_tr_b16 v[52:53], v22 offset:30720
    buffer_load_dwordx4 v12, s[60:63], s15 offen offset:0 lds
    v_mfma_f32_32x32x16_bf16 v[80:95], a[120:123], v[40:43], v[80:95]
    ds_read_b64_tr_b16 v[54:55], v22 offset:31232
    s_waitcnt lgkmcnt(6)
    v_mfma_f32_32x32x16_bf16 v[96:111], a[8:11], v[44:47], v[96:111]
    buffer_load_dwordx4 v13, s[60:63], s15 offen offset:1024 lds
    s_add_u32 m0, s13, 98304
    s_lshl1_add_u32 s15, s96, s9
    buffer_load_dwordx4 v8, s[56:59], s15 offen offset:0 lds
    buffer_load_dwordx4 v9, s[56:59], s15 offen offset:1024 lds
    buffer_load_dwordx4 v10, s[56:59], s15 offen offset:2048 lds
    buffer_load_dwordx4 v11, s[56:59], s15 offen offset:3072 lds
    s_add_u32 m0, s12, 114688
    s_mul_i32 s15, s96, 2688
    s_add_u32 s15, s15, s10
    buffer_load_dwordx4 v12, s[60:63], s15 offen offset:0 lds
    s_waitcnt vmcnt(13)
    s_barrier
    ds_read_b64_tr_b16 v[40:41], v22 offset:49152
    ds_read_b128 a[16:19], v18 offset:32768
    v_mfma_f32_32x32x16_bf16 v[112:127], a[120:123], v[44:47], v[112:127]
    ds_read_b64_tr_b16 v[42:43], v22 offset:49664
    ds_read_b128 a[128:131], v18 offset:36864
    s_waitcnt lgkmcnt(6)
    v_mfma_f32_32x32x16_bf16 v[64:79], a[12:15], v[48:51], v[64:79]
    ds_read_b64_tr_b16 v[44:45], v22 offset:57344
    buffer_load_dwordx4 v13, s[60:63], s15 offen offset:1024 lds
    v_mfma_f32_32x32x16_bf16 v[80:95], a[124:127], v[48:51], v[80:95]
    ds_read_b64_tr_b16 v[46:47], v22 offset:57856
    s_add_u32 m0, s12, 122880
    s_add_u32 s15, s15, 128
    s_waitcnt lgkmcnt(6)
    v_mfma_f32_32x32x16_bf16 v[96:111], a[12:15], v[52:55], v[96:111]
    ds_read_b64_tr_b16 v[48:49], v22 offset:51200
    ds_read_b128 a[20:23], v19 offset:32768
    buffer_load_dwordx4 v12, s[60:63], s15 offen offset:0 lds
    v_mfma_f32_32x32x16_bf16 v[112:127], a[124:127], v[52:55], v[112:127]
    ds_read_b64_tr_b16 v[50:51], v22 offset:51712
    ds_read_b128 a[132:135], v19 offset:36864
    s_waitcnt lgkmcnt(6)
    v_mfma_f32_32x32x16_bf16 v[64:79], a[16:19], v[40:43], v[64:79]
    ds_read_b64_tr_b16 v[52:53], v22 offset:59392
    v_mfma_f32_32x32x16_bf16 v[80:95], a[128:131], v[40:43], v[80:95]
    ds_read_b64_tr_b16 v[54:55], v22 offset:59904
    buffer_load_dwordx4 v13, s[60:63], s15 offen offset:1024 lds
    s_waitcnt lgkmcnt(6)
    v_mfma_f32_32x32x16_bf16 v[96:111], a[16:19], v[44:47], v[96:111]
    ds_read_b64_tr_b16 v[40:41], v22 offset:53248
    ds_read_b128 a[24:27], v20 offset:32768
    v_mfma_f32_32x32x16_bf16 v[112:127], a[128:131], v[44:47], v[112:127]
    ds_read_b64_tr_b16 v[42:43], v22 offset:53760
    ds_read_b128 a[136:139], v20 offset:36864
    s_add_u32 m0, s13, 131072
    s_lshl1_add_u32 s15, s97, s9
    buffer_load_dwordx4 v8, s[56:59], s15 offen offset:0 lds
    s_waitcnt lgkmcnt(6)
    v_mfma_f32_32x32x16_bf16 v[64:79], a[20:23], v[48:51], v[64:79]
    ds_read_b64_tr_b16 v[44:45], v22 offset:61440
    v_mfma_f32_32x32x16_bf16 v[80:95], a[132:135], v[48:51], v[80:95]
    ds_read_b64_tr_b16 v[46:47], v22 offset:61952
    buffer_load_dwordx4 v9, s[56:59], s15 offen offset:1024 lds
    s_waitcnt lgkmcnt(6)
    v_mfma_f32_32x32x16_bf16 v[96:111], a[20:23], v[52:55], v[96:111]
    ds_read_b64_tr_b16 v[48:49], v22 offset:55296
    ds_read_b128 a[28:31], v21 offset:32768
    v_mfma_f32_32x32x16_bf16 v[112:127], a[132:135], v[52:55], v[112:127]
    ds_read_b64_tr_b16 v[50:51], v22 offset:55808
    ds_read_b128 a[140:143], v21 offset:36864
    buffer_load_dwordx4 v10, s[56:59], s15 offen offset:2048 lds
    s_waitcnt lgkmcnt(6)
    v_mfma_f32_32x32x16_bf16 v[64:79], a[24:27], v[40:43], v[64:79]
    ds_read_b64_tr_b16 v[52:53], v22 offset:63488
    v_mfma_f32_32x32x16_bf16 v[80:95], a[136:139], v[40:43], v[80:95]
    ds_read_b64_tr_b16 v[54:55], v22 offset:64000
    buffer_load_dwordx4 v11, s[56:59], s15 offen offset:3072 lds
    s_waitcnt lgkmcnt(6)
    v_mfma_f32_32x32x16_bf16 v[96:111], a[24:27], v[44:47], v[96:111]
    s_add_u32 m0, s12, 147456
    s_mul_i32 s15, s97, 2688
    s_add_u32 s15, s15, s10
    s_waitcnt vmcnt(12)
    s_barrier
    v_add_u32 v22, 0x10000, v22
    ds_read_b64_tr_b16 v[40:41], v22 offset:16384
    v_add_u32 v18, 0x10000, v18
    ds_read_b128 a[32:35], v18 offset:0
    buffer_load_dwordx4 v12, s[60:63], s15 offen offset:0 lds
    v_mfma_f32_32x32x16_bf16 v[112:127], a[136:139], v[44:47], v[112:127]
    ds_read_b64_tr_b16 v[42:43], v22 offset:16896
    ds_read_b128 a[144:147], v18 offset:4096
    s_waitcnt lgkmcnt(6)
    v_mfma_f32_32x32x16_bf16 v[64:79], a[28:31], v[48:51], v[64:79]
    ds_read_b64_tr_b16 v[44:45], v22 offset:24576
    buffer_load_dwordx4 v13, s[60:63], s15 offen offset:1024 lds
    v_mfma_f32_32x32x16_bf16 v[80:95], a[140:143], v[48:51], v[80:95]
    ds_read_b64_tr_b16 v[46:47], v22 offset:25088
    s_add_u32 m0, s12, 155648
    s_add_u32 s15, s15, 128
    s_waitcnt lgkmcnt(6)
    v_mfma_f32_32x32x16_bf16 v[96:111], a[28:31], v[52:55], v[96:111]
    ds_read_b64_tr_b16 v[48:49], v22 offset:18432
    v_add_u32 v19, 0x10000, v19
    ds_read_b128 a[36:39], v19 offset:0
    buffer_load_dwordx4 v12, s[60:63], s15 offen offset:0 lds
    v_mfma_f32_32x32x16_bf16 v[112:127], a[140:143], v[52:55], v[112:127]
    ds_read_b64_tr_b16 v[50:51], v22 offset:18944
    ds_read_b128 a[148:151], v19 offset:4096
    s_waitcnt lgkmcnt(6)
    v_mfma_f32_32x32x16_bf16 v[64:79], a[32:35], v[40:43], v[64:79]
    ds_read_b64_tr_b16 v[52:53], v22 offset:26624
    buffer_load_dwordx4 v13, s[60:63], s15 offen offset:1024 lds
    v_mfma_f32_32x32x16_bf16 v[80:95], a[144:147], v[40:43], v[80:95]
    ds_read_b64_tr_b16 v[54:55], v22 offset:27136
    s_waitcnt lgkmcnt(6)
    v_mfma_f32_32x32x16_bf16 v[96:111], a[32:35], v[44:47], v[96:111]
    ds_read_b64_tr_b16 v[40:41], v22 offset:20480
    v_add_u32 v20, 0x10000, v20
    ds_read_b128 a[40:43], v20 offset:0
    s_add_u32 m0, s13, 0
    s_lshl1_add_u32 s15, s40, s9
    buffer_load_dwordx4 v8, s[56:59], s15 offen offset:0 lds
    v_mfma_f32_32x32x16_bf16 v[112:127], a[144:147], v[44:47], v[112:127]
    ds_read_b64_tr_b16 v[42:43], v22 offset:20992
    ds_read_b128 a[152:155], v20 offset:4096
    s_waitcnt lgkmcnt(6)
    v_mfma_f32_32x32x16_bf16 v[64:79], a[36:39], v[48:51], v[64:79]
    ds_read_b64_tr_b16 v[44:45], v22 offset:28672
    v_mfma_f32_32x32x16_bf16 v[80:95], a[148:151], v[48:51], v[80:95]
    ds_read_b64_tr_b16 v[46:47], v22 offset:29184
    buffer_load_dwordx4 v9, s[56:59], s15 offen offset:1024 lds
    s_waitcnt lgkmcnt(6)
    v_mfma_f32_32x32x16_bf16 v[96:111], a[36:39], v[52:55], v[96:111]
    ds_read_b64_tr_b16 v[48:49], v22 offset:22528
    v_add_u32 v21, 0x10000, v21
    ds_read_b128 a[44:47], v21 offset:0
    v_mfma_f32_32x32x16_bf16 v[112:127], a[148:151], v[52:55], v[112:127]
    ds_read_b64_tr_b16 v[50:51], v22 offset:23040
    ds_read_b128 a[156:159], v21 offset:4096
    buffer_load_dwordx4 v10, s[56:59], s15 offen offset:2048 lds
    s_waitcnt lgkmcnt(6)
    v_mfma_f32_32x32x16_bf16 v[64:79], a[40:43], v[40:43], v[64:79]
    ds_read_b64_tr_b16 v[52:53], v22 offset:30720
    v_mfma_f32_32x32x16_bf16 v[80:95], a[152:155], v[40:43], v[80:95]
    ds_read_b64_tr_b16 v[54:55], v22 offset:31232
    buffer_load_dwordx4 v11, s[56:59], s15 offen offset:3072 lds
    s_waitcnt lgkmcnt(6)
    v_mfma_f32_32x32x16_bf16 v[96:111], a[40:43], v[44:47], v[96:111]
    s_waitcnt vmcnt(12)
    s_barrier
    ds_read_b64_tr_b16 v[40:41], v22 offset:49152
    ds_read_b128 a[48:51], v18 offset:32768
    s_add_u32 m0, s12, 16384
    s_mul_i32 s15, s40, 2688
    s_add_u32 s15, s15, s10
    v_mfma_f32_32x32x16_bf16 v[112:127], a[152:155], v[44:47], v[112:127]
    ds_read_b64_tr_b16 v[42:43], v22 offset:49664
    ds_read_b128 a[160:163], v18 offset:36864
    buffer_load_dwordx4 v12, s[60:63], s15 offen offset:0 lds
    s_waitcnt lgkmcnt(6)
    v_mfma_f32_32x32x16_bf16 v[64:79], a[44:47], v[48:51], v[64:79]
    ds_read_b64_tr_b16 v[44:45], v22 offset:57344
    buffer_load_dwordx4 v13, s[60:63], s15 offen offset:1024 lds
    v_mfma_f32_32x32x16_bf16 v[80:95], a[156:159], v[48:51], v[80:95]
    ds_read_b64_tr_b16 v[46:47], v22 offset:57856
    s_add_u32 m0, s12, 24576
    s_add_u32 s15, s15, 128
    s_waitcnt lgkmcnt(6)
    v_mfma_f32_32x32x16_bf16 v[96:111], a[44:47], v[52:55], v[96:111]
    ds_read_b64_tr_b16 v[48:49], v22 offset:51200
    ds_read_b128 a[52:55], v19 offset:32768
    buffer_load_dwordx4 v12, s[60:63], s15 offen offset:0 lds
    v_mfma_f32_32x32x16_bf16 v[112:127], a[156:159], v[52:55], v[112:127]
    ds_read_b64_tr_b16 v[50:51], v22 offset:51712
    ds_read_b128 a[164:167], v19 offset:36864
    s_waitcnt lgkmcnt(6)
    v_mfma_f32_32x32x16_bf16 v[64:79], a[48:51], v[40:43], v[64:79]
    ds_read_b64_tr_b16 v[52:53], v22 offset:59392
    buffer_load_dwordx4 v13, s[60:63], s15 offen offset:1024 lds
    v_mfma_f32_32x32x16_bf16 v[80:95], a[160:163], v[40:43], v[80:95]
    ds_read_b64_tr_b16 v[54:55], v22 offset:59904
    s_waitcnt lgkmcnt(6)
    v_mfma_f32_32x32x16_bf16 v[96:111], a[48:51], v[44:47], v[96:111]
    ds_read_b64_tr_b16 v[40:41], v22 offset:53248
    ds_read_b128 a[56:59], v20 offset:32768
    s_add_u32 m0, s13, 32768
    s_lshl1_add_u32 s15, s41, s9
    buffer_load_dwordx4 v8, s[56:59], s15 offen offset:0 lds
    v_mfma_f32_32x32x16_bf16 v[112:127], a[160:163], v[44:47], v[112:127]
    ds_read_b64_tr_b16 v[42:43], v22 offset:53760
    ds_read_b128 a[168:171], v20 offset:36864
    s_waitcnt lgkmcnt(6)
    v_mfma_f32_32x32x16_bf16 v[64:79], a[52:55], v[48:51], v[64:79]
    ds_read_b64_tr_b16 v[44:45], v22 offset:61440
    v_mfma_f32_32x32x16_bf16 v[80:95], a[164:167], v[48:51], v[80:95]
    ds_read_b64_tr_b16 v[46:47], v22 offset:61952
    buffer_load_dwordx4 v9, s[56:59], s15 offen offset:1024 lds
    s_waitcnt lgkmcnt(6)
    v_mfma_f32_32x32x16_bf16 v[96:111], a[52:55], v[52:55], v[96:111]
    ds_read_b64_tr_b16 v[48:49], v22 offset:55296
    ds_read_b128 a[60:63], v21 offset:32768
    v_mfma_f32_32x32x16_bf16 v[112:127], a[164:167], v[52:55], v[112:127]
    ds_read_b64_tr_b16 v[50:51], v22 offset:55808
    ds_read_b128 a[172:175], v21 offset:36864
    buffer_load_dwordx4 v10, s[56:59], s15 offen offset:2048 lds
    s_waitcnt lgkmcnt(6)
    v_mfma_f32_32x32x16_bf16 v[64:79], a[56:59], v[40:43], v[64:79]
    ds_read_b64_tr_b16 v[52:53], v22 offset:63488
    v_mfma_f32_32x32x16_bf16 v[80:95], a[168:171], v[40:43], v[80:95]
    ds_read_b64_tr_b16 v[54:55], v22 offset:64000
    buffer_load_dwordx4 v11, s[56:59], s15 offen offset:3072 lds
    s_waitcnt lgkmcnt(6)
    v_mfma_f32_32x32x16_bf16 v[96:111], a[56:59], v[44:47], v[96:111]
    s_waitcnt vmcnt(12)
    s_barrier
    v_add_u32 v22, 0x10000, v22
    ds_read_b64_tr_b16 v[40:41], v22 offset:16384
    v_add_u32 v18, 0x10000, v18
    ds_read_b128 a[64:67], v18 offset:0
    s_add_u32 m0, s12, 49152
    s_mul_i32 s15, s41, 2688
    s_add_u32 s15, s15, s10
    v_mfma_f32_32x32x16_bf16 v[112:127], a[168:171], v[44:47], v[112:127]
    ds_read_b64_tr_b16 v[42:43], v22 offset:16896
    ds_read_b128 a[176:179], v18 offset:4096
    buffer_load_dwordx4 v12, s[60:63], s15 offen offset:0 lds
    s_waitcnt lgkmcnt(6)
    v_mfma_f32_32x32x16_bf16 v[64:79], a[60:63], v[48:51], v[64:79]
    ds_read_b64_tr_b16 v[44:45], v22 offset:24576
    buffer_load_dwordx4 v13, s[60:63], s15 offen offset:1024 lds
    v_mfma_f32_32x32x16_bf16 v[80:95], a[172:175], v[48:51], v[80:95]
    ds_read_b64_tr_b16 v[46:47], v22 offset:25088
    s_add_u32 m0, s12, 57344
    s_add_u32 s15, s15, 128
    s_waitcnt lgkmcnt(6)
    v_mfma_f32_32x32x16_bf16 v[96:111], a[60:63], v[52:55], v[96:111]
    ds_read_b64_tr_b16 v[48:49], v22 offset:18432
    v_add_u32 v19, 0x10000, v19
    ds_read_b128 a[68:71], v19 offset:0
    buffer_load_dwordx4 v12, s[60:63], s15 offen offset:0 lds
    v_mfma_f32_32x32x16_bf16 v[112:127], a[172:175], v[52:55], v[112:127]
    ds_read_b64_tr_b16 v[50:51], v22 offset:18944
    ds_read_b128 a[180:183], v19 offset:4096
    s_waitcnt lgkmcnt(6)
    v_mfma_f32_32x32x16_bf16 v[64:79], a[64:67], v[40:43], v[64:79]
    ds_read_b64_tr_b16 v[52:53], v22 offset:26624
    buffer_load_dwordx4 v13, s[60:63], s15 offen offset:1024 lds
    v_mfma_f32_32x32x16_bf16 v[80:95], a[176:179], v[40:43], v[80:95]
    ds_read_b64_tr_b16 v[54:55], v22 offset:27136
    s_add_u32 m0, s12, 65536
    s_mul_i32 s15, s0, 2688
    s_add_u32 s15, s15, s37
    s_waitcnt lgkmcnt(6)
    v_mfma_f32_32x32x16_bf16 v[96:111], a[64:67], v[44:47], v[96:111]
    ds_read_b64_tr_b16 v[40:41], v22 offset:20480
    v_add_u32 v20, 0x10000, v20
    ds_read_b128 a[72:75], v20 offset:0
    buffer_load_dwordx4 v12, s[60:63], s15 offen offset:0 lds
    v_mfma_f32_32x32x16_bf16 v[112:127], a[176:179], v[44:47], v[112:127]
    ds_read_b64_tr_b16 v[42:43], v22 offset:20992
    ds_read_b128 a[184:187], v20 offset:4096
    s_waitcnt lgkmcnt(6)
    v_mfma_f32_32x32x16_bf16 v[64:79], a[68:71], v[48:51], v[64:79]
    ds_read_b64_tr_b16 v[44:45], v22 offset:28672
    v_mfma_f32_32x32x16_bf16 v[80:95], a[180:183], v[48:51], v[80:95]
    ds_read_b64_tr_b16 v[46:47], v22 offset:29184
    buffer_load_dwordx4 v13, s[60:63], s15 offen offset:1024 lds
    s_waitcnt lgkmcnt(6)
    v_mfma_f32_32x32x16_bf16 v[96:111], a[68:71], v[52:55], v[96:111]
    ds_read_b64_tr_b16 v[48:49], v22 offset:22528
    v_add_u32 v21, 0x10000, v21
    ds_read_b128 a[76:79], v21 offset:0
    s_add_u32 m0, s12, 73728
    s_add_u32 s15, s15, 128
    v_mfma_f32_32x32x16_bf16 v[112:127], a[180:183], v[52:55], v[112:127]
    ds_read_b64_tr_b16 v[50:51], v22 offset:23040
    ds_read_b128 a[188:191], v21 offset:4096
    buffer_load_dwordx4 v12, s[60:63], s15 offen offset:0 lds
    s_waitcnt lgkmcnt(6)
    v_mfma_f32_32x32x16_bf16 v[64:79], a[72:75], v[40:43], v[64:79]
    ds_read_b64_tr_b16 v[52:53], v22 offset:30720
    v_mfma_f32_32x32x16_bf16 v[80:95], a[184:187], v[40:43], v[80:95]
    ds_read_b64_tr_b16 v[54:55], v22 offset:31232
    buffer_load_dwordx4 v13, s[60:63], s15 offen offset:1024 lds
    s_waitcnt lgkmcnt(6)
    v_mfma_f32_32x32x16_bf16 v[96:111], a[72:75], v[44:47], v[96:111]
    s_waitcnt vmcnt(12)
    s_barrier
    v_add_u32 v22, 0xfffe0000, v22
    ds_read_b64_tr_b16 v[40:41], v22 offset:16384
    v_add_u32 v18, 0xfffe0000, v18
    ds_read_b128 a[80:83], v18 offset:0
    v_mfma_f32_32x32x16_bf16 v[112:127], a[184:187], v[44:47], v[112:127]
    ds_read_b64_tr_b16 v[42:43], v22 offset:16896
    ds_read_b128 a[192:195], v18 offset:4096
    s_waitcnt lgkmcnt(6)
    v_mfma_f32_32x32x16_bf16 v[64:79], a[76:79], v[48:51], v[64:79]
    ds_read_b64_tr_b16 v[44:45], v22 offset:24576
    v_mfma_f32_32x32x16_bf16 v[80:95], a[188:191], v[48:51], v[80:95]
    ds_read_b64_tr_b16 v[46:47], v22 offset:25088
    s_waitcnt lgkmcnt(6)
    v_mfma_f32_32x32x16_bf16 v[96:111], a[76:79], v[52:55], v[96:111]
    ds_read_b64_tr_b16 v[48:49], v22 offset:18432
    v_add_u32 v19, 0xfffe0000, v19
    ds_read_b128 a[84:87], v19 offset:0
    v_mfma_f32_32x32x16_bf16 v[112:127], a[188:191], v[52:55], v[112:127]
    ds_read_b64_tr_b16 v[50:51], v22 offset:18944
    ds_read_b128 a[196:199], v19 offset:4096
    s_waitcnt lgkmcnt(6)
    v_mfma_f32_32x32x16_bf16 v[64:79], a[80:83], v[40:43], v[64:79]
    ds_read_b64_tr_b16 v[52:53], v22 offset:26624
    v_mfma_f32_32x32x16_bf16 v[80:95], a[192:195], v[40:43], v[80:95]
    ds_read_b64_tr_b16 v[54:55], v22 offset:27136
    s_waitcnt lgkmcnt(6)
    v_mfma_f32_32x32x16_bf16 v[96:111], a[80:83], v[44:47], v[96:111]
    ds_read_b64_tr_b16 v[40:41], v22 offset:20480
    v_add_u32 v20, 0xfffe0000, v20
    ds_read_b128 a[88:91], v20 offset:0
    v_mfma_f32_32x32x16_bf16 v[112:127], a[192:195], v[44:47], v[112:127]
    ds_read_b64_tr_b16 v[42:43], v22 offset:20992
    ds_read_b128 a[200:203], v20 offset:4096
    s_waitcnt lgkmcnt(6)
    v_mfma_f32_32x32x16_bf16 v[64:79], a[84:87], v[48:51], v[64:79]
    ds_read_b64_tr_b16 v[44:45], v22 offset:28672
    v_mfma_f32_32x32x16_bf16 v[80:95], a[196:199], v[48:51], v[80:95]
    ds_read_b64_tr_b16 v[46:47], v22 offset:29184
    s_waitcnt lgkmcnt(6)
    v_mfma_f32_32x32x16_bf16 v[96:111], a[84:87], v[52:55], v[96:111]
    ds_read_b64_tr_b16 v[48:49], v22 offset:22528
    v_add_u32 v21, 0xfffe0000, v21
    ds_read_b128 a[92:95], v21 offset:0
    v_mfma_f32_32x32x16_bf16 v[112:127], a[196:199], v[52:55], v[112:127]
    ds_read_b64_tr_b16 v[50:51], v22 offset:23040
    ds_read_b128 a[204:207], v21 offset:4096
    s_waitcnt lgkmcnt(6)
    v_mfma_f32_32x32x16_bf16 v[64:79], a[88:91], v[40:43], v[64:79]
    ds_read_b64_tr_b16 v[52:53], v22 offset:30720
    v_mfma_f32_32x32x16_bf16 v[80:95], a[200:203], v[40:43], v[80:95]
    ds_read_b64_tr_b16 v[54:55], v22 offset:31232
    s_waitcnt lgkmcnt(6)
    v_mfma_f32_32x32x16_bf16 v[96:111], a[88:91], v[44:47], v[96:111]
    s_waitcnt vmcnt(4)
    s_barrier
    ds_read_b64_tr_b16 v[40:41], v22 offset:49152
    ds_read_b128 a[96:99], v18 offset:32768
    s_add_u32 m0, s12, 131072
    s_mul_i32 s15, s1, 2688
    s_add_u32 s15, s15, s37
    v_mfma_f32_32x32x16_bf16 v[112:127], a[200:203], v[44:47], v[112:127]
    ds_read_b64_tr_b16 v[42:43], v22 offset:49664
    ds_read_b128 a[208:211], v18 offset:36864
    buffer_load_dwordx4 v12, s[60:63], s15 offen offset:0 lds
    s_waitcnt lgkmcnt(6)
    v_mfma_f32_32x32x16_bf16 v[64:79], a[92:95], v[48:51], v[64:79]
    ds_read_b64_tr_b16 v[44:45], v22 offset:57344
    buffer_load_dwordx4 v13, s[60:63], s15 offen offset:1024 lds
    v_mfma_f32_32x32x16_bf16 v[80:95], a[204:207], v[48:51], v[80:95]
    ds_read_b64_tr_b16 v[46:47], v22 offset:57856
    s_add_u32 m0, s12, 139264
    s_add_u32 s15, s15, 128
    s_waitcnt lgkmcnt(6)
    v_mfma_f32_32x32x16_bf16 v[96:111], a[92:95], v[52:55], v[96:111]
    ds_read_b64_tr_b16 v[48:49], v22 offset:51200
    ds_read_b128 a[100:103], v19 offset:32768
    buffer_load_dwordx4 v12, s[60:63], s15 offen offset:0 lds
    v_mfma_f32_32x32x16_bf16 v[112:127], a[204:207], v[52:55], v[112:127]
    ds_read_b64_tr_b16 v[50:51], v22 offset:51712
    ds_read_b128 a[212:215], v19 offset:36864
    buffer_load_dwordx4 v13, s[60:63], s15 offen offset:1024 lds
    s_waitcnt lgkmcnt(6)
    v_mfma_f32_32x32x16_bf16 v[64:79], a[96:99], v[40:43], v[64:79]
    ds_read_b64_tr_b16 v[52:53], v22 offset:59392
    s_add_u32 m0, s12, 147456
    s_mul_i32 s15, s3, 2688
    s_add_u32 s15, s15, s37
    v_mfma_f32_32x32x16_bf16 v[80:95], a[208:211], v[40:43], v[80:95]
    ds_read_b64_tr_b16 v[54:55], v22 offset:59904
    buffer_load_dwordx4 v12, s[60:63], s15 offen offset:0 lds
    s_waitcnt lgkmcnt(6)
    v_mfma_f32_32x32x16_bf16 v[96:111], a[96:99], v[44:47], v[96:111]
    ds_read_b64_tr_b16 v[40:41], v22 offset:53248
    ds_read_b128 a[104:107], v20 offset:32768
    buffer_load_dwordx4 v13, s[60:63], s15 offen offset:1024 lds
    v_mfma_f32_32x32x16_bf16 v[112:127], a[208:211], v[44:47], v[112:127]
    ds_read_b64_tr_b16 v[42:43], v22 offset:53760
    ds_read_b128 a[216:219], v20 offset:36864
    s_add_u32 m0, s12, 155648
    s_add_u32 s15, s15, 128
    s_waitcnt lgkmcnt(6)
    v_mfma_f32_32x32x16_bf16 v[64:79], a[100:103], v[48:51], v[64:79]
    ds_read_b64_tr_b16 v[44:45], v22 offset:61440
    buffer_load_dwordx4 v12, s[60:63], s15 offen offset:0 lds
    v_mfma_f32_32x32x16_bf16 v[80:95], a[212:215], v[48:51], v[80:95]
    ds_read_b64_tr_b16 v[46:47], v22 offset:61952
    buffer_load_dwordx4 v13, s[60:63], s15 offen offset:1024 lds
    s_waitcnt lgkmcnt(6)
    v_mfma_f32_32x32x16_bf16 v[96:111], a[100:103], v[52:55], v[96:111]
    ds_read_b64_tr_b16 v[48:49], v22 offset:55296
    ds_read_b128 a[108:111], v21 offset:32768
    v_mfma_f32_32x32x16_bf16 v[112:127], a[212:215], v[52:55], v[112:127]
    ds_read_b64_tr_b16 v[50:51], v22 offset:55808
    ds_read_b128 a[220:223], v21 offset:36864
    s_waitcnt lgkmcnt(6)
    v_mfma_f32_32x32x16_bf16 v[64:79], a[104:107], v[40:43], v[64:79]
    ds_read_b64_tr_b16 v[52:53], v22 offset:63488
    v_mfma_f32_32x32x16_bf16 v[80:95], a[216:219], v[40:43], v[80:95]
    ds_read_b64_tr_b16 v[54:55], v22 offset:64000
    s_waitcnt lgkmcnt(6)
    v_mfma_f32_32x32x16_bf16 v[96:111], a[104:107], v[44:47], v[96:111]
    s_waitcnt vmcnt(8)
    s_barrier
    v_add_u32 v22, 0x10000, v22
    ds_read_b64_tr_b16 v[40:41], v22 offset:0
    s_add_u32 m0, s12, 0
    s_mul_i32 s15, s96, 2688
    s_add_u32 s15, s15, s37
    v_mfma_f32_32x32x16_bf16 v[112:127], a[216:219], v[44:47], v[112:127]
    ds_read_b64_tr_b16 v[42:43], v22 offset:512
    buffer_load_dwordx4 v12, s[60:63], s15 offen offset:0 lds
    s_waitcnt lgkmcnt(4)
    v_mfma_f32_32x32x16_bf16 v[64:79], a[108:111], v[48:51], v[64:79]
    ds_read_b64_tr_b16 v[44:45], v22 offset:8192
    buffer_load_dwordx4 v13, s[60:63], s15 offen offset:1024 lds
    v_mfma_f32_32x32x16_bf16 v[80:95], a[220:223], v[48:51], v[80:95]
    ds_read_b64_tr_b16 v[46:47], v22 offset:8704
    s_add_u32 m0, s12, 8192
    s_add_u32 s15, s15, 128
    s_waitcnt lgkmcnt(4)
    v_mfma_f32_32x32x16_bf16 v[96:111], a[108:111], v[52:55], v[96:111]
    ds_read_b64_tr_b16 v[48:49], v22 offset:2048
    buffer_load_dwordx4 v12, s[60:63], s15 offen offset:0 lds
    v_mfma_f32_32x32x16_bf16 v[112:127], a[220:223], v[52:55], v[112:127]
    ds_read_b64_tr_b16 v[50:51], v22 offset:2560
    buffer_load_dwordx4 v13, s[60:63], s15 offen offset:1024 lds
    s_waitcnt lgkmcnt(4)
    v_mfma_f32_32x32x16_bf16 v[160:175], a[0:3], v[40:43], 0
    ds_read_b64_tr_b16 v[52:53], v22 offset:10240
    s_add_u32 m0, s12, 16384
    s_mul_i32 s15, s97, 2688
    s_add_u32 s15, s15, s37
    v_mfma_f32_32x32x16_bf16 v[176:191], a[112:115], v[40:43], 0
    ds_read_b64_tr_b16 v[54:55], v22 offset:10752
    buffer_load_dwordx4 v12, s[60:63], s15 offen offset:0 lds
    s_waitcnt lgkmcnt(4)
    v_mfma_f32_32x32x16_bf16 v[192:207], a[0:3], v[44:47], 0
    ds_read_b64_tr_b16 v[40:41], v22 offset:4096
    buffer_load_dwordx4 v13, s[60:63], s15 offen offset:1024 lds
    v_mfma_f32_32x32x16_bf16 v[208:223], a[112:115], v[44:47], 0
    ds_read_b64_tr_b16 v[42:43], v22 offset:4608
    s_add_u32 m0, s12, 24576
    s_add_u32 s15, s15, 128
    s_waitcnt lgkmcnt(4)
    v_mfma_f32_32x32x16_bf16 v[160:175], a[4:7], v[48:51], v[160:175]
    ds_read_b64_tr_b16 v[44:45], v22 offset:12288
    buffer_load_dwordx4 v12, s[60:63], s15 offen offset:0 lds
    v_mfma_f32_32x32x16_bf16 v[176:191], a[116:119], v[48:51], v[176:191]
    ds_read_b64_tr_b16 v[46:47], v22 offset:12800
    buffer_load_dwordx4 v13, s[60:63], s15 offen offset:1024 lds
    s_waitcnt lgkmcnt(4)
    v_mfma_f32_32x32x16_bf16 v[192:207], a[4:7], v[52:55], v[192:207]
    ds_read_b64_tr_b16 v[48:49], v22 offset:6144
    v_mfma_f32_32x32x16_bf16 v[208:223], a[116:119], v[52:55], v[208:223]
    ds_read_b64_tr_b16 v[50:51], v22 offset:6656
    s_waitcnt lgkmcnt(4)
    v_mfma_f32_32x32x16_bf16 v[160:175], a[8:11], v[40:43], v[160:175]
    ds_read_b64_tr_b16 v[52:53], v22 offset:14336
    v_mfma_f32_32x32x16_bf16 v[176:191], a[120:123], v[40:43], v[176:191]
    ds_read_b64_tr_b16 v[54:55], v22 offset:14848
    s_waitcnt lgkmcnt(4)
    v_mfma_f32_32x32x16_bf16 v[192:207], a[8:11], v[44:47], v[192:207]
    s_waitcnt vmcnt(12)
    s_barrier
    v_add_u32 v22, 0x10000, v22
    ds_read_b64_tr_b16 v[40:41], v22 offset:0
    s_add_u32 m0, s12, 32768
    s_mul_i32 s15, s40, 2688
    s_add_u32 s15, s15, s37
    v_mfma_f32_32x32x16_bf16 v[208:223], a[120:123], v[44:47], v[208:223]
    ds_read_b64_tr_b16 v[42:43], v22 offset:512
    buffer_load_dwordx4 v12, s[60:63], s15 offen offset:0 lds
    s_waitcnt lgkmcnt(4)
    v_mfma_f32_32x32x16_bf16 v[160:175], a[12:15], v[48:51], v[160:175]
    ds_read_b64_tr_b16 v[44:45], v22 offset:8192
    buffer_load_dwordx4 v13, s[60:63], s15 offen offset:1024 lds
    v_mfma_f32_32x32x16_bf16 v[176:191], a[124:127], v[48:51], v[176:191]
    ds_read_b64_tr_b16 v[46:47], v22 offset:8704
    s_add_u32 m0, s12, 40960
    s_add_u32 s15, s15, 128
    s_waitcnt lgkmcnt(4)
    v_mfma_f32_32x32x16_bf16 v[192:207], a[12:15], v[52:55], v[192:207]
    ds_read_b64_tr_b16 v[48:49], v22 offset:2048
    buffer_load_dwordx4 v12, s[60:63], s15 offen offset:0 lds
    v_mfma_f32_32x32x16_bf16 v[208:223], a[124:127], v[52:55], v[208:223]
    ds_read_b64_tr_b16 v[50:51], v22 offset:2560
    buffer_load_dwordx4 v13, s[60:63], s15 offen offset:1024 lds
    s_waitcnt lgkmcnt(4)
    v_mfma_f32_32x32x16_bf16 v[160:175], a[16:19], v[40:43], v[160:175]
    ds_read_b64_tr_b16 v[52:53], v22 offset:10240
    s_add_u32 m0, s12, 49152
    s_mul_i32 s15, s41, 2688
    s_add_u32 s15, s15, s37
    v_mfma_f32_32x32x16_bf16 v[176:191], a[128:131], v[40:43], v[176:191]
    ds_read_b64_tr_b16 v[54:55], v22 offset:10752
    buffer_load_dwordx4 v12, s[60:63], s15 offen offset:0 lds
    s_waitcnt lgkmcnt(4)
    v_mfma_f32_32x32x16_bf16 v[192:207], a[16:19], v[44:47], v[192:207]
    ds_read_b64_tr_b16 v[40:41], v22 offset:4096
    buffer_load_dwordx4 v13, s[60:63], s15 offen offset:1024 lds
    v_mfma_f32_32x32x16_bf16 v[208:223], a[128:131], v[44:47], v[208:223]
    ds_read_b64_tr_b16 v[42:43], v22 offset:4608
    s_add_u32 m0, s12, 57344
    s_add_u32 s15, s15, 128
    s_waitcnt lgkmcnt(4)
    v_mfma_f32_32x32x16_bf16 v[160:175], a[20:23], v[48:51], v[160:175]
    ds_read_b64_tr_b16 v[44:45], v22 offset:12288
    buffer_load_dwordx4 v12, s[60:63], s15 offen offset:0 lds
    v_mfma_f32_32x32x16_bf16 v[176:191], a[132:135], v[48:51], v[176:191]
    ds_read_b64_tr_b16 v[46:47], v22 offset:12800
    s_waitcnt lgkmcnt(4)
    v_mfma_f32_32x32x16_bf16 v[192:207], a[20:23], v[52:55], v[192:207]
    ds_read_b64_tr_b16 v[48:49], v22 offset:6144
    buffer_load_dwordx4 v13, s[60:63], s15 offen offset:1024 lds
    v_mfma_f32_32x32x16_bf16 v[208:223], a[132:135], v[52:55], v[208:223]
    ds_read_b64_tr_b16 v[50:51], v22 offset:6656
    s_load_dword s9, s[92:93], 0
    s_waitcnt lgkmcnt(4)
    v_mfma_f32_32x32x16_bf16 v[160:175], a[24:27], v[40:43], v[160:175]
    ds_read_b64_tr_b16 v[52:53], v22 offset:14336
    s_add_u32 m0, s12, 81920
    v_mfma_f32_32x32x16_bf16 v[176:191], a[136:139], v[40:43], v[176:191]
    ds_read_b64_tr_b16 v[54:55], v22 offset:14848
    s_waitcnt lgkmcnt(4)
    v_mfma_f32_32x32x16_bf16 v[192:207], a[24:27], v[44:47], v[192:207]
    s_waitcnt vmcnt(16)
    s_barrier
    ds_read_b64_tr_b16 v[40:41], v22 offset:16384
    v_mfma_f32_32x32x16_bf16 v[208:223], a[136:139], v[44:47], v[208:223]
    ds_read_b64_tr_b16 v[42:43], v22 offset:16896
    s_waitcnt lgkmcnt(4)
    v_mfma_f32_32x32x16_bf16 v[160:175], a[28:31], v[48:51], v[160:175]
    ds_read_b64_tr_b16 v[44:45], v22 offset:24576
    v_mfma_f32_32x32x16_bf16 v[176:191], a[140:143], v[48:51], v[176:191]
    ds_read_b64_tr_b16 v[46:47], v22 offset:25088
    s_waitcnt lgkmcnt(4)
    v_mfma_f32_32x32x16_bf16 v[192:207], a[28:31], v[52:55], v[192:207]
    ds_read_b64_tr_b16 v[48:49], v22 offset:18432
    v_mfma_f32_32x32x16_bf16 v[208:223], a[140:143], v[52:55], v[208:223]
    ds_read_b64_tr_b16 v[50:51], v22 offset:18944
    s_waitcnt lgkmcnt(4)
    v_mfma_f32_32x32x16_bf16 v[160:175], a[32:35], v[40:43], v[160:175]
    ds_read_b64_tr_b16 v[52:53], v22 offset:26624
    v_mfma_f32_32x32x16_bf16 v[176:191], a[144:147], v[40:43], v[176:191]
    ds_read_b64_tr_b16 v[54:55], v22 offset:27136
    buffer_load_dwordx4 v28, s[76:79], s36 offen offset:0 lds
    s_waitcnt lgkmcnt(4)
    v_mfma_f32_32x32x16_bf16 v[192:207], a[32:35], v[44:47], v[192:207]
    ds_read_b64_tr_b16 v[40:41], v22 offset:20480
    v_mfma_f32_32x32x16_bf16 v[208:223], a[144:147], v[44:47], v[208:223]
    ds_read_b64_tr_b16 v[42:43], v22 offset:20992
    buffer_load_dwordx4 v29, s[76:79], s36 offen offset:1024 lds
    v_readlane_b32 s36, v4, 1
    s_waitcnt lgkmcnt(4)
    v_mfma_f32_32x32x16_bf16 v[160:175], a[36:39], v[48:51], v[160:175]
    ds_read_b64_tr_b16 v[44:45], v22 offset:28672
    s_add_u32 m0, s12, 90112
    v_mfma_f32_32x32x16_bf16 v[176:191], a[148:151], v[48:51], v[176:191]
    ds_read_b64_tr_b16 v[46:47], v22 offset:29184
    s_waitcnt lgkmcnt(4)
    v_mfma_f32_32x32x16_bf16 v[192:207], a[36:39], v[52:55], v[192:207]
    ds_read_b64_tr_b16 v[48:49], v22 offset:22528
    buffer_load_dwordx4 v28, s[76:79], s36 offen offset:0 lds
    v_mfma_f32_32x32x16_bf16 v[208:223], a[148:151], v[52:55], v[208:223]
    ds_read_b64_tr_b16 v[50:51], v22 offset:23040
    s_waitcnt lgkmcnt(4)
    v_mfma_f32_32x32x16_bf16 v[160:175], a[40:43], v[40:43], v[160:175]
    ds_read_b64_tr_b16 v[52:53], v22 offset:30720
    buffer_load_dwordx4 v29, s[76:79], s36 offen offset:1024 lds
    v_readlane_b32 s36, v4, 2
    v_mfma_f32_32x32x16_bf16 v[176:191], a[152:155], v[40:43], v[176:191]
    ds_read_b64_tr_b16 v[54:55], v22 offset:31232
    s_add_u32 m0, s12, 98304
    s_waitcnt lgkmcnt(4)
    v_mfma_f32_32x32x16_bf16 v[192:207], a[40:43], v[44:47], v[192:207]
    s_waitcnt vmcnt(16)
    s_barrier
    v_add_u32 v22, 0xfffe0000, v22
    ds_read_b64_tr_b16 v[40:41], v22 offset:0
    buffer_load_dwordx4 v28, s[76:79], s36 offen offset:0 lds
    v_mfma_f32_32x32x16_bf16 v[208:223], a[152:155], v[44:47], v[208:223]
    ds_read_b64_tr_b16 v[42:43], v22 offset:512
    s_waitcnt lgkmcnt(4)
    v_mfma_f32_32x32x16_bf16 v[160:175], a[44:47], v[48:51], v[160:175]
    ds_read_b64_tr_b16 v[44:45], v22 offset:8192
    buffer_load_dwordx4 v29, s[76:79], s36 offen offset:1024 lds
    v_readlane_b32 s36, v4, 3
    v_cvt_pk_bf16_f32 v64, v64, v65
    v_cvt_pk_bf16_f32 v65, v66, v67
    v_mfma_f32_32x32x16_bf16 v[176:191], a[156:159], v[48:51], v[176:191]
    ds_read_b64_tr_b16 v[46:47], v22 offset:8704
    s_add_u32 m0, s12, 106496
    v_cvt_pk_bf16_f32 v66, v68, v69
    v_cvt_pk_bf16_f32 v67, v70, v71
    s_waitcnt lgkmcnt(4)
    v_mfma_f32_32x32x16_bf16 v[192:207], a[44:47], v[52:55], v[192:207]
    ds_read_b64_tr_b16 v[48:49], v22 offset:2048
    buffer_load_dwordx4 v28, s[76:79], s36 offen offset:0 lds
    v_cvt_pk_bf16_f32 v68, v72, v73
    v_cvt_pk_bf16_f32 v69, v74, v75
    v_cvt_pk_bf16_f32 v70, v76, v77
    v_mfma_f32_32x32x16_bf16 v[208:223], a[156:159], v[52:55], v[208:223]
    ds_read_b64_tr_b16 v[50:51], v22 offset:2560
    v_cvt_pk_bf16_f32 v71, v78, v79
    buffer_store_dwordx4 v[64:67], v27, s[72:75], s17 offen offset:0 sc1
    buffer_store_dwordx4 v[68:71], v27, s[72:75], s18 offen offset:0 sc1
    s_waitcnt lgkmcnt(4)
    v_mfma_f32_32x32x16_bf16 v[160:175], a[48:51], v[40:43], v[160:175]
    ds_read_b64_tr_b16 v[52:53], v22 offset:10240
    v_cvt_pk_bf16_f32 v80, v80, v81
    v_cvt_pk_bf16_f32 v81, v82, v83
    v_cvt_pk_bf16_f32 v82, v84, v85
    v_cvt_pk_bf16_f32 v83, v86, v87
    v_mfma_f32_32x32x16_bf16 v[176:191], a[160:163], v[40:43], v[176:191]
    ds_read_b64_tr_b16 v[54:55], v22 offset:10752
    s_waitcnt lgkmcnt(0)
    s_cmp_lt_u32 s9, 16
    s_cbranch_scc1 L_spin_13
L_back_14:
    v_mfma_f32_32x32x16_bf16 v[192:207], a[48:51], v[44:47], v[192:207]
    ds_read_b64_tr_b16 v[40:41], v22 offset:4096
    v_cvt_pk_bf16_f32 v84, v88, v89
    v_cvt_pk_bf16_f32 v85, v90, v91
    v_cvt_pk_bf16_f32 v86, v92, v93
    v_cvt_pk_bf16_f32 v87, v94, v95
    v_mfma_f32_32x32x16_bf16 v[208:223], a[160:163], v[44:47], v[208:223]
    ds_read_b64_tr_b16 v[42:43], v22 offset:4608
    buffer_store_dwordx4 v[80:83], v27, s[72:75], s19 offen offset:0 sc1
    buffer_store_dwordx4 v[84:87], v27, s[72:75], s20 offen offset:0 sc1
    v_cvt_pk_bf16_f32 v96, v96, v97
    v_mfma_f32_32x32x16_bf16 v[160:175], a[52:55], v[48:51], v[160:175]
    ds_read_b64_tr_b16 v[44:45], v22 offset:12288
    v_cvt_pk_bf16_f32 v97, v98, v99
    v_cvt_pk_bf16_f32 v98, v100, v101
    v_cvt_pk_bf16_f32 v99, v102, v103
    v_cvt_pk_bf16_f32 v100, v104, v105
    v_mfma_f32_32x32x16_bf16 v[176:191], a[164:167], v[48:51], v[176:191]
    ds_read_b64_tr_b16 v[46:47], v22 offset:12800
    v_cvt_pk_bf16_f32 v101, v106, v107
    v_cvt_pk_bf16_f32 v102, v108, v109
    v_cvt_pk_bf16_f32 v103, v110, v111
    v_mfma_f32_32x32x16_bf16 v[192:207], a[52:55], v[52:55], v[192:207]
    ds_read_b64_tr_b16 v[48:49], v22 offset:6144
    buffer_store_dwordx4 v[96:99], v27, s[72:75], s17 offen offset:1024 sc1
    buffer_store_dwordx4 v[100:103], v27, s[72:75], s18 offen offset:1024 sc1
    v_cvt_pk_bf16_f32 v112, v112, v113
    v_cvt_pk_bf16_f32 v113, v114, v115
    v_mfma_f32_32x32x16_bf16 v[208:223], a[164:167], v[52:55], v[208:223]
    ds_read_b64_tr_b16 v[50:51], v22 offset:6656
    v_cvt_pk_bf16_f32 v114, v116, v117
    v_cvt_pk_bf16_f32 v115, v118, v119
    v_cvt_pk_bf16_f32 v116, v120, v121
    s_waitcnt lgkmcnt(4)
    v_mfma_f32_32x32x16_bf16 v[160:175], a[56:59], v[40:43], v[160:175]
    ds_read_b64_tr_b16 v[52:53], v22 offset:14336
    v_cvt_pk_bf16_f32 v117, v122, v123
    v_cvt_pk_bf16_f32 v118, v124, v125
    v_cvt_pk_bf16_f32 v119, v126, v127
    buffer_store_dwordx4 v[112:115], v27, s[72:75], s19 offen offset:1024 sc1
    v_mfma_f32_32x32x16_bf16 v[176:191], a[168:171], v[40:43], v[176:191]
    ds_read_b64_tr_b16 v[54:55], v22 offset:14848
    buffer_store_dwordx4 v[116:119], v27, s[72:75], s20 offen offset:1024 sc1
    s_waitcnt lgkmcnt(4)
    v_mfma_f32_32x32x16_bf16 v[192:207], a[56:59], v[44:47], v[192:207]
    s_waitcnt vmcnt(23)
    s_barrier
    ds_read_b64_tr_b16 v[40:41], v22 offset:16384
    v_mfma_f32_32x32x16_bf16 v[208:223], a[168:171], v[44:47], v[208:223]
    ds_read_b64_tr_b16 v[42:43], v22 offset:16896
    s_waitcnt lgkmcnt(4)
    v_mfma_f32_32x32x16_bf16 v[160:175], a[60:63], v[48:51], v[160:175]
    ds_read_b64_tr_b16 v[44:45], v22 offset:24576
    v_mfma_f32_32x32x16_bf16 v[176:191], a[172:175], v[48:51], v[176:191]
    ds_read_b64_tr_b16 v[46:47], v22 offset:25088
    s_waitcnt lgkmcnt(4)
    v_mfma_f32_32x32x16_bf16 v[192:207], a[60:63], v[52:55], v[192:207]
    ds_read_b64_tr_b16 v[48:49], v22 offset:18432
    v_mfma_f32_32x32x16_bf16 v[208:223], a[172:175], v[52:55], v[208:223]
    ds_read_b64_tr_b16 v[50:51], v22 offset:18944
    s_waitcnt lgkmcnt(4)
    v_mfma_f32_32x32x16_bf16 v[160:175], a[64:67], v[40:43], v[160:175]
    ds_read_b64_tr_b16 v[52:53], v22 offset:26624
    v_mfma_f32_32x32x16_bf16 v[176:191], a[176:179], v[40:43], v[176:191]
    ds_read_b64_tr_b16 v[54:55], v22 offset:27136
    s_waitcnt lgkmcnt(4)
    v_mfma_f32_32x32x16_bf16 v[192:207], a[64:67], v[44:47], v[192:207]
    ds_read_b64_tr_b16 v[40:41], v22 offset:20480
    v_mfma_f32_32x32x16_bf16 v[208:223], a[176:179], v[44:47], v[208:223]
    ds_read_b64_tr_b16 v[42:43], v22 offset:20992
    s_waitcnt lgkmcnt(4)
    v_mfma_f32_32x32x16_bf16 v[160:175], a[68:71], v[48:51], v[160:175]
    ds_read_b64_tr_b16 v[44:45], v22 offset:28672
    v_mfma_f32_32x32x16_bf16 v[176:191], a[180:183], v[48:51], v[176:191]
    ds_read_b64_tr_b16 v[46:47], v22 offset:29184
    s_waitcnt lgkmcnt(4)
    v_mfma_f32_32x32x16_bf16 v[192:207], a[68:71], v[52:55], v[192:207]
    ds_read_b64_tr_b16 v[48:49], v22 offset:22528
    v_mfma_f32_32x32x16_bf16 v[208:223], a[180:183], v[52:55], v[208:223]
    ds_read_b64_tr_b16 v[50:51], v22 offset:23040
    s_waitcnt lgkmcnt(4)
    v_mfma_f32_32x32x16_bf16 v[160:175], a[72:75], v[40:43], v[160:175]
    ds_read_b64_tr_b16 v[52:53], v22 offset:30720
    v_mfma_f32_32x32x16_bf16 v[176:191], a[184:187], v[40:43], v[176:191]
    ds_read_b64_tr_b16 v[54:55], v22 offset:31232
    s_waitcnt lgkmcnt(4)
    v_mfma_f32_32x32x16_bf16 v[192:207], a[72:75], v[44:47], v[192:207]
    s_waitcnt vmcnt(19)
    s_barrier
    ds_read_b64_tr_b16 v[40:41], v22 offset:32768
    v_mfma_f32_32x32x16_bf16 v[208:223], a[184:187], v[44:47], v[208:223]
    ds_read_b64_tr_b16 v[42:43], v22 offset:33280
    s_waitcnt lgkmcnt(4)
    v_mfma_f32_32x32x16_bf16 v[160:175], a[76:79], v[48:51], v[160:175]
    ds_read_b64_tr_b16 v[44:45], v22 offset:40960
    v_mfma_f32_32x32x16_bf16 v[176:191], a[188:191], v[48:51], v[176:191]
    ds_read_b64_tr_b16 v[46:47], v22 offset:41472
    s_waitcnt lgkmcnt(4)
    v_mfma_f32_32x32x16_bf16 v[192:207], a[76:79], v[52:55], v[192:207]
    ds_read_b64_tr_b16 v[48:49], v22 offset:34816
    v_mfma_f32_32x32x16_bf16 v[208:223], a[188:191], v[52:55], v[208:223]
    ds_read_b64_tr_b16 v[50:51], v22 offset:35328
    s_waitcnt lgkmcnt(4)
    v_mfma_f32_32x32x16_bf16 v[160:175], a[80:83], v[40:43], v[160:175]
    ds_read_b64_tr_b16 v[52:53], v22 offset:43008
    v_mfma_f32_32x32x16_bf16 v[176:191], a[192:195], v[40:43], v[176:191]
    ds_read_b64_tr_b16 v[54:55], v22 offset:43520
    s_waitcnt lgkmcnt(4)
    v_mfma_f32_32x32x16_bf16 v[192:207], a[80:83], v[44:47], v[192:207]
    ds_read_b64_tr_b16 v[40:41], v22 offset:36864
    buffer_load_dwordx4 v29, s[76:79], s36 offen offset:1024 lds
    v_readlane_b32 s36, v4, 4
    v_mfma_f32_32x32x16_bf16 v[208:223], a[192:195], v[44:47], v[208:223]
    ds_read_b64_tr_b16 v[42:43], v22 offset:37376
    s_waitcnt lgkmcnt(4)
    v_mfma_f32_32x32x16_bf16 v[160:175], a[84:87], v[48:51], v[160:175]
    ds_read_b64_tr_b16 v[44:45], v22 offset:45056
    v_mfma_f32_32x32x16_bf16 v[176:191], a[196:199], v[48:51], v[176:191]
    ds_read_b64_tr_b16 v[46:47], v22 offset:45568
    s_waitcnt lgkmcnt(4)
    v_mfma_f32_32x32x16_bf16 v[192:207], a[84:87], v[52:55], v[192:207]
    ds_read_b64_tr_b16 v[48:49], v22 offset:38912
    v_mfma_f32_32x32x16_bf16 v[208:223], a[196:199], v[52:55], v[208:223]
    ds_read_b64_tr_b16 v[50:51], v22 offset:39424
    s_waitcnt lgkmcnt(4)
    v_mfma_f32_32x32x16_bf16 v[160:175], a[88:91], v[40:43], v[160:175]
    ds_read_b64_tr_b16 v[52:53], v22 offset:47104
    v_mfma_f32_32x32x16_bf16 v[176:191], a[200:203], v[40:43], v[176:191]
    ds_read_b64_tr_b16 v[54:55], v22 offset:47616
    s_waitcnt lgkmcnt(4)
    v_mfma_f32_32x32x16_bf16 v[192:207], a[88:91], v[44:47], v[192:207]
    s_waitcnt vmcnt(16)
    s_barrier
    ds_read_b64_tr_b16 v[40:41], v22 offset:49152
    v_mfma_f32_32x32x16_bf16 v[208:223], a[200:203], v[44:47], v[208:223]
    ds_read_b64_tr_b16 v[42:43], v22 offset:49664
    s_waitcnt lgkmcnt(4)
    v_mfma_f32_32x32x16_bf16 v[160:175], a[92:95], v[48:51], v[160:175]
    ds_read_b64_tr_b16 v[44:45], v22 offset:57344
    v_mfma_f32_32x32x16_bf16 v[176:191], a[204:207], v[48:51], v[176:191]
    ds_read_b64_tr_b16 v[46:47], v22 offset:57856
    s_waitcnt lgkmcnt(4)
    v_mfma_f32_32x32x16_bf16 v[192:207], a[92:95], v[52:55], v[192:207]
    ds_read_b64_tr_b16 v[48:49], v22 offset:51200
    v_mfma_f32_32x32x16_bf16 v[208:223], a[204:207], v[52:55], v[208:223]
    ds_read_b64_tr_b16 v[50:51], v22 offset:51712
    s_waitcnt lgkmcnt(4)
    v_mfma_f32_32x32x16_bf16 v[160:175], a[96:99], v[40:43], v[160:175]
    ds_read_b64_tr_b16 v[52:53], v22 offset:59392
    v_mfma_f32_32x32x16_bf16 v[176:191], a[208:211], v[40:43], v[176:191]
    ds_read_b64_tr_b16 v[54:55], v22 offset:59904
    s_waitcnt lgkmcnt(4)
    v_mfma_f32_32x32x16_bf16 v[192:207], a[96:99], v[44:47], v[192:207]
    ds_read_b64_tr_b16 v[40:41], v22 offset:53248
    v_mfma_f32_32x32x16_bf16 v[208:223], a[208:211], v[44:47], v[208:223]
    ds_read_b64_tr_b16 v[42:43], v22 offset:53760
    s_waitcnt lgkmcnt(4)
    v_mfma_f32_32x32x16_bf16 v[160:175], a[100:103], v[48:51], v[160:175]
    ds_read_b64_tr_b16 v[44:45], v22 offset:61440
    v_mfma_f32_32x32x16_bf16 v[176:191], a[212:215], v[48:51], v[176:191]
    ds_read_b64_tr_b16 v[46:47], v22 offset:61952
    s_waitcnt lgkmcnt(4)
    v_mfma_f32_32x32x16_bf16 v[192:207], a[100:103], v[52:55], v[192:207]
    ds_read_b64_tr_b16 v[48:49], v22 offset:55296
    v_mfma_f32_32x32x16_bf16 v[208:223], a[212:215], v[52:55], v[208:223]
    ds_read_b64_tr_b16 v[50:51], v22 offset:55808
    s_waitcnt lgkmcnt(4)
    v_mfma_f32_32x32x16_bf16 v[160:175], a[104:107], v[40:43], v[160:175]
    ds_read_b64_tr_b16 v[52:53], v22 offset:63488
    v_mfma_f32_32x32x16_bf16 v[176:191], a[216:219], v[40:43], v[176:191]
    ds_read_b64_tr_b16 v[54:55], v22 offset:64000
    s_waitcnt lgkmcnt(4)
    v_mfma_f32_32x32x16_bf16 v[192:207], a[104:107], v[44:47], v[192:207]
    v_mfma_f32_32x32x16_bf16 v[208:223], a[216:219], v[44:47], v[208:223]
    s_waitcnt lgkmcnt(2)
    v_mfma_f32_32x32x16_bf16 v[160:175], a[108:111], v[48:51], v[160:175]
    v_mfma_f32_32x32x16_bf16 v[176:191], a[220:223], v[48:51], v[176:191]
    s_waitcnt lgkmcnt(0)
    v_mfma_f32_32x32x16_bf16 v[192:207], a[108:111], v[52:55], v[192:207]
    v_mfma_f32_32x32x16_bf16 v[208:223], a[220:223], v[52:55], v[208:223]
    s_sub_i32 s29, s5, 0
    s_max_i32 s29, s29, 0
    s_lshl_b32 s29, s29, 11
    s_add_u32 s29, s29, 17039360
    s_load_dword s9, s[72:73], s29
    s_sub_i32 s29, s5, 1
    s_max_i32 s29, s29, 0
    s_lshl_b32 s29, s29, 11
    s_add_u32 s29, s29, 17039360
    s_load_dword s10, s[72:73], s29
    s_sub_i32 s29, s5, 2
    s_max_i32 s29, s29, 0
    s_lshl_b32 s29, s29, 11
    s_add_u32 s29, s29, 17039360
    s_load_dword s11, s[72:73], s29
    s_barrier
    s_nop 3
    v_cvt_pk_bf16_f32 v160, v160, v161
    v_cvt_pk_bf16_f32 v161, v162, v163
    v_cvt_pk_bf16_f32 v162, v164, v165
    v_cvt_pk_bf16_f32 v163, v166, v167
    v_cvt_pk_bf16_f32 v164, v168, v169
    v_cvt_pk_bf16_f32 v165, v170, v171
    v_cvt_pk_bf16_f32 v166, v172, v173
    v_cvt_pk_bf16_f32 v167, v174, v175
    buffer_store_dwordx4 v[160:163], v27, s[72:75], s17 offen offset:2048 sc1
    buffer_store_dwordx4 v[164:167], v27, s[72:75], s18 offen offset:2048 sc1
    v_cvt_pk_bf16_f32 v176, v176, v177
    v_cvt_pk_bf16_f32 v177, v178, v179
    v_cvt_pk_bf16_f32 v178, v180, v181
    v_cvt_pk_bf16_f32 v179, v182, v183
    v_cvt_pk_bf16_f32 v180, v184, v185
    v_cvt_pk_bf16_f32 v181, v186, v187
    v_cvt_pk_bf16_f32 v182, v188, v189
    v_cvt_pk_bf16_f32 v183, v190, v191
    buffer_store_dwordx4 v[176:179], v27, s[72:75], s19 offen offset:2048 sc1
    buffer_store_dwordx4 v[180:183], v27, s[72:75], s20 offen offset:2048 sc1
    v_cvt_pk_bf16_f32 v192, v192, v193
    v_cvt_pk_bf16_f32 v193, v194, v195
    v_cvt_pk_bf16_f32 v194, v196, v197
    v_cvt_pk_bf16_f32 v195, v198, v199
    v_cvt_pk_bf16_f32 v196, v200, v201
    v_cvt_pk_bf16_f32 v197, v202, v203
    v_cvt_pk_bf16_f32 v198, v204, v205
    v_cvt_pk_bf16_f32 v199, v206, v207
    buffer_store_dwordx4 v[192:195], v27, s[72:75], s17 offen offset:3072 sc1
    buffer_store_dwordx4 v[196:199], v27, s[72:75], s18 offen offset:3072 sc1
    v_cvt_pk_bf16_f32 v208, v208, v209
    v_cvt_pk_bf16_f32 v209, v210, v211
    v_cvt_pk_bf16_f32 v210, v212, v213
    v_cvt_pk_bf16_f32 v211, v214, v215
    v_cvt_pk_bf16_f32 v212, v216, v217
    v_cvt_pk_bf16_f32 v213, v218, v219
    v_cvt_pk_bf16_f32 v214, v220, v221
    v_cvt_pk_bf16_f32 v215, v222, v223
    buffer_store_dwordx4 v[208:211], v27, s[72:75], s19 offen offset:3072 sc1
    buffer_store_dwordx4 v[212:215], v27, s[72:75], s20 offen offset:3072 sc1
    v_mov_b32 v8, 0x3f803f80
    v_mov_b32 v9, v8
    v_mov_b32 v10, v8
    v_mov_b32 v11, v8
    v_and_b32 v2, 3, v1
    v_bfe_u32 v3, v1, 2, 1
    v_lshlrev_b32 v3, 9, v3
    v_lshl_add_u32 v2, v2, 4, v3
    v_lshrrev_b32 v3, 3, v1
    v_lshl_add_u32 v2, v3, 10, v2
    s_min_u32 s29, s4, 2
    s_lshl_b32 s29, s29, 13
    v_add_u32 v2, s29, v2
    ds_write_b128 v2, v[8:11] offset:25024
    v_lshrrev_b32 v3, 4, v1
    v_min_u32 v3, 2, v3
    v_lshl_add_u32 v7, v3, 2, s22
    v_cmp_gt_u32 vcc, 8, v7
    v_and_b32 v2, 15, v1
    v_lshlrev_b32 v2, 4, v2
    v_lshl_add_u32 v2, v3, 13, v2
    v_mov_b32 v3, 0x3f80
    v_cndmask_b32 v18, 0, v3, vcc
    v_mov_b32 v19, 0
    v_mov_b32 v20, v18
    v_mov_b32 v21, 0
    v_add_u32 v2, s12, v2
    ds_write_b128 v2, v[18:21] offset:1792
    v_add_u32 v13, 13312, v27
    v_and_b32 v18, 31, v1
    v_lshlrev_b32 v18, 2, v18
    v_add_u32 v19, s39, v18
    s_and_b32 s29, s6, 1
    s_lshl1_add_u32 s29, s8, s29
    s_lshr_b32 s30, s6, 3
    s_lshl1_add_u32 s29, s29, s30
    s_lshl_b32 s29, s29, 7
    s_lshl_b32 s3, s5, 11
    s_add_u32 s3, s3, s29
    s_add_u32 s3, s3, 17039872
    s_waitcnt vmcnt(0)
    s_barrier
    s_mov_b32 s35, 1
    s_add_u32 s29, s21, 128
    s_atomic_add s35, s[72:73], s29
    s_lshl_b32 s21, s2, 9
    s_add_u32 s21, s21, 17104896
    s_waitcnt lgkmcnt(0)
    s_min_u32 s9, s9, s10
    s_min_u32 s9, s9, s11
    s_cmp_lt_u32 s9, 14
    s_cbranch_scc1 L_spin_15
L_back_16:
    s_mul_i32 s33, s6, 1792
    s_add_u32 s33, s33, 0
    s_mul_i32 s14, s22, 57344
    s_add_u32 s14, s14, s33
    buffer_load_dwordx2 v[56:57], v25, s[72:75], s14 offen offset:0 sc1
    buffer_load_dwordx2 v[58:59], v25, s[72:75], s14 offen offset:512 sc1
    buffer_load_dwordx2 v[60:61], v25, s[72:75], s14 offen offset:1024 sc1
    buffer_load_dwordx2 v[62:63], v25, s[72:75], s14 offen offset:1536 sc1
    s_add_i32 s29, s22, -8
    s_max_i32 s29, s29, 0
    s_mul_i32 s29, s29, 57344
    s_add_u32 s14, s29, s33
    s_add_u32 m0, s12, 0
    s_add_u32 s14, s14, 28672
    buffer_load_dwordx4 v26, s[72:75], s14 offen sc1 lds
    s_mov_b32 exec_hi, 0xffff
    buffer_load_dwordx4 v26, s[72:75], s14 offen offset:1024 sc1 lds
    s_mov_b32 exec_hi, -1
    s_add_i32 s29, s22, -4
    s_max_i32 s29, s29, 0
    s_mul_i32 s29, s29, 57344
    s_add_u32 s14, s29, s33
    s_add_u32 m0, s12, 8192
    s_add_u32 s14, s14, 28672
    buffer_load_dwordx4 v26, s[72:75], s14 offen sc1 lds
    s_mov_b32 exec_hi, 0xffff
    buffer_load_dwordx4 v26, s[72:75], s14 offen offset:1024 sc1 lds
    s_mov_b32 exec_hi, -1
    s_add_i32 s29, s22, 0
    s_max_i32 s29, s29, 0
    s_mul_i32 s29, s29, 57344
    s_add_u32 s14, s29, s33
    s_add_u32 m0, s12, 16384
    s_add_u32 s14, s14, 28672
    buffer_load_dwordx4 v26, s[72:75], s14 offen sc1 lds
    s_mov_b32 exec_hi, 0xffff
    buffer_load_dwordx4 v26, s[72:75], s14 offen offset:1024 sc1 lds
    s_mov_b32 exec_hi, -1
    s_add_u32 m0, s12, 114688
    s_nop 0
    buffer_load_dwordx4 v28, s[76:79], s36 offen offset:0 lds
    buffer_load_dwordx4 v29, s[76:79], s36 offen offset:1024 lds
    v_readlane_b32 s36, v4, 5
    s_add_u32 m0, s12, 122880
    s_nop 3
    buffer_load_dwordx4 v28, s[76:79], s36 offen offset:0 lds
    buffer_load_dwordx4 v29, s[76:79], s36 offen offset:1024 lds
    v_readlane_b32 s36, v4, 6
    s_add_u32 m0, s12, 131072
    s_nop 3
    buffer_load_dwordx4 v28, s[76:79], s36 offen offset:0 lds
    buffer_load_dwordx4 v29, s[76:79], s36 offen offset:1024 lds
    v_readlane_b32 s36, v4, 7
    s_add_u32 m0, s12, 139264
    s_nop 3
    buffer_load_dwordx4 v28, s[76:79], s36 offen offset:0 lds
    buffer_load_dwordx4 v29, s[76:79], s36 offen offset:1024 lds
    v_readlane_b32 s36, v4, 8
    s_add_u32 m0, s12, 147456
    s_nop 3
    buffer_load_dwordx4 v28, s[76:79], s36 offen offset:0 lds
    buffer_load_dwordx4 v29, s[76:79], s36 offen offset:1024 lds
    v_readlane_b32 s36, v4, 9
    s_waitcnt vmcnt(10)
    s_barrier
    v_mov_b32 v20, 0x40000000
    s_add_u32 m0, s12, 155648
    s_waitcnt vmcnt(0)
    buffer_load_dword v37, v20, s[92:95], 0 offen
    buffer_load_dword v37, v20, s[92:95], 0 offen
    buffer_load_dwordx4 v28, s[76:79], s36 offen offset:0 lds
    buffer_load_dwordx4 v29, s[76:79], s36 offen offset:1024 lds
    v_readlane_b32 s36, v4, 10
    s_add_u32 m0, s12, 49152
    s_nop 3
    buffer_load_dwordx4 v28, s[76:79], s36 offen offset:0 lds
    buffer_load_dwordx4 v29, s[76:79], s36 offen offset:1024 lds
    v_readlane_b32 s36, v4, 11
    s_add_u32 m0, s12, 57344
    s_nop 3
    buffer_load_dwordx4 v28, s[76:79], s36 offen offset:0 lds
    buffer_load_dword v37, v20, s[92:95], 0 offen
    buffer_load_dwordx4 v29, s[76:79], s36 offen offset:1024 lds
    v_readlane_b32 s36, v4, 12
    s_add_u32 m0, s12, 65536
    s_nop 3
    buffer_load_dwordx4 v28, s[76:79], s36 offen offset:0 lds
    buffer_load_dwordx4 v29, s[76:79], s36 offen offset:1024 lds
    v_readlane_b32 s36, v4, 13
    s_add_u32 m0, s12, 73728
    s_nop 3
    buffer_load_dwordx4 v28, s[76:79], s36 offen offset:0 lds
    s_sub_i32 s29, s5, 0
    s_max_i32 s29, s29, 0
    s_lshl_b32 s29, s29, 11
    s_add_u32 s29, s29, 17039488
    s_load_dword s9, s[72:73], s29
    s_sub_i32 s29, s5, 1
    s_max_i32 s29, s29, 0
    s_lshl_b32 s29, s29, 11
    s_add_u32 s29, s29, 17039488
    s_load_dword s10, s[72:73], s29
    s_sub_i32 s29, s5, 2
    s_max_i32 s29, s29, 0
    s_lshl_b32 s29, s29, 11
    s_add_u32 s29, s29, 17039488
    s_load_dword s11, s[72:73], s29
    buffer_load_dwordx4 v29, s[76:79], s36 offen offset:1024 lds
    v_readlane_b32 s36, v4, 14
    buffer_load_dword v37, v20, s[92:95], 0 offen
    buffer_load_dword v37, v20, s[92:95], 0 offen
    buffer_load_dword v37, v20, s[92:95], 0 offen
    s_branch L_shared
L_typeB15:
    s_add_u32 m0, s13, 0
    s_lshl1_add_u32 s15, s0, s9
    buffer_load_dwordx4 v8, s[56:59], s15 offen offset:0 lds
    buffer_load_dwordx4 v9, s[56:59], s15 offen offset:1024 lds
    buffer_load_dwordx4 v10, s[56:59], s15 offen offset:2048 lds
    buffer_load_dwordx4 v11, s[56:59], s15 offen offset:3072 lds
    v_and_b32 v6, 1, v4
    s_lshl_b32 s12, s4, 11
    s_mul_i32 s29, s4, 43008
    s_lshl_b32 s10, s6, 7
    s_cmp_eq_u32 s6, 15
    s_cselect_b32 s30, 384, 0
    s_add_u32 s10, s10, s30
    s_add_u32 s10, s10, s29
    v_lshlrev_b32 v7, 2, v6
    v_xor_b32 v7, v7, v3
    v_mul_u32_u24 v5, 2688, v2
    v_lshl_add_u32 v12, v7, 4, v5
    v_add_u32 v13, 20480, v12
    s_mov_b32 s60, s38
    s_and_b32 s61, s39, 0xffff
    s_mov_b32 s62, 1204224
    s_mov_b32 s63, 0x20000
    s_add_u32 s1, s0, 64
    s_cmp_eq_u32 s1, 448
    s_cselect_b32 s1, 0, s1
    s_add_u32 m0, s12, 16384
    s_mul_i32 s15, s0, 2688
    s_add_u32 s15, s15, s10
    buffer_load_dwordx4 v12, s[60:63], s15 offen offset:0 lds
    buffer_load_dwordx4 v13, s[60:63], s15 offen offset:1024 lds
    v_lshlrev_b32 v7, 1, v6
    v_xor_b32 v7, v7, v3
    v_mul_u32_u24 v5, 3584, v2
    v_lshl_add_u32 v14, v7, 4, v5
    v_add_u32 v15, 27648, v14
    v_lshlrev_b32 v7, 1, v6
    v_xor_b32 v7, v7, v3
    v_xor_b32 v7, 4, v7
    v_mul_u32_u24 v5, 3584, v2
    v_lshl_add_u32 v16, v7, 4, v5
    v_add_u32 v17, 27648, v16
    v_lshlrev_b32 v7, 2, v6
    v_xor_b32 v7, v7, v3
    v_mul_u32_u24 v5, 896, v2
    v_lshl_add_u32 v28, v7, 4, v5
    v_add_u32 v29, 6144, v28
    s_and_b32 s7, s4, 1
    s_lshr_b32 s8, s4, 1
    s_lshl_b32 s11, s6, 8
    s_mul_i32 s29, s4, 57344
    s_add_u32 s11, s11, s29
    s_mov_b32 s64, s44
    s_and_b32 s65, s45, 0xffff
    s_mov_b32 s66, 1605632
    s_mov_b32 s67, 0x20000
    s_mov_b32 s68, s46
    s_and_b32 s69, s47, 0xffff
    s_mov_b32 s70, 1605632
    s_mov_b32 s71, 0x20000
    s_mov_b32 s72, s96
    s_and_b32 s73, s97, 0xffff
    s_mov_b32 s74, 18874368
    s_mov_b32 s75, 0x20000
    s_mov_b32 s80, s40
    s_and_b32 s81, s41, 0xffff
    s_mov_b32 s82, 401408
    s_mov_b32 s83, 0x20000
    s_mov_b32 s76, s48
    s_and_b32 s77, s49, 0xffff
    s_mov_b32 s78, 1605632
    s_mov_b32 s79, 0x20000
    s_mov_b32 s84, s52
    s_and_b32 s85, s53, 0xffff
    s_mov_b32 s86, 1835008
    s_mov_b32 s87, 0x20000
    s_mov_b32 s88, s50
    s_and_b32 s89, s51, 0xffff
    s_mov_b32 s90, 896
    s_mov_b32 s91, 0x20000
    s_mov_b32 s92, s54
    s_and_b32 s93, s55, 0xffff
    s_mov_b32 s94, 256
    s_mov_b32 s95, 0x20000
    s_add_u32 s3, s1, 64
    s_cmp_eq_u32 s3, 448
    s_cselect_b32 s3, 0, s3
    s_add_u32 s96, s3, 64
    s_cmp_eq_u32 s96, 448
    s_cselect_b32 s96, 0, s96
    s_add_u32 s97, s96, 64
    s_cmp_eq_u32 s97, 448
    s_cselect_b32 s97, 0, s97
    s_add_u32 s40, s97, 64
    s_cmp_eq_u32 s40, 448
    s_cselect_b32 s40, 0, s40
    s_add_u32 s41, s40, 64
    s_cmp_eq_u32 s41, 448
    s_cselect_b32 s41, 0, s41
    s_add_u32 s37, s10, 256
    v_min_u32 v2, 11, v1
    v_lshlrev_b32 v2, 7, v2
    s_cmp_eq_u32 s4, 3
    s_cselect_b32 s30, 0, 0x40000000
    v_add_u32 v2, s30, v2
    v_mov_b32 v3, 0
    s_lshl_b32 s29, s5, 11
    s_add_u32 s29, s29, 17039360
    buffer_store_dword v3, v2, s[72:75], s29 offen sc1
    v_and_b32 v2, 31, v1
    v_lshrrev_b32 v3, 5, v1
    v_bfe_u32 v4, v1, 1, 3
    v_xor_b32 v4, v4, v3
    v_lshlrev_b32 v4, 4, v4
    v_lshlrev_b32 v5, 7, v2
    s_lshl_b32 s29, s7, 13
    v_add_u32 v5, s29, v5
    v_xor_b32 v6, 0, v4
    v_add_u32 v18, v5, v6
    v_xor_b32 v6, 32, v4
    v_add_u32 v19, v5, v6
    v_xor_b32 v6, 64, v4
    v_add_u32 v20, v5, v6
    v_xor_b32 v6, 96, v4
    v_add_u32 v21, v5, v6
    v_mul_u32_u24 v6, 7168, v3
    v_lshl_add_u32 v27, v2, 4, v6
    v_bfe_u32 v2, v1, 2, 2
    v_and_b32 v6, 3, v1
    v_bfe_u32 v4, v1, 4, 1
    v_lshl_add_u32 v5, v3, 3, v2
    v_lshlrev_b32 v5, 7, v5
    v_lshl_add_u32 v5, v6, 3, v5
    v_lshl_add_u32 v3, v3, 2, v2
    v_lshlrev_b32 v3, 7, v3
    v_lshl_add_u32 v3, v6, 3, v3
    v_lshrrev_b32 v6, 1, v2
    v_xor_b32 v7, s8, v6
    v_lshlrev_b32 v7, 6, v7
    v_lshl_add_u32 v7, v4, 5, v7
    v_add_u32 v22, v5, v7
    v_add_u32 v3, s12, v3
    v_xor_b32 v7, s7, v6
    v_lshlrev_b32 v7, 6, v7
    v_lshl_add_u32 v7, v4, 5, v7
    v_add_u32 v30, v3, v7
    v_xor_b32 v7, 64, v7
    v_add_u32 v31, v3, v7
    v_lshl_add_u32 v6, v4, 1, v6
    v_lshl_add_u32 v5, v4, 13, v5
    s_lshl_b32 s29, s8, 1
    v_xor_b32 v7, s29, v6
    v_lshl_add_u32 v23, v7, 5, v5
    v_xor_b32 v7, 1, v7
    v_lshl_add_u32 v24, v7, 5, v5
    v_lshlrev_b32 v25, 3, v1
    v_lshlrev_b32 v26, 4, v1
    s_lshl_b32 s29, s5, 11
    s_lshl_b32 s30, s2, 9
    s_add_u32 s30, s30, 65536
    s_cmp_eq_u32 s4, 0
    s_cselect_b32 s21, s29, s30
    s_add_u32 s21, s21, 17039360
    s_add_u32 m0, s12, 24576
    s_add_u32 s15, s15, 128
    buffer_load_dwordx4 v12, s[60:63], s15 offen offset:0 lds
    buffer_load_dwordx4 v13, s[60:63], s15 offen offset:1024 lds
    s_add_u32 m0, s13, 32768
    s_lshl1_add_u32 s15, s1, s9
    buffer_load_dwordx4 v8, s[56:59], s15 offen offset:0 lds
    buffer_load_dwordx4 v9, s[56:59], s15 offen offset:1024 lds
    buffer_load_dwordx4 v10, s[56:59], s15 offen offset:2048 lds
    buffer_load_dwordx4 v11, s[56:59], s15 offen offset:3072 lds
    s_add_u32 m0, s12, 49152
    s_mul_i32 s15, s1, 2688
    s_add_u32 s15, s15, s10
    s_lshr_b32 s29, s2, 3
    s_min_u32 s29, s29, 27
    s_mul_i32 s30, s29, 37
    s_lshr_b32 s30, s30, 8
    s_mul_i32 s31, s30, 7
    s_sub_u32 s24, s29, s31
    s_and_b32 s29, s2, 7
    s_lshl_b32 s29, s29, 2
    s_add_u32 s23, s29, s30
    s_mul_i32 s25, s23, 294912
    s_lshl_b32 s29, s4, 10
    s_add_u32 s25, s25, s29
    s_add_u32 s25, s25, 6291456
    s_lshl_b32 s29, s24, 7
    s_mul_i32 s26, s4, 14336
    s_add_u32 s26, s26, s29
    s_mul_i32 s30, s8, 25088
    s_mul_i32 s31, s7, 14336
    s_add_u32 s27, s30, s31
    s_add_u32 s27, s27, s29
    s_lshr_b32 s28, s23, 1
    s_lshl_b32 s28, s28, 11
    s_add_u32 s28, s28, 17039360
    s_mul_i32 s29, s8, 147456
    v_add_u32 v32, s29, v26
    s_sub_u32 s29, 147456, s29
    v_add_u32 v33, s29, v26
    v_and_b32 v2, 31, v1
    v_lshrrev_b32 v3, 5, v1
    v_lshlrev_b32 v3, 2, v3
    v_sub_u32 v2, v2, v3
    v_mov_b32 v3, 0xf149f2ca
    v_cmp_le_i32 vcc, 0, v2
    v_cmp_le_i32 s[30:31], 1, v2
    s_nop 0
    v_cndmask_b32_e64 v224, v3, 0, vcc
    v_cndmask_b32 v240, 0, v3, vcc
    v_cndmask_b32_e64 v225, v3, 0, s[30:31]
    v_cndmask_b32_e64 v241, 0, v3, s[30:31]
    v_cmp_le_i32 vcc, 2, v2
    v_cmp_le_i32 s[30:31], 3, v2
    s_nop 0
    v_cndmask_b32_e64 v226, v3, 0, vcc
    v_cndmask_b32 v242, 0, v3, vcc
    v_cndmask_b32_e64 v227, v3, 0, s[30:31]
    v_cndmask_b32_e64 v243, 0, v3, s[30:31]
    v_cmp_le_i32 vcc, 8, v2
    v_cmp_le_i32 s[30:31], 9, v2
    s_nop 0
    v_cndmask_b32_e64 v228, v3, 0, vcc
    v_cndmask_b32 v244, 0, v3, vcc
    v_cndmask_b32_e64 v229, v3, 0, s[30:31]
    v_cndmask_b32_e64 v245, 0, v3, s[30:31]
    v_cmp_le_i32 vcc, 10, v2
    v_cmp_le_i32 s[30:31], 11, v2
    s_nop 0
    v_cndmask_b32_e64 v230, v3, 0, vcc
    v_cndmask_b32 v246, 0, v3, vcc
    v_cndmask_b32_e64 v231, v3, 0, s[30:31]
    v_cndmask_b32_e64 v247, 0, v3, s[30:31]
    v_cmp_le_i32 vcc, 16, v2
    v_cmp_le_i32 s[30:31], 17, v2
    s_nop 0
    v_cndmask_b32_e64 v232, v3, 0, vcc
    v_cndmask_b32 v248, 0, v3, vcc
    v_cndmask_b32_e64 v233, v3, 0, s[30:31]
    v_cndmask_b32_e64 v249, 0, v3, s[30:31]
    v_cmp_le_i32 vcc, 18, v2
    v_cmp_le_i32 s[30:31], 19, v2
    s_nop 0
    v_cndmask_b32_e64 v234, v3, 0, vcc
    v_cndmask_b32 v250, 0, v3, vcc
    v_cndmask_b32_e64 v235, v3, 0, s[30:31]
    v_cndmask_b32_e64 v251, 0, v3, s[30:31]
    buffer_load_dwordx4 v12, s[60:63], s15 offen offset:0 lds
    v_cmp_le_i32 vcc, 24, v2
    v_cmp_le_i32 s[30:31], 25, v2
    s_nop 0
    v_cndmask_b32_e64 v236, v3, 0, vcc
    v_cndmask_b32 v252, 0, v3, vcc
    v_cndmask_b32_e64 v237, v3, 0, s[30:31]
    v_cndmask_b32_e64 v253, 0, v3, s[30:31]
    v_cmp_le_i32 vcc, 26, v2
    v_cmp_le_i32 s[30:31], 27, v2
    s_nop 0
    v_cndmask_b32_e64 v238, v3, 0, vcc
    v_cndmask_b32 v254, 0, v3, vcc
    v_cndmask_b32_e64 v239, v3, 0, s[30:31]
    v_cndmask_b32_e64 v255, 0, v3, s[30:31]
    s_lshl_b32 s29, s5, 2
    s_lshl_b32 s30, s7, 1
    s_add_u32 s29, s29, s30
    s_mul_i32 s17, s29, 28672
    s_lshl_b32 s30, s8, 9
    s_add_u32 s17, s17, s30
    s_add_u32 s17, s17, 4198400
    s_add_u32 s18, s17, 14336
    s_add_u32 s19, s17, 28672
    s_add_u32 s20, s18, 28672
    s_lshl_b32 s16, s29, 7
    s_add_u32 s16, s16, 16777216
    s_and_b32 s29, s23, 3
    s_mul_i32 s30, s29, 7
    s_lshr_b32 s30, s30, 1
    s_lshl1_add_u32 s30, s24, s30
    s_lshl1_add_u32 s29, s29, s24
    v_add_u32 v2, s30, v1
    v_mul_u32_u24 v3, 4682, v2
    v_lshrrev_b32 v3, 16, v3
    v_mul_u32_u24 v3, 14, v3
    v_sub_u32 v2, v2, v3
    v_lshlrev_b32 v2, 1, v2
    v_cmp_lt_u32 vcc, 13, v1
    v_add_u32 v3, s29, v1
    v_add_u32 v3, 4, v3
    v_addc_co_u32 v2, vcc, 0, v2, vcc
    v_and_b32 v3, 7, v3
    v_cmp_lt_u32 vcc, 27, v1
    v_mul_u32_u24 v6, 57344, v2
    v_add_u32 v6, s26, v6
    v_mul_u32_u24 v7, 50176, v3
    v_add_u32 v7, s27, v7
    v_cndmask_b32 v4, v6, v7, vcc
    v_add_u32 v3, 28, v3
    v_cndmask_b32 v2, v2, v3, vcc
    v_lshlrev_b32 v2, 12, v2
    v_add_u32 v5, s25, v2
    v_readlane_b32 s36, v4, 0
    v_readlane_b32 s38, v5, 0
    buffer_load_dwordx4 v13, s[60:63], s15 offen offset:1024 lds
    s_add_u32 m0, s12, 57344
    s_add_u32 s15, s15, 128
    s_cmp_ge_u32 s2, 224
    s_cselect_b32 s39, 0x40000000, 0
    v_add_u32 v28, s39, v28
    v_add_u32 v29, s39, v29
    v_add_u32 v32, s39, v32
    v_add_u32 v33, s39, v33
    v_lshrrev_b32 v6, 5, v1
    v_lshlrev_b32 v6, 4, v6
    buffer_load_dwordx4 v12, s[60:63], s15 offen offset:0 lds
    buffer_load_dwordx4 v13, s[60:63], s15 offen offset:1024 lds
    s_add_u32 m0, s13, 65536
    s_lshl1_add_u32 s15, s3, s9
    buffer_load_dwordx4 v8, s[56:59], s15 offen offset:0 lds
    buffer_load_dwordx4 v9, s[56:59], s15 offen offset:1024 lds
    buffer_load_dwordx4 v10, s[56:59], s15 offen offset:2048 lds
    buffer_load_dwordx4 v11, s[56:59], s15 offen offset:3072 lds
    s_add_u32 m0, s12, 81920
    s_mul_i32 s15, s3, 2688
    s_add_u32 s15, s15, s10
    buffer_load_dwordx4 v12, s[60:63], s15 offen offset:0 lds
    s_waitcnt vmcnt(13)
    s_barrier
    ds_read_b64_tr_b16 v[40:41], v22 offset:16384
    ds_read_b128 a[0:3], v18 offset:0
    ds_read_b64_tr_b16 v[42:43], v22 offset:16896
    ds_read_b128 a[112:115], v18 offset:4096
    ds_read_b64_tr_b16 v[44:45], v22 offset:24576
    ds_read_b64_tr_b16 v[46:47], v22 offset:25088
    ds_read_b64_tr_b16 v[48:49], v22 offset:18432
    ds_read_b128 a[4:7], v19 offset:0
    ds_read_b64_tr_b16 v[50:51], v22 offset:18944
    ds_read_b128 a[116:119], v19 offset:4096
    s_waitcnt lgkmcnt(6)
    v_mfma_f32_32x32x16_bf16 v[64:79], a[0:3], v[40:43], 0
    ds_read_b64_tr_b16 v[52:53], v22 offset:26624
    v_mfma_f32_32x32x16_bf16 v[80:95], a[112:115], v[40:43], 0
    ds_read_b64_tr_b16 v[54:55], v22 offset:27136
    buffer_load_dwordx4 v13, s[60:63], s15 offen offset:1024 lds
    s_waitcnt lgkmcnt(6)
    v_mfma_f32_32x32x16_bf16 v[96:111], a[0:3], v[44:47], 0
    ds_read_b64_tr_b16 v[40:41], v22 offset:20480
    ds_read_b128 a[8:11], v20 offset:0
    s_add_u32 m0, s12, 90112
    s_add_u32 s15, s15, 128
    v_mfma_f32_32x32x16_bf16 v[112:127], a[112:115], v[44:47], 0
    ds_read_b64_tr_b16 v[42:43], v22 offset:20992
    ds_read_b128 a[120:123], v20 offset:4096
    s_waitcnt lgkmcnt(6)
    v_mfma_f32_32x32x16_bf16 v[64:79], a[4:7], v[48:51], v[64:79]
    ds_read_b64_tr_b16 v[44:45], v22 offset:28672
    s_cmp_eq_u32 s4, 3
    s_cbranch_scc1 L_go_17
L_go_17_b:
    v_mfma_f32_32x32x16_bf16 v[80:95], a[116:119], v[48:51], v[80:95]
    ds_read_b64_tr_b16 v[46:47], v22 offset:29184
    s_waitcnt lgkmcnt(6)
    v_mfma_f32_32x32x16_bf16 v[96:111], a[4:7], v[52:55], v[96:111]
    ds_read_b64_tr_b16 v[48:49], v22 offset:22528
    ds_read_b128 a[12:15], v21 offset:0
    v_mfma_f32_32x32x16_bf16 v[112:127], a[116:119], v[52:55], v[112:127]
    ds_read_b64_tr_b16 v[50:51], v22 offset:23040
    ds_read_b128 a[124:127], v21 offset:4096
    s_waitcnt lgkmcnt(6)
    v_mfma_f32_32x32x16_bf16 v[64:79], a[8:11], v[40:43], v[64:79]
    ds_read_b64_tr_b16 v[52:53], v22 offset:30720
    buffer_load_dwordx4 v12, s[60:63], s15 offen offset:0 lds
    v_mfma_f32_32x32x16_bf16 v[80:95], a[120:123], v[40:43], v[80:95]
    ds_read_b64_tr_b16 v[54:55], v22 offset:31232
    s_waitcnt lgkmcnt(6)
    v_mfma_f32_32x32x16_bf16 v[96:111], a[8:11], v[44:47], v[96:111]
    buffer_load_dwordx4 v13, s[60:63], s15 offen offset:1024 lds
    s_add_u32 m0, s13, 98304
    s_lshl1_add_u32 s15, s96, s9
    buffer_load_dwordx4 v8, s[56:59], s15 offen offset:0 lds
    buffer_load_dwordx4 v9, s[56:59], s15 offen offset:1024 lds
    buffer_load_dwordx4 v10, s[56:59], s15 offen offset:2048 lds
    buffer_load_dwordx4 v11, s[56:59], s15 offen offset:3072 lds
    s_add_u32 m0, s12, 114688
    s_mul_i32 s15, s96, 2688
    s_add_u32 s15, s15, s10
    buffer_load_dwordx4 v12, s[60:63], s15 offen offset:0 lds
    s_waitcnt vmcnt(13)
    s_barrier
    ds_read_b64_tr_b16 v[40:41], v22 offset:49152
    ds_read_b128 a[16:19], v18 offset:32768
    v_mfma_f32_32x32x16_bf16 v[112:127], a[120:123], v[44:47], v[112:127]
    ds_read_b64_tr_b16 v[42:43], v22 offset:49664
    ds_read_b128 a[128:131], v18 offset:36864
    s_waitcnt lgkmcnt(6)
    v_mfma_f32_32x32x16_bf16 v[64:79], a[12:15], v[48:51], v[64:79]
    ds_read_b64_tr_b16 v[44:45], v22 offset:57344
    buffer_load_dwordx4 v13, s[60:63], s15 offen offset:1024 lds
    v_mfma_f32_32x32x16_bf16 v[80:95], a[124:127], v[48:51], v[80:95]
    ds_read_b64_tr_b16 v[46:47], v22 offset:57856
    s_add_u32 m0, s12, 122880
    s_add_u32 s15, s15, 128
    s_waitcnt lgkmcnt(6)
    v_mfma_f32_32x32x16_bf16 v[96:111], a[12:15], v[52:55], v[96:111]
    ds_read_b64_tr_b16 v[48:49], v22 offset:51200
    ds_read_b128 a[20:23], v19 offset:32768
    buffer_load_dwordx4 v12, s[60:63], s15 offen offset:0 lds
    v_mfma_f32_32x32x16_bf16 v[112:127], a[124:127], v[52:55], v[112:127]
    ds_read_b64_tr_b16 v[50:51], v22 offset:51712
    ds_read_b128 a[132:135], v19 offset:36864
    s_waitcnt lgkmcnt(6)
    v_mfma_f32_32x32x16_bf16 v[64:79], a[16:19], v[40:43], v[64:79]
    ds_read_b64_tr_b16 v[52:53], v22 offset:59392
    v_mfma_f32_32x32x16_bf16 v[80:95], a[128:131], v[40:43], v[80:95]
    ds_read_b64_tr_b16 v[54:55], v22 offset:59904
    buffer_load_dwordx4 v13, s[60:63], s15 offen offset:1024 lds
    s_waitcnt lgkmcnt(6)
    v_mfma_f32_32x32x16_bf16 v[96:111], a[16:19], v[44:47], v[96:111]
    ds_read_b64_tr_b16 v[40:41], v22 offset:53248
    ds_read_b128 a[24:27], v20 offset:32768
    v_mfma_f32_32x32x16_bf16 v[112:127], a[128:131], v[44:47], v[112:127]
    ds_read_b64_tr_b16 v[42:43], v22 offset:53760
    ds_read_b128 a[136:139], v20 offset:36864
    s_add_u32 m0, s13, 131072
    s_lshl1_add_u32 s15, s97, s9
    buffer_load_dwordx4 v8, s[56:59], s15 offen offset:0 lds
    s_waitcnt lgkmcnt(6)
    v_mfma_f32_32x32x16_bf16 v[64:79], a[20:23], v[48:51], v[64:79]
    ds_read_b64_tr_b16 v[44:45], v22 offset:61440
    v_mfma_f32_32x32x16_bf16 v[80:95], a[132:135], v[48:51], v[80:95]
    ds_read_b64_tr_b16 v[46:47], v22 offset:61952
    buffer_load_dwordx4 v9, s[56:59], s15 offen offset:1024 lds
    s_waitcnt lgkmcnt(6)
    v_mfma_f32_32x32x16_bf16 v[96:111], a[20:23], v[52:55], v[96:111]
    ds_read_b64_tr_b16 v[48:49], v22 offset:55296
    ds_read_b128 a[28:31], v21 offset:32768
    v_mfma_f32_32x32x16_bf16 v[112:127], a[132:135], v[52:55], v[112:127]
    ds_read_b64_tr_b16 v[50:51], v22 offset:55808
    ds_read_b128 a[140:143], v21 offset:36864
    buffer_load_dwordx4 v10, s[56:59], s15 offen offset:2048 lds
    s_waitcnt lgkmcnt(6)
    v_mfma_f32_32x32x16_bf16 v[64:79], a[24:27], v[40:43], v[64:79]
    ds_read_b64_tr_b16 v[52:53], v22 offset:63488
    v_mfma_f32_32x32x16_bf16 v[80:95], a[136:139], v[40:43], v[80:95]
    ds_read_b64_tr_b16 v[54:55], v22 offset:64000
    buffer_load_dwordx4 v11, s[56:59], s15 offen offset:3072 lds
    s_waitcnt lgkmcnt(6)
    v_mfma_f32_32x32x16_bf16 v[96:111], a[24:27], v[44:47], v[96:111]
    s_add_u32 m0, s12, 147456
    s_mul_i32 s15, s97, 2688
    s_add_u32 s15, s15, s10
    s_waitcnt vmcnt(12)
    s_barrier
    v_add_u32 v22, 0x10000, v22
    ds_read_b64_tr_b16 v[40:41], v22 offset:16384
    v_add_u32 v18, 0x10000, v18
    ds_read_b128 a[32:35], v18 offset:0
    buffer_load_dwordx4 v12, s[60:63], s15 offen offset:0 lds
    v_mfma_f32_32x32x16_bf16 v[112:127], a[136:139], v[44:47], v[112:127]
    ds_read_b64_tr_b16 v[42:43], v22 offset:16896
    ds_read_b128 a[144:147], v18 offset:4096
    s_waitcnt lgkmcnt(6)
    v_mfma_f32_32x32x16_bf16 v[64:79], a[28:31], v[48:51], v[64:79]
    ds_read_b64_tr_b16 v[44:45], v22 offset:24576
    buffer_load_dwordx4 v13, s[60:63], s15 offen offset:1024 lds
    v_mfma_f32_32x32x16_bf16 v[80:95], a[140:143], v[48:51], v[80:95]
    ds_read_b64_tr_b16 v[46:47], v22 offset:25088
    s_add_u32 m0, s12, 155648
    s_add_u32 s15, s15, 128
    s_waitcnt lgkmcnt(6)
    v_mfma_f32_32x32x16_bf16 v[96:111], a[28:31], v[52:55], v[96:111]
    ds_read_b64_tr_b16 v[48:49], v22 offset:18432
    v_add_u32 v19, 0x10000, v19
    ds_read_b128 a[36:39], v19 offset:0
    buffer_load_dwordx4 v12, s[60:63], s15 offen offset:0 lds
    v_mfma_f32_32x32x16_bf16 v[112:127], a[140:143], v[52:55], v[112:127]
    ds_read_b64_tr_b16 v[50:51], v22 offset:18944
    ds_read_b128 a[148:151], v19 offset:4096
    s_waitcnt lgkmcnt(6)
    v_mfma_f32_32x32x16_bf16 v[64:79], a[32:35], v[40:43], v[64:79]
    ds_read_b64_tr_b16 v[52:53], v22 offset:26624
    buffer_load_dwordx4 v13, s[60:63], s15 offen offset:1024 lds
    v_mfma_f32_32x32x16_bf16 v[80:95], a[144:147], v[40:43], v[80:95]
    ds_read_b64_tr_b16 v[54:55], v22 offset:27136
    s_waitcnt lgkmcnt(6)
    v_mfma_f32_32x32x16_bf16 v[96:111], a[32:35], v[44:47], v[96:111]
    ds_read_b64_tr_b16 v[40:41], v22 offset:20480
    v_add_u32 v20, 0x10000, v20
    ds_read_b128 a[40:43], v20 offset:0
    s_add_u32 m0, s13, 0
    s_lshl1_add_u32 s15, s40, s9
    buffer_load_dwordx4 v8, s[56:59], s15 offen offset:0 lds
    v_mfma_f32_32x32x16_bf16 v[112:127], a[144:147], v[44:47], v[112:127]
    ds_read_b64_tr_b16 v[42:43], v22 offset:20992
    ds_read_b128 a[152:155], v20 offset:4096
    s_waitcnt lgkmcnt(6)
    v_mfma_f32_32x32x16_bf16 v[64:79], a[36:39], v[48:51], v[64:79]
    ds_read_b64_tr_b16 v[44:45], v22 offset:28672
    v_mfma_f32_32x32x16_bf16 v[80:95], a[148:151], v[48:51], v[80:95]
    ds_read_b64_tr_b16 v[46:47], v22 offset:29184
    buffer_load_dwordx4 v9, s[56:59], s15 offen offset:1024 lds
    s_waitcnt lgkmcnt(6)
    v_mfma_f32_32x32x16_bf16 v[96:111], a[36:39], v[52:55], v[96:111]
    ds_read_b64_tr_b16 v[48:49], v22 offset:22528
    v_add_u32 v21, 0x10000, v21
    ds_read_b128 a[44:47], v21 offset:0
    v_mfma_f32_32x32x16_bf16 v[112:127], a[148:151], v[52:55], v[112:127]
    ds_read_b64_tr_b16 v[50:51], v22 offset:23040
    ds_read_b128 a[156:159], v21 offset:4096
    buffer_load_dwordx4 v10, s[56:59], s15 offen offset:2048 lds
    s_waitcnt lgkmcnt(6)
    v_mfma_f32_32x32x16_bf16 v[64:79], a[40:43], v[40:43], v[64:79]
    ds_read_b64_tr_b16 v[52:53], v22 offset:30720
    v_mfma_f32_32x32x16_bf16 v[80:95], a[152:155], v[40:43], v[80:95]
    ds_read_b64_tr_b16 v[54:55], v22 offset:31232
    buffer_load_dwordx4 v11, s[56:59], s15 offen offset:3072 lds
    s_waitcnt lgkmcnt(6)
    v_mfma_f32_32x32x16_bf16 v[96:111], a[40:43], v[44:47], v[96:111]
    s_waitcnt vmcnt(12)
    s_barrier
    ds_read_b64_tr_b16 v[40:41], v22 offset:49152
    ds_read_b128 a[48:51], v18 offset:32768
    s_add_u32 m0, s12, 16384
    s_mul_i32 s15, s40, 2688
    s_add_u32 s15, s15, s10
    v_mfma_f32_32x32x16_bf16 v[112:127], a[152:155], v[44:47], v[112:127]
    ds_read_b64_tr_b16 v[42:43], v22 offset:49664
    ds_read_b128 a[160:163], v18 offset:36864
    buffer_load_dwordx4 v12, s[60:63], s15 offen offset:0 lds
    s_waitcnt lgkmcnt(6)
    v_mfma_f32_32x32x16_bf16 v[64:79], a[44:47], v[48:51], v[64:79]
    ds_read_b64_tr_b16 v[44:45], v22 offset:57344
    buffer_load_dwordx4 v13, s[60:63], s15 offen offset:1024 lds
    v_mfma_f32_32x32x16_bf16 v[80:95], a[156:159], v[48:51], v[80:95]
    ds_read_b64_tr_b16 v[46:47], v22 offset:57856
    s_add_u32 m0, s12, 24576
    s_add_u32 s15, s15, 128
    s_waitcnt lgkmcnt(6)
    v_mfma_f32_32x32x16_bf16 v[96:111], a[44:47], v[52:55], v[96:111]
    ds_read_b64_tr_b16 v[48:49], v22 offset:51200
    ds_read_b128 a[52:55], v19 offset:32768
    buffer_load_dwordx4 v12, s[60:63], s15 offen offset:0 lds
    v_mfma_f32_32x32x16_bf16 v[112:127], a[156:159], v[52:55], v[112:127]
    ds_read_b64_tr_b16 v[50:51], v22 offset:51712
    ds_read_b128 a[164:167], v19 offset:36864
    s_waitcnt lgkmcnt(6)
    v_mfma_f32_32x32x16_bf16 v[64:79], a[48:51], v[40:43], v[64:79]
    ds_read_b64_tr_b16 v[52:53], v22 offset:59392
    buffer_load_dwordx4 v13, s[60:63], s15 offen offset:1024 lds
    v_mfma_f32_32x32x16_bf16 v[80:95], a[160:163], v[40:43], v[80:95]
    ds_read_b64_tr_b16 v[54:55], v22 offset:59904
    s_waitcnt lgkmcnt(6)
    v_mfma_f32_32x32x16_bf16 v[96:111], a[48:51], v[44:47], v[96:111]
    ds_read_b64_tr_b16 v[40:41], v22 offset:53248
    ds_read_b128 a[56:59], v20 offset:32768
    s_add_u32 m0, s13, 32768
    s_lshl1_add_u32 s15, s41, s9
    buffer_load_dwordx4 v8, s[56:59], s15 offen offset:0 lds
    v_mfma_f32_32x32x16_bf16 v[112:127], a[160:163], v[44:47], v[112:127]
    ds_read_b64_tr_b16 v[42:43], v22 offset:53760
    ds_read_b128 a[168:171], v20 offset:36864
    s_waitcnt lgkmcnt(6)
    v_mfma_f32_32x32x16_bf16 v[64:79], a[52:55], v[48:51], v[64:79]
    ds_read_b64_tr_b16 v[44:45], v22 offset:61440
    v_mfma_f32_32x32x16_bf16 v[80:95], a[164:167], v[48:51], v[80:95]
    ds_read_b64_tr_b16 v[46:47], v22 offset:61952
    buffer_load_dwordx4 v9, s[56:59], s15 offen offset:1024 lds
    s_waitcnt lgkmcnt(6)
    v_mfma_f32_32x32x16_bf16 v[96:111], a[52:55], v[52:55], v[96:111]
    ds_read_b64_tr_b16 v[48:49], v22 offset:55296
    ds_read_b128 a[60:63], v21 offset:32768
    v_mfma_f32_32x32x16_bf16 v[112:127], a[164:167], v[52:55], v[112:127]
    ds_read_b64_tr_b16 v[50:51], v22 offset:55808
    ds_read_b128 a[172:175], v21 offset:36864
    buffer_load_dwordx4 v10, s[56:59], s15 offen offset:2048 lds
    s_waitcnt lgkmcnt(6)
    v_mfma_f32_32x32x16_bf16 v[64:79], a[56:59], v[40:43], v[64:79]
    ds_read_b64_tr_b16 v[52:53], v22 offset:63488
    v_mfma_f32_32x32x16_bf16 v[80:95], a[168:171], v[40:43], v[80:95]
    ds_read_b64_tr_b16 v[54:55], v22 offset:64000
    buffer_load_dwordx4 v11, s[56:59], s15 offen offset:3072 lds
    s_waitcnt lgkmcnt(6)
    v_mfma_f32_32x32x16_bf16 v[96:111], a[56:59], v[44:47], v[96:111]
    s_waitcnt vmcnt(12)
    s_barrier
    v_add_u32 v22, 0x10000, v22
    ds_read_b64_tr_b16 v[40:41], v22 offset:16384
    v_add_u32 v18, 0x10000, v18
    ds_read_b128 a[64:67], v18 offset:0
    s_add_u32 m0, s12, 49152
    s_mul_i32 s15, s41, 2688
    s_add_u32 s15, s15, s10
    v_mfma_f32_32x32x16_bf16 v[112:127], a[168:171], v[44:47], v[112:127]
    ds_read_b64_tr_b16 v[42:43], v22 offset:16896
    ds_read_b128 a[176:179], v18 offset:4096
    buffer_load_dwordx4 v12, s[60:63], s15 offen offset:0 lds
    s_waitcnt lgkmcnt(6)
    v_mfma_f32_32x32x16_bf16 v[64:79], a[60:63], v[48:51], v[64:79]
    ds_read_b64_tr_b16 v[44:45], v22 offset:24576
    buffer_load_dwordx4 v13, s[60:63], s15 offen offset:1024 lds
    v_mfma_f32_32x32x16_bf16 v[80:95], a[172:175], v[48:51], v[80:95]
    ds_read_b64_tr_b16 v[46:47], v22 offset:25088
    s_add_u32 m0, s12, 57344
    s_add_u32 s15, s15, 128
    s_waitcnt lgkmcnt(6)
    v_mfma_f32_32x32x16_bf16 v[96:111], a[60:63], v[52:55], v[96:111]
    ds_read_b64_tr_b16 v[48:49], v22 offset:18432
    v_add_u32 v19, 0x10000, v19
    ds_read_b128 a[68:71], v19 offset:0
    buffer_load_dwordx4 v12, s[60:63], s15 offen offset:0 lds
    v_mfma_f32_32x32x16_bf16 v[112:127], a[172:175], v[52:55], v[112:127]
    ds_read_b64_tr_b16 v[50:51], v22 offset:18944
    ds_read_b128 a[180:183], v19 offset:4096
    s_waitcnt lgkmcnt(6)
    v_mfma_f32_32x32x16_bf16 v[64:79], a[64:67], v[40:43], v[64:79]
    ds_read_b64_tr_b16 v[52:53], v22 offset:26624
    buffer_load_dwordx4 v13, s[60:63], s15 offen offset:1024 lds
    v_mfma_f32_32x32x16_bf16 v[80:95], a[176:179], v[40:43], v[80:95]
    ds_read_b64_tr_b16 v[54:55], v22 offset:27136
    s_add_u32 m0, s12, 65536
    s_mul_i32 s15, s0, 2688
    s_add_u32 s15, s15, s37
    s_waitcnt lgkmcnt(6)
    v_mfma_f32_32x32x16_bf16 v[96:111], a[64:67], v[44:47], v[96:111]
    ds_read_b64_tr_b16 v[40:41], v22 offset:20480
    v_add_u32 v20, 0x10000, v20
    ds_read_b128 a[72:75], v20 offset:0
    buffer_load_dwordx4 v12, s[60:63], s15 offen offset:0 lds
    v_mfma_f32_32x32x16_bf16 v[112:127], a[176:179], v[44:47], v[112:127]
    ds_read_b64_tr_b16 v[42:43], v22 offset:20992
    ds_read_b128 a[184:187], v20 offset:4096
    s_waitcnt lgkmcnt(6)
    v_mfma_f32_32x32x16_bf16 v[64:79], a[68:71], v[48:51], v[64:79]
    ds_read_b64_tr_b16 v[44:45], v22 offset:28672
    v_mfma_f32_32x32x16_bf16 v[80:95], a[180:183], v[48:51], v[80:95]
    ds_read_b64_tr_b16 v[46:47], v22 offset:29184
    buffer_load_dwordx4 v13, s[60:63], s15 offen offset:1024 lds
    s_waitcnt lgkmcnt(6)
    v_mfma_f32_32x32x16_bf16 v[96:111], a[68:71], v[52:55], v[96:111]
    ds_read_b64_tr_b16 v[48:49], v22 offset:22528
    v_add_u32 v21, 0x10000, v21
    ds_read_b128 a[76:79], v21 offset:0
    v_mfma_f32_32x32x16_bf16 v[112:127], a[180:183], v[52:55], v[112:127]
    ds_read_b64_tr_b16 v[50:51], v22 offset:23040
    ds_read_b128 a[188:191], v21 offset:4096
    s_waitcnt lgkmcnt(6)
    v_mfma_f32_32x32x16_bf16 v[64:79], a[72:75], v[40:43], v[64:79]
    ds_read_b64_tr_b16 v[52:53], v22 offset:30720
    v_mfma_f32_32x32x16_bf16 v[80:95], a[184:187], v[40:43], v[80:95]
    ds_read_b64_tr_b16 v[54:55], v22 offset:31232
    s_waitcnt lgkmcnt(6)
    v_mfma_f32_32x32x16_bf16 v[96:111], a[72:75], v[44:47], v[96:111]
    s_waitcnt vmcnt(10)
    s_barrier
    v_add_u32 v22, 0xfffe0000, v22
    ds_read_b64_tr_b16 v[40:41], v22 offset:16384
    v_add_u32 v18, 0xfffe0000, v18
    ds_read_b128 a[80:83], v18 offset:0
    v_mfma_f32_32x32x16_bf16 v[112:127], a[184:187], v[44:47], v[112:127]
    ds_read_b64_tr_b16 v[42:43], v22 offset:16896
    ds_read_b128 a[192:195], v18 offset:4096
    s_waitcnt lgkmcnt(6)
    v_mfma_f32_32x32x16_bf16 v[64:79], a[76:79], v[48:51], v[64:79]
    ds_read_b64_tr_b16 v[44:45], v22 offset:24576
    v_mfma_f32_32x32x16_bf16 v[80:95], a[188:191], v[48:51], v[80:95]
    ds_read_b64_tr_b16 v[46:47], v22 offset:25088
    s_waitcnt lgkmcnt(6)
    v_mfma_f32_32x32x16_bf16 v[96:111], a[76:79], v[52:55], v[96:111]
    ds_read_b64_tr_b16 v[48:49], v22 offset:18432
    v_add_u32 v19, 0xfffe0000, v19
    ds_read_b128 a[84:87], v19 offset:0
    v_mfma_f32_32x32x16_bf16 v[112:127], a[188:191], v[52:55], v[112:127]
    ds_read_b64_tr_b16 v[50:51], v22 offset:18944
    ds_read_b128 a[196:199], v19 offset:4096
    s_waitcnt lgkmcnt(6)
    v_mfma_f32_32x32x16_bf16 v[64:79], a[80:83], v[40:43], v[64:79]
    ds_read_b64_tr_b16 v[52:53], v22 offset:26624
    v_mfma_f32_32x32x16_bf16 v[80:95], a[192:195], v[40:43], v[80:95]
    ds_read_b64_tr_b16 v[54:55], v22 offset:27136
    s_waitcnt lgkmcnt(6)
    v_mfma_f32_32x32x16_bf16 v[96:111], a[80:83], v[44:47], v[96:111]
    ds_read_b64_tr_b16 v[40:41], v22 offset:20480
    v_add_u32 v20, 0xfffe0000, v20
    ds_read_b128 a[88:91], v20 offset:0
    v_mfma_f32_32x32x16_bf16 v[112:127], a[192:195], v[44:47], v[112:127]
    ds_read_b64_tr_b16 v[42:43], v22 offset:20992
    ds_read_b128 a[200:203], v20 offset:4096
    s_waitcnt lgkmcnt(6)
    v_mfma_f32_32x32x16_bf16 v[64:79], a[84:87], v[48:51], v[64:79]
    ds_read_b64_tr_b16 v[44:45], v22 offset:28672
    v_mfma_f32_32x32x16_bf16 v[80:95], a[196:199], v[48:51], v[80:95]
    ds_read_b64_tr_b16 v[46:47], v22 offset:29184
    s_waitcnt lgkmcnt(6)
    v_mfma_f32_32x32x16_bf16 v[96:111], a[84:87], v[52:55], v[96:111]
    ds_read_b64_tr_b16 v[48:49], v22 offset:22528
    v_add_u32 v21, 0xfffe0000, v21
    ds_read_b128 a[92:95], v21 offset:0
    v_mfma_f32_32x32x16_bf16 v[112:127], a[196:199], v[52:55], v[112:127]
    ds_read_b64_tr_b16 v[50:51], v22 offset:23040
    ds_read_b128 a[204:207], v21 offset:4096
    s_waitcnt lgkmcnt(6)
    v_mfma_f32_32x32x16_bf16 v[64:79], a[88:91], v[40:43], v[64:79]
    ds_read_b64_tr_b16 v[52:53], v22 offset:30720
    v_mfma_f32_32x32x16_bf16 v[80:95], a[200:203], v[40:43], v[80:95]
    ds_read_b64_tr_b16 v[54:55], v22 offset:31232
    s_waitcnt lgkmcnt(6)
    v_mfma_f32_32x32x16_bf16 v[96:111], a[88:91], v[44:47], v[96:111]
    s_waitcnt vmcnt(2)
    s_barrier
    ds_read_b64_tr_b16 v[40:41], v22 offset:49152
    ds_read_b128 a[96:99], v18 offset:32768
    s_add_u32 m0, s12, 131072
    s_mul_i32 s15, s1, 2688
    s_add_u32 s15, s15, s37
    v_mfma_f32_32x32x16_bf16 v[112:127], a[200:203], v[44:47], v[112:127]
    ds_read_b64_tr_b16 v[42:43], v22 offset:49664
    ds_read_b128 a[208:211], v18 offset:36864
    buffer_load_dwordx4 v12, s[60:63], s15 offen offset:0 lds
    s_waitcnt lgkmcnt(6)
    v_mfma_f32_32x32x16_bf16 v[64:79], a[92:95], v[48:51], v[64:79]
    ds_read_b64_tr_b16 v[44:45], v22 offset:57344
    buffer_load_dwordx4 v13, s[60:63], s15 offen offset:1024 lds
    v_mfma_f32_32x32x16_bf16 v[80:95], a[204:207], v[48:51], v[80:95]
    ds_read_b64_tr_b16 v[46:47], v22 offset:57856
    s_add_u32 m0, s12, 147456
    s_mul_i32 s15, s3, 2688
    s_add_u32 s15, s15, s37
    s_waitcnt lgkmcnt(6)
    v_mfma_f32_32x32x16_bf16 v[96:111], a[92:95], v[52:55], v[96:111]
    ds_read_b64_tr_b16 v[48:49], v22 offset:51200
    ds_read_b128 a[100:103], v19 offset:32768
    buffer_load_dwordx4 v12, s[60:63], s15 offen offset:0 lds
    v_mfma_f32_32x32x16_bf16 v[112:127], a[204:207], v[52:55], v[112:127]
    ds_read_b64_tr_b16 v[50:51], v22 offset:51712
    ds_read_b128 a[212:215], v19 offset:36864
    buffer_load_dwordx4 v13, s[60:63], s15 offen offset:1024 lds
    s_waitcnt lgkmcnt(6)
    v_mfma_f32_32x32x16_bf16 v[64:79], a[96:99], v[40:43], v[64:79]
    ds_read_b64_tr_b16 v[52:53], v22 offset:59392
    s_lshl_b32 s14, s0, 1
    buffer_load_dwordx4 v[128:131], v6, s[88:91], s14 offen offset:0
    v_mfma_f32_32x32x16_bf16 v[80:95], a[208:211], v[40:43], v[80:95]
    ds_read_b64_tr_b16 v[54:55], v22 offset:59904
    s_lshl_b32 s14, s0, 1
    buffer_load_dwordx4 v[132:135], v6, s[88:91], s14 offen offset:32
    s_waitcnt lgkmcnt(6)
    v_mfma_f32_32x32x16_bf16 v[96:111], a[96:99], v[44:47], v[96:111]
    ds_read_b64_tr_b16 v[40:41], v22 offset:53248
    ds_read_b128 a[104:107], v20 offset:32768
    s_lshl_b32 s14, s0, 1
    buffer_load_dwordx4 v[136:139], v6, s[88:91], s14 offen offset:64
    v_mfma_f32_32x32x16_bf16 v[112:127], a[208:211], v[44:47], v[112:127]
    ds_read_b64_tr_b16 v[42:43], v22 offset:53760
    ds_read_b128 a[216:219], v20 offset:36864
    s_lshl_b32 s14, s0, 1
    buffer_load_dwordx4 v[140:143], v6, s[88:91], s14 offen offset:96
    s_waitcnt lgkmcnt(6)
    v_mfma_f32_32x32x16_bf16 v[64:79], a[100:103], v[48:51], v[64:79]
    ds_read_b64_tr_b16 v[44:45], v22 offset:61440
    s_lshl_b32 s14, s1, 1
    buffer_load_dwordx4 v[144:147], v6, s[88:91], s14 offen offset:0
    v_mfma_f32_32x32x16_bf16 v[80:95], a[212:215], v[48:51], v[80:95]
    ds_read_b64_tr_b16 v[46:47], v22 offset:61952
    s_lshl_b32 s14, s1, 1
    buffer_load_dwordx4 v[148:151], v6, s[88:91], s14 offen offset:32
    s_waitcnt lgkmcnt(6)
    v_mfma_f32_32x32x16_bf16 v[96:111], a[100:103], v[52:55], v[96:111]
    ds_read_b64_tr_b16 v[48:49], v22 offset:55296
    ds_read_b128 a[108:111], v21 offset:32768
    s_lshl_b32 s14, s1, 1
    buffer_load_dwordx4 v[152:155], v6, s[88:91], s14 offen offset:64
    v_mfma_f32_32x32x16_bf16 v[112:127], a[212:215], v[52:55], v[112:127]
    ds_read_b64_tr_b16 v[50:51], v22 offset:55808
    ds_read_b128 a[220:223], v21 offset:36864
    s_waitcnt lgkmcnt(6)
    v_mfma_f32_32x32x16_bf16 v[64:79], a[104:107], v[40:43], v[64:79]
    ds_read_b64_tr_b16 v[52:53], v22 offset:63488
    v_mfma_f32_32x32x16_bf16 v[80:95], a[216:219], v[40:43], v[80:95]
    ds_read_b64_tr_b16 v[54:55], v22 offset:64000
    s_waitcnt lgkmcnt(6)
    v_mfma_f32_32x32x16_bf16 v[96:111], a[104:107], v[44:47], v[96:111]
    s_waitcnt vmcnt(11)
    s_barrier
    v_add_u32 v22, 0x10000, v22
    ds_read_b64_tr_b16 v[40:41], v22 offset:0
    s_add_u32 m0, s12, 0
    s_mul_i32 s15, s96, 2688
    s_add_u32 s15, s15, s37
    v_mfma_f32_32x32x16_bf16 v[112:127], a[216:219], v[44:47], v[112:127]
    ds_read_b64_tr_b16 v[42:43], v22 offset:512
    buffer_load_dwordx4 v12, s[60:63], s15 offen offset:0 lds
    s_waitcnt lgkmcnt(4)
    v_mfma_f32_32x32x16_bf16 v[64:79], a[108:111], v[48:51], v[64:79]
    buffer_load_dwordx4 v13, s[60:63], s15 offen offset:1024 lds
    v_mfma_f32_32x32x16_bf16 v[80:95], a[220:223], v[48:51], v[80:95]
    s_add_u32 m0, s12, 16384
    s_mul_i32 s15, s97, 2688
    s_add_u32 s15, s15, s37
    s_waitcnt lgkmcnt(2)
    v_mfma_f32_32x32x16_bf16 v[96:111], a[108:111], v[52:55], v[96:111]
    ds_read_b64_tr_b16 v[48:49], v22 offset:2048
    buffer_load_dwordx4 v12, s[60:63], s15 offen offset:0 lds
    v_mfma_f32_32x32x16_bf16 v[112:127], a[220:223], v[52:55], v[112:127]
    ds_read_b64_tr_b16 v[50:51], v22 offset:2560
    buffer_load_dwordx4 v13, s[60:63], s15 offen offset:1024 lds
    s_waitcnt lgkmcnt(2)
    v_mfma_f32_32x32x16_bf16 v[160:175], a[0:3], v[40:43], 0
    v_mfma_f32_32x32x16_bf16 v[176:191], a[112:115], v[40:43], 0
    s_waitcnt vmcnt(10)
    v_mfma_f32_32x32x16_bf16 v[192:207], v[128:131], a[0:3], 0
    ds_read_b64_tr_b16 v[40:41], v22 offset:4096
    s_lshl_b32 s14, s1, 1
    buffer_load_dwordx4 v[156:159], v6, s[88:91], s14 offen offset:96
    v_mfma_f32_32x32x16_bf16 v[208:223], v[128:131], a[112:115], 0
    ds_read_b64_tr_b16 v[42:43], v22 offset:4608
    s_waitcnt lgkmcnt(2)
    v_mfma_f32_32x32x16_bf16 v[160:175], a[4:7], v[48:51], v[160:175]
    v_mfma_f32_32x32x16_bf16 v[176:191], a[116:119], v[48:51], v[176:191]
    s_waitcnt vmcnt(10)
    v_mfma_f32_32x32x16_bf16 v[192:207], v[132:135], a[4:7], v[192:207]
    ds_read_b64_tr_b16 v[48:49], v22 offset:6144
    s_lshl_b32 s14, s3, 1
    buffer_load_dwordx4 v[128:131], v6, s[88:91], s14 offen offset:0
    v_mfma_f32_32x32x16_bf16 v[208:223], v[132:135], a[116:119], v[208:223]
    ds_read_b64_tr_b16 v[50:51], v22 offset:6656
    s_waitcnt lgkmcnt(2)
    v_mfma_f32_32x32x16_bf16 v[160:175], a[8:11], v[40:43], v[160:175]
    v_mfma_f32_32x32x16_bf16 v[176:191], a[120:123], v[40:43], v[176:191]
    s_waitcnt vmcnt(10)
    v_mfma_f32_32x32x16_bf16 v[192:207], v[136:139], a[8:11], v[192:207]
    s_barrier
    v_add_u32 v22, 0x10000, v22
    ds_read_b64_tr_b16 v[40:41], v22 offset:0
    s_lshl_b32 s14, s3, 1
    buffer_load_dwordx4 v[132:135], v6, s[88:91], s14 offen offset:32
    v_mfma_f32_32x32x16_bf16 v[208:223], v[136:139], a[120:123], v[208:223]
    ds_read_b64_tr_b16 v[42:43], v22 offset:512
    s_add_u32 m0, s12, 32768
    s_mul_i32 s15, s40, 2688
    s_add_u32 s15, s15, s37
    s_waitcnt lgkmcnt(2)
    v_mfma_f32_32x32x16_bf16 v[160:175], a[12:15], v[48:51], v[160:175]
    buffer_load_dwordx4 v12, s[60:63], s15 offen offset:0 lds
    v_mfma_f32_32x32x16_bf16 v[176:191], a[124:127], v[48:51], v[176:191]
    buffer_load_dwordx4 v13, s[60:63], s15 offen offset:1024 lds
    s_waitcnt vmcnt(12)
    v_mfma_f32_32x32x16_bf16 v[192:207], v[140:143], a[12:15], v[192:207]
    ds_read_b64_tr_b16 v[48:49], v22 offset:2048
    s_lshl_b32 s14, s3, 1
    buffer_load_dwordx4 v[136:139], v6, s[88:91], s14 offen offset:64
    v_mfma_f32_32x32x16_bf16 v[208:223], v[140:143], a[124:127], v[208:223]
    ds_read_b64_tr_b16 v[50:51], v22 offset:2560
    s_add_u32 m0, s12, 49152
    s_mul_i32 s15, s41, 2688
    s_add_u32 s15, s15, s37
    s_waitcnt lgkmcnt(2)
    v_mfma_f32_32x32x16_bf16 v[160:175], a[16:19], v[40:43], v[160:175]
    buffer_load_dwordx4 v12, s[60:63], s15 offen offset:0 lds
    v_mfma_f32_32x32x16_bf16 v[176:191], a[128:131], v[40:43], v[176:191]
    buffer_load_dwordx4 v13, s[60:63], s15 offen offset:1024 lds
    s_waitcnt vmcnt(14)
    v_mfma_f32_32x32x16_bf16 v[192:207], v[144:147], a[16:19], v[192:207]
    ds_read_b64_tr_b16 v[40:41], v22 offset:4096
    s_load_dword s9, s[92:93], 0
    v_mfma_f32_32x32x16_bf16 v[208:223], v[144:147], a[128:131], v[208:223]
    ds_read_b64_tr_b16 v[42:43], v22 offset:4608
    s_lshl_b32 s14, s3, 1
    buffer_load_dwordx4 v[140:143], v6, s[88:91], s14 offen offset:96
    s_waitcnt lgkmcnt(2)
    v_mfma_f32_32x32x16_bf16 v[160:175], a[20:23], v[48:51], v[160:175]
    s_add_u32 m0, s12, 81920
    v_mfma_f32_32x32x16_bf16 v[176:191], a[132:135], v[48:51], v[176:191]
    buffer_load_dwordx4 v28, s[76:79], s36 offen offset:0 lds
    s_waitcnt vmcnt(15)
    v_mfma_f32_32x32x16_bf16 v[192:207], v[148:151], a[20:23], v[192:207]
    ds_read_b64_tr_b16 v[48:49], v22 offset:6144
    s_lshl_b32 s14, s96, 1
    buffer_load_dwordx4 v[144:147], v6, s[88:91], s14 offen offset:0
    v_mfma_f32_32x32x16_bf16 v[208:223], v[148:151], a[132:135], v[208:223]
    ds_read_b64_tr_b16 v[50:51], v22 offset:6656
    buffer_load_dwordx4 v29, s[76:79], s36 offen offset:1024 lds
    v_readlane_b32 s36, v4, 1
    s_waitcnt lgkmcnt(2)
    v_mfma_f32_32x32x16_bf16 v[160:175], a[24:27], v[40:43], v[160:175]
    s_add_u32 m0, s12, 90112
    v_mfma_f32_32x32x16_bf16 v[176:191], a[136:139], v[40:43], v[176:191]
    s_waitcnt vmcnt(16)
    v_mfma_f32_32x32x16_bf16 v[192:207], v[152:155], a[24:27], v[192:207]
    s_barrier
    ds_read_b64_tr_b16 v[40:41], v22 offset:16384
    s_lshl_b32 s14, s96, 1
    buffer_load_dwordx4 v[148:151], v6, s[88:91], s14 offen offset:32
    v_mfma_f32_32x32x16_bf16 v[208:223], v[152:155], a[136:139], v[208:223]
    ds_read_b64_tr_b16 v[42:43], v22 offset:16896
    s_waitcnt lgkmcnt(2)
    v_mfma_f32_32x32x16_bf16 v[160:175], a[28:31], v[48:51], v[160:175]
    buffer_load_dwordx4 v28, s[76:79], s36 offen offset:0 lds
    v_mfma_f32_32x32x16_bf16 v[176:191], a[140:143], v[48:51], v[176:191]
    buffer_load_dwordx4 v29, s[76:79], s36 offen offset:1024 lds
    v_readlane_b32 s36, v4, 2
    s_waitcnt vmcnt(14)
    v_mfma_f32_32x32x16_bf16 v[192:207], v[156:159], a[28:31], v[192:207]
    ds_read_b64_tr_b16 v[48:49], v22 offset:18432
    s_lshl_b32 s14, s96, 1
    buffer_load_dwordx4 v[152:155], v6, s[88:91], s14 offen offset:64
    v_mfma_f32_32x32x16_bf16 v[208:223], v[156:159], a[140:143], v[208:223]
    ds_read_b64_tr_b16 v[50:51], v22 offset:18944
    s_add_u32 m0, s12, 98304
    s_waitcnt lgkmcnt(2)
    v_mfma_f32_32x32x16_bf16 v[160:175], a[32:35], v[40:43], v[160:175]
    buffer_load_dwordx4 v28, s[76:79], s36 offen offset:0 lds
    v_mfma_f32_32x32x16_bf16 v[176:191], a[144:147], v[40:43], v[176:191]
    buffer_load_dwordx4 v29, s[76:79], s36 offen offset:1024 lds
    v_readlane_b32 s36, v4, 3
    s_waitcnt vmcnt(16)
    v_mfma_f32_32x32x16_bf16 v[192:207], v[128:131], a[32:35], v[192:207]
    ds_read_b64_tr_b16 v[40:41], v22 offset:20480
    s_lshl_b32 s14, s96, 1
    buffer_load_dwordx4 v[156:159], v6, s[88:91], s14 offen offset:96
    v_mfma_f32_32x32x16_bf16 v[208:223], v[128:131], a[144:147], v[208:223]
    ds_read_b64_tr_b16 v[42:43], v22 offset:20992
    s_add_u32 m0, s12, 106496
    s_waitcnt lgkmcnt(2)
    v_mfma_f32_32x32x16_bf16 v[160:175], a[36:39], v[48:51], v[160:175]
    v_mfma_f32_32x32x16_bf16 v[176:191], a[148:151], v[48:51], v[176:191]
    s_waitcnt vmcnt(16)
    v_mfma_f32_32x32x16_bf16 v[192:207], v[132:135], a[36:39], v[192:207]
    ds_read_b64_tr_b16 v[48:49], v22 offset:22528
    s_lshl_b32 s14, s97, 1
    buffer_load_dwordx4 v[128:131], v6, s[88:91], s14 offen offset:0
    v_mfma_f32_32x32x16_bf16 v[208:223], v[132:135], a[148:151], v[208:223]
    ds_read_b64_tr_b16 v[50:51], v22 offset:23040
    s_waitcnt lgkmcnt(2)
    v_mfma_f32_32x32x16_bf16 v[160:175], a[40:43], v[40:43], v[160:175]
    v_mfma_f32_32x32x16_bf16 v[176:191], a[152:155], v[40:43], v[176:191]
    s_waitcnt vmcnt(14)
    v_mfma_f32_32x32x16_bf16 v[192:207], v[136:139], a[40:43], v[192:207]
    s_barrier
    v_add_u32 v22, 0xfffe0000, v22
    ds_read_b64_tr_b16 v[40:41], v22 offset:0
    s_lshl_b32 s14, s97, 1
    buffer_load_dwordx4 v[132:135], v6, s[88:91], s14 offen offset:32
    v_mfma_f32_32x32x16_bf16 v[208:223], v[136:139], a[152:155], v[208:223]
    ds_read_b64_tr_b16 v[42:43], v22 offset:512
    s_waitcnt lgkmcnt(2)
    v_mfma_f32_32x32x16_bf16 v[160:175], a[44:47], v[48:51], v[160:175]
    s_waitcnt lgkmcnt(0)
    s_cmp_lt_u32 s9, 16
    s_cbranch_scc1 L_spin_18
L_back_19:
    v_mfma_f32_32x32x16_bf16 v[176:191], a[156:159], v[48:51], v[176:191]
    buffer_load_dwordx4 v28, s[76:79], s36 offen offset:0 lds
    v_cvt_pk_bf16_f32 v64, v64, v65
    v_cvt_pk_bf16_f32 v65, v66, v67
    v_cvt_pk_bf16_f32 v66, v68, v69
    s_waitcnt vmcnt(13)
    v_mfma_f32_32x32x16_bf16 v[192:207], v[140:143], a[44:47], v[192:207]
    ds_read_b64_tr_b16 v[48:49], v22 offset:2048
    s_lshl_b32 s14, s97, 1
    buffer_load_dwordx4 v[136:139], v6, s[88:91], s14 offen offset:64
    v_cvt_pk_bf16_f32 v67, v70, v71
    v_cvt_pk_bf16_f32 v68, v72, v73
    v_mfma_f32_32x32x16_bf16 v[208:223], v[140:143], a[156:159], v[208:223]
    ds_read_b64_tr_b16 v[50:51], v22 offset:2560
    buffer_load_dwordx4 v29, s[76:79], s36 offen offset:1024 lds
    v_readlane_b32 s36, v4, 4
    v_cvt_pk_bf16_f32 v69, v74, v75
    v_mfma_f32_32x32x16_bf16 v[160:175], a[48:51], v[40:43], v[160:175]
    v_cvt_pk_bf16_f32 v70, v76, v77
    v_cvt_pk_bf16_f32 v71, v78, v79
    buffer_store_dwordx4 v[64:67], v27, s[72:75], s17 offen offset:0 sc1
    buffer_store_dwordx4 v[68:71], v27, s[72:75], s18 offen offset:0 sc1
    v_cvt_pk_bf16_f32 v80, v80, v81
    v_mfma_f32_32x32x16_bf16 v[176:191], a[160:163], v[40:43], v[176:191]
    v_cvt_pk_bf16_f32 v81, v82, v83
    v_cvt_pk_bf16_f32 v82, v84, v85
    v_cvt_pk_bf16_f32 v83, v86, v87
    v_cvt_pk_bf16_f32 v84, v88, v89
    s_waitcnt vmcnt(15)
    v_mfma_f32_32x32x16_bf16 v[192:207], v[144:147], a[48:51], v[192:207]
    ds_read_b64_tr_b16 v[40:41], v22 offset:4096
    s_lshl_b32 s14, s97, 1
    buffer_load_dwordx4 v[140:143], v6, s[88:91], s14 offen offset:96
    v_cvt_pk_bf16_f32 v85, v90, v91
    v_cvt_pk_bf16_f32 v86, v92, v93
    v_mfma_f32_32x32x16_bf16 v[208:223], v[144:147], a[160:163], v[208:223]
    ds_read_b64_tr_b16 v[42:43], v22 offset:4608
    v_cvt_pk_bf16_f32 v87, v94, v95
    buffer_store_dwordx4 v[80:83], v27, s[72:75], s19 offen offset:0 sc1
    buffer_store_dwordx4 v[84:87], v27, s[72:75], s20 offen offset:0 sc1
    s_waitcnt lgkmcnt(2)
    v_mfma_f32_32x32x16_bf16 v[160:175], a[52:55], v[48:51], v[160:175]
    v_cvt_pk_bf16_f32 v96, v96, v97
    v_cvt_pk_bf16_f32 v97, v98, v99
    v_cvt_pk_bf16_f32 v98, v100, v101
    v_cvt_pk_bf16_f32 v99, v102, v103
    v_cvt_pk_bf16_f32 v100, v104, v105
    v_mfma_f32_32x32x16_bf16 v[176:191], a[164:167], v[48:51], v[176:191]
    v_cvt_pk_bf16_f32 v101, v106, v107
    v_cvt_pk_bf16_f32 v102, v108, v109
    v_cvt_pk_bf16_f32 v103, v110, v111
    buffer_store_dwordx4 v[96:99], v27, s[72:75], s17 offen offset:1024 sc1
    s_waitcnt vmcnt(17)
    v_mfma_f32_32x32x16_bf16 v[192:207], v[148:151], a[52:55], v[192:207]
    ds_read_b64_tr_b16 v[48:49], v22 offset:6144
    s_lshl_b32 s14, s40, 1
    buffer_load_dwordx4 v[144:147], v6, s[88:91], s14 offen offset:0
    buffer_store_dwordx4 v[100:103], v27, s[72:75], s18 offen offset:1024 sc1
    v_cvt_pk_bf16_f32 v112, v112, v113
    v_mfma_f32_32x32x16_bf16 v[208:223], v[148:151], a[164:167], v[208:223]
    ds_read_b64_tr_b16 v[50:51], v22 offset:6656
    v_cvt_pk_bf16_f32 v113, v114, v115
    v_cvt_pk_bf16_f32 v114, v116, v117
    v_cvt_pk_bf16_f32 v115, v118, v119
    s_waitcnt lgkmcnt(2)
    v_mfma_f32_32x32x16_bf16 v[160:175], a[56:59], v[40:43], v[160:175]
    v_cvt_pk_bf16_f32 v116, v120, v121
    v_cvt_pk_bf16_f32 v117, v122, v123
    v_cvt_pk_bf16_f32 v118, v124, v125
    v_cvt_pk_bf16_f32 v119, v126, v127
    buffer_store_dwordx4 v[112:115], v27, s[72:75], s19 offen offset:1024 sc1
    v_mfma_f32_32x32x16_bf16 v[176:191], a[168:171], v[40:43], v[176:191]
    buffer_store_dwordx4 v[116:119], v27, s[72:75], s20 offen offset:1024 sc1
    s_waitcnt vmcnt(18)
    v_mfma_f32_32x32x16_bf16 v[192:207], v[152:155], a[56:59], v[192:207]
    s_barrier
    ds_read_b64_tr_b16 v[40:41], v22 offset:16384
    s_lshl_b32 s14, s40, 1
    buffer_load_dwordx4 v[148:151], v6, s[88:91], s14 offen offset:32
    v_mfma_f32_32x32x16_bf16 v[208:223], v[152:155], a[168:171], v[208:223]
    ds_read_b64_tr_b16 v[42:43], v22 offset:16896
    s_waitcnt lgkmcnt(2)
    v_mfma_f32_32x32x16_bf16 v[160:175], a[60:63], v[48:51], v[160:175]
    v_mfma_f32_32x32x16_bf16 v[176:191], a[172:175], v[48:51], v[176:191]
    s_waitcnt vmcnt(16)
    v_mfma_f32_32x32x16_bf16 v[192:207], v[156:159], a[60:63], v[192:207]
    ds_read_b64_tr_b16 v[48:49], v22 offset:18432
    s_lshl_b32 s14, s40, 1
    buffer_load_dwordx4 v[152:155], v6, s[88:91], s14 offen offset:64
    v_mfma_f32_32x32x16_bf16 v[208:223], v[156:159], a[172:175], v[208:223]
    ds_read_b64_tr_b16 v[50:51], v22 offset:18944
    s_waitcnt lgkmcnt(2)
    v_mfma_f32_32x32x16_bf16 v[160:175], a[64:67], v[40:43], v[160:175]
    v_mfma_f32_32x32x16_bf16 v[176:191], a[176:179], v[40:43], v[176:191]
    s_waitcnt vmcnt(16)
    v_mfma_f32_32x32x16_bf16 v[192:207], v[128:131], a[64:67], v[192:207]
    ds_read_b64_tr_b16 v[40:41], v22 offset:20480
    s_lshl_b32 s14, s40, 1
    buffer_load_dwordx4 v[156:159], v6, s[88:91], s14 offen offset:96
    v_mfma_f32_32x32x16_bf16 v[208:223], v[128:131], a[176:179], v[208:223]
    ds_read_b64_tr_b16 v[42:43], v22 offset:20992
    s_waitcnt lgkmcnt(2)
    v_mfma_f32_32x32x16_bf16 v[160:175], a[68:71], v[48:51], v[160:175]
    v_mfma_f32_32x32x16_bf16 v[176:191], a[180:183], v[48:51], v[176:191]
    s_waitcnt vmcnt(16)
    v_mfma_f32_32x32x16_bf16 v[192:207], v[132:135], a[68:71], v[192:207]
    ds_read_b64_tr_b16 v[48:49], v22 offset:22528
    s_lshl_b32 s14, s41, 1
    buffer_load_dwordx4 v[128:131], v6, s[88:91], s14 offen offset:0
    v_mfma_f32_32x32x16_bf16 v[208:223], v[132:135], a[180:183], v[208:223]
    ds_read_b64_tr_b16 v[50:51], v22 offset:23040
    s_waitcnt lgkmcnt(2)
    v_mfma_f32_32x32x16_bf16 v[160:175], a[72:75], v[40:43], v[160:175]
    v_mfma_f32_32x32x16_bf16 v[176:191], a[184:187], v[40:43], v[176:191]
    s_waitcnt vmcnt(15)
    v_mfma_f32_32x32x16_bf16 v[192:207], v[136:139], a[72:75], v[192:207]
    s_barrier
    ds_read_b64_tr_b16 v[40:41], v22 offset:32768
    s_lshl_b32 s14, s41, 1
    buffer_load_dwordx4 v[132:135], v6, s[88:91], s14 offen offset:32
    v_mfma_f32_32x32x16_bf16 v[208:223], v[136:139], a[184:187], v[208:223]
    ds_read_b64_tr_b16 v[42:43], v22 offset:33280
    s_waitcnt lgkmcnt(2)
    v_mfma_f32_32x32x16_bf16 v[160:175], a[76:79], v[48:51], v[160:175]
    v_mfma_f32_32x32x16_bf16 v[176:191], a[188:191], v[48:51], v[176:191]
    s_waitcnt vmcnt(12)
    v_mfma_f32_32x32x16_bf16 v[192:207], v[140:143], a[76:79], v[192:207]
    ds_read_b64_tr_b16 v[48:49], v22 offset:34816
    s_lshl_b32 s14, s41, 1
    buffer_load_dwordx4 v[136:139], v6, s[88:91], s14 offen offset:64
    v_mfma_f32_32x32x16_bf16 v[208:223], v[140:143], a[188:191], v[208:223]
    ds_read_b64_tr_b16 v[50:51], v22 offset:35328
    s_waitcnt lgkmcnt(2)
    v_mfma_f32_32x32x16_bf16 v[160:175], a[80:83], v[40:43], v[160:175]
    v_mfma_f32_32x32x16_bf16 v[176:191], a[192:195], v[40:43], v[176:191]
    s_waitcnt vmcnt(9)
    v_mfma_f32_32x32x16_bf16 v[192:207], v[144:147], a[80:83], v[192:207]
    ds_read_b64_tr_b16 v[40:41], v22 offset:36864
    s_lshl_b32 s14, s41, 1
    buffer_load_dwordx4 v[140:143], v6, s[88:91], s14 offen offset:96
    v_mfma_f32_32x32x16_bf16 v[208:223], v[144:147], a[192:195], v[208:223]
    ds_read_b64_tr_b16 v[42:43], v22 offset:37376
    s_waitcnt lgkmcnt(2)
    v_mfma_f32_32x32x16_bf16 v[160:175], a[84:87], v[48:51], v[160:175]
    v_mfma_f32_32x32x16_bf16 v[176:191], a[196:199], v[48:51], v[176:191]
    s_waitcnt vmcnt(6)
    v_mfma_f32_32x32x16_bf16 v[192:207], v[148:151], a[84:87], v[192:207]
    ds_read_b64_tr_b16 v[48:49], v22 offset:38912
    v_mfma_f32_32x32x16_bf16 v[208:223], v[148:151], a[196:199], v[208:223]
    ds_read_b64_tr_b16 v[50:51], v22 offset:39424
    s_waitcnt lgkmcnt(2)
    v_mfma_f32_32x32x16_bf16 v[160:175], a[88:91], v[40:43], v[160:175]
    v_mfma_f32_32x32x16_bf16 v[176:191], a[200:203], v[40:43], v[176:191]
    s_waitcnt vmcnt(5)
    v_mfma_f32_32x32x16_bf16 v[192:207], v[152:155], a[88:91], v[192:207]
    s_barrier
    ds_read_b64_tr_b16 v[40:41], v22 offset:49152
    v_mfma_f32_32x32x16_bf16 v[208:223], v[152:155], a[200:203], v[208:223]
    ds_read_b64_tr_b16 v[42:43], v22 offset:49664
    s_waitcnt lgkmcnt(2)
    v_mfma_f32_32x32x16_bf16 v[160:175], a[92:95], v[48:51], v[160:175]
    v_mfma_f32_32x32x16_bf16 v[176:191], a[204:207], v[48:51], v[176:191]
    s_waitcnt vmcnt(4)
    v_mfma_f32_32x32x16_bf16 v[192:207], v[156:159], a[92:95], v[192:207]
    ds_read_b64_tr_b16 v[48:49], v22 offset:51200
    v_mfma_f32_32x32x16_bf16 v[208:223], v[156:159], a[204:207], v[208:223]
    ds_read_b64_tr_b16 v[50:51], v22 offset:51712
    s_waitcnt lgkmcnt(2)
    v_mfma_f32_32x32x16_bf16 v[160:175], a[96:99], v[40:43], v[160:175]
    v_mfma_f32_32x32x16_bf16 v[176:191], a[208:211], v[40:43], v[176:191]
    s_waitcnt vmcnt(3)
    v_mfma_f32_32x32x16_bf16 v[192:207], v[128:131], a[96:99], v[192:207]
    ds_read_b64_tr_b16 v[40:41], v22 offset:53248
    v_mfma_f32_32x32x16_bf16 v[208:223], v[128:131], a[208:211], v[208:223]
    ds_read_b64_tr_b16 v[42:43], v22 offset:53760
    s_waitcnt lgkmcnt(2)
    v_mfma_f32_32x32x16_bf16 v[160:175], a[100:103], v[48:51], v[160:175]
    v_mfma_f32_32x32x16_bf16 v[176:191], a[212:215], v[48:51], v[176:191]
    s_waitcnt vmcnt(2)
    v_mfma_f32_32x32x16_bf16 v[192:207], v[132:135], a[100:103], v[192:207]
    ds_read_b64_tr_b16 v[48:49], v22 offset:55296
    v_mfma_f32_32x32x16_bf16 v[208:223], v[132:135], a[212:215], v[208:223]
    ds_read_b64_tr_b16 v[50:51], v22 offset:55808
    s_waitcnt lgkmcnt(2)
    v_mfma_f32_32x32x16_bf16 v[160:175], a[104:107], v[40:43], v[160:175]
    v_mfma_f32_32x32x16_bf16 v[176:191], a[216:219], v[40:43], v[176:191]
    s_waitcnt vmcnt(1)
    v_mfma_f32_32x32x16_bf16 v[192:207], v[136:139], a[104:107], v[192:207]
    v_mfma_f32_32x32x16_bf16 v[208:223], v[136:139], a[216:219], v[208:223]
    s_waitcnt lgkmcnt(0)
    v_mfma_f32_32x32x16_bf16 v[160:175], a[108:111], v[48:51], v[160:175]
    v_mfma_f32_32x32x16_bf16 v[176:191], a[220:223], v[48:51], v[176:191]
    s_waitcnt vmcnt(0)
    v_mfma_f32_32x32x16_bf16 v[192:207], v[140:143], a[108:111], v[192:207]
    v_mfma_f32_32x32x16_bf16 v[208:223], v[140:143], a[220:223], v[208:223]
    s_sub_i32 s29, s5, 0
    s_max_i32 s29, s29, 0
    s_lshl_b32 s29, s29, 11
    s_add_u32 s29, s29, 17039360
    s_load_dword s9, s[72:73], s29
    s_sub_i32 s29, s5, 1
    s_max_i32 s29, s29, 0
    s_lshl_b32 s29, s29, 11
    s_add_u32 s29, s29, 17039360
    s_load_dword s10, s[72:73], s29
    s_sub_i32 s29, s5, 2
    s_max_i32 s29, s29, 0
    s_lshl_b32 s29, s29, 11
    s_add_u32 s29, s29, 17039360
    s_load_dword s11, s[72:73], s29
    s_barrier
    s_nop 3
    v_cvt_pk_bf16_f32 v160, v160, v161
    v_cvt_pk_bf16_f32 v161, v162, v163
    v_cvt_pk_bf16_f32 v162, v164, v165
    v_cvt_pk_bf16_f32 v163, v166, v167
    v_cvt_pk_bf16_f32 v164, v168, v169
    v_cvt_pk_bf16_f32 v165, v170, v171
    v_cvt_pk_bf16_f32 v166, v172, v173
    v_cvt_pk_bf16_f32 v167, v174, v175
    buffer_store_dwordx4 v[160:163], v27, s[72:75], s17 offen offset:2048 sc1
    buffer_store_dwordx4 v[164:167], v27, s[72:75], s18 offen offset:2048 sc1
    v_cvt_pk_bf16_f32 v176, v176, v177
    v_cvt_pk_bf16_f32 v177, v178, v179
    v_cvt_pk_bf16_f32 v178, v180, v181
    v_cvt_pk_bf16_f32 v179, v182, v183
    v_cvt_pk_bf16_f32 v180, v184, v185
    v_cvt_pk_bf16_f32 v181, v186, v187
    v_cvt_pk_bf16_f32 v182, v188, v189
    v_cvt_pk_bf16_f32 v183, v190, v191
    buffer_store_dwordx4 v[176:179], v27, s[72:75], s19 offen offset:2048 sc1
    buffer_store_dwordx4 v[180:183], v27, s[72:75], s20 offen offset:2048 sc1
    v_and_b32 v6, 31, v1
    v_lshlrev_b32 v6, 2, v6
    v_min_f32 v3, 0x41f00000, v192
    v_mul_f32 v3, 0x3fb8aa3b, v3
    v_exp_f32 v8, v3
    v_min_f32 v3, 0x41f00000, v208
    v_mul_f32 v3, 0x3fb8aa3b, v3
    v_exp_f32 v9, v3
    s_nop 0
    buffer_store_dword v8, v6, s[72:75], s16 offen offset:0 sc1
    buffer_store_dword v9, v6, s[72:75], s16 offen offset:128 sc1
    v_mov_b32 v8, 0x3f803f80
    v_mov_b32 v9, v8
    v_mov_b32 v10, v8
    v_mov_b32 v11, v8
    v_and_b32 v2, 3, v1
    v_bfe_u32 v3, v1, 2, 1
    v_lshlrev_b32 v3, 9, v3
    v_lshl_add_u32 v2, v2, 4, v3
    v_lshrrev_b32 v3, 3, v1
    v_lshl_add_u32 v2, v3, 10, v2
    s_min_u32 s29, s4, 2
    s_lshl_b32 s29, s29, 13
    v_add_u32 v2, s29, v2
    ds_write_b128 v2, v[8:11] offset:25024
    v_lshrrev_b32 v3, 4, v1
    v_min_u32 v3, 2, v3
    v_lshl_add_u32 v7, v3, 2, s22
    v_cmp_gt_u32 vcc, 8, v7
    v_and_b32 v2, 15, v1
    v_lshlrev_b32 v2, 4, v2
    v_lshl_add_u32 v2, v3, 13, v2
    v_mov_b32 v3, 0x3f80
    v_cndmask_b32 v18, 0, v3, vcc
    v_mov_b32 v19, 0
    v_mov_b32 v20, v18
    v_mov_b32 v21, 0
    v_add_u32 v2, s12, v2
    ds_write_b128 v2, v[18:21] offset:1792
    v_add_u32 v13, 13312, v27
    v_and_b32 v18, 31, v1
    v_lshlrev_b32 v18, 2, v18
    v_add_u32 v19, s39, v18
    s_and_b32 s29, s6, 1
    s_lshl1_add_u32 s29, s8, s29
    s_lshr_b32 s30, s6, 3
    s_lshl1_add_u32 s29, s29, s30
    s_lshl_b32 s29, s29, 7
    s_lshl_b32 s3, s5, 11
    s_add_u32 s3, s3, s29
    s_add_u32 s3, s3, 17039872
    s_waitcnt vmcnt(0)
    s_barrier
    s_mov_b32 s35, 1
    s_add_u32 s29, s21, 128
    s_atomic_add s35, s[72:73], s29
    s_lshl_b32 s21, s2, 9
    s_add_u32 s21, s21, 17104896
    s_waitcnt lgkmcnt(0)
    s_min_u32 s9, s9, s10
    s_min_u32 s9, s9, s11
    s_cmp_lt_u32 s9, 14
    s_cbranch_scc1 L_spin_20
L_back_21:
    s_mul_i32 s33, s6, 1792
    s_add_u32 s33, s33, 0
    s_mul_i32 s14, s22, 57344
    s_add_u32 s14, s14, s33
    buffer_load_dwordx2 v[56:57], v25, s[72:75], s14 offen offset:0 sc1
    buffer_load_dwordx2 v[58:59], v25, s[72:75], s14 offen offset:512 sc1
    buffer_load_dwordx2 v[60:61], v25, s[72:75], s14 offen offset:1024 sc1
    buffer_load_dwordx2 v[62:63], v25, s[72:75], s14 offen offset:1536 sc1
    s_add_i32 s29, s22, -8
    s_max_i32 s29, s29, 0
    s_mul_i32 s29, s29, 57344
    s_add_u32 s14, s29, s33
    s_add_u32 m0, s12, 0
    s_add_u32 s14, s14, 28672
    buffer_load_dwordx4 v26, s[72:75], s14 offen sc1 lds
    s_mov_b32 exec_hi, 0xffff
    buffer_load_dwordx4 v26, s[72:75], s14 offen offset:1024 sc1 lds
    s_mov_b32 exec_hi, -1
    s_add_i32 s29, s22, -4
    s_max_i32 s29, s29, 0
    s_mul_i32 s29, s29, 57344
    s_add_u32 s14, s29, s33
    s_add_u32 m0, s12, 8192
    s_add_u32 s14, s14, 28672
    buffer_load_dwordx4 v26, s[72:75], s14 offen sc1 lds
    s_mov_b32 exec_hi, 0xffff
    buffer_load_dwordx4 v26, s[72:75], s14 offen offset:1024 sc1 lds
    s_mov_b32 exec_hi, -1
    s_add_i32 s29, s22, 0
    s_max_i32 s29, s29, 0
    s_mul_i32 s29, s29, 57344
    s_add_u32 s14, s29, s33
    s_add_u32 m0, s12, 16384
    s_add_u32 s14, s14, 28672
    buffer_load_dwordx4 v26, s[72:75], s14 offen sc1 lds
    s_mov_b32 exec_hi, 0xffff
    buffer_load_dwordx4 v26, s[72:75], s14 offen offset:1024 sc1 lds
    s_mov_b32 exec_hi, -1
    s_add_u32 m0, s12, 114688
    s_nop 0
    buffer_load_dwordx4 v28, s[76:79], s36 offen offset:0 lds
    buffer_load_dwordx4 v29, s[76:79], s36 offen offset:1024 lds
    v_readlane_b32 s36, v4, 5
    s_add_u32 m0, s12, 122880
    s_nop 3
    buffer_load_dwordx4 v28, s[76:79], s36 offen offset:0 lds
    buffer_load_dwordx4 v29, s[76:79], s36 offen offset:1024 lds
    v_readlane_b32 s36, v4, 6
    s_add_u32 m0, s12, 131072
    s_nop 3
    buffer_load_dwordx4 v28, s[76:79], s36 offen offset:0 lds
    buffer_load_dwordx4 v29, s[76:79], s36 offen offset:1024 lds
    v_readlane_b32 s36, v4, 7
    s_add_u32 m0, s12, 139264
    s_nop 3
    buffer_load_dwordx4 v28, s[76:79], s36 offen offset:0 lds
    buffer_load_dwordx4 v29, s[76:79], s36 offen offset:1024 lds
    v_readlane_b32 s36, v4, 8
    s_add_u32 m0, s12, 147456
    s_nop 3
    buffer_load_dwordx4 v28, s[76:79], s36 offen offset:0 lds
    buffer_load_dwordx4 v29, s[76:79], s36 offen offset:1024 lds
    v_readlane_b32 s36, v4, 9
    s_waitcnt vmcnt(10)
    s_barrier
    v_mov_b32 v20, 0x40000000
    s_add_u32 m0, s12, 155648
    s_waitcnt vmcnt(0)
    buffer_load_dword v37, v20, s[92:95], 0 offen
    buffer_load_dword v37, v20, s[92:95], 0 offen
    buffer_load_dwordx4 v28, s[76:79], s36 offen offset:0 lds
    buffer_load_dwordx4 v29, s[76:79], s36 offen offset:1024 lds
    v_readlane_b32 s36, v4, 10
    s_add_u32 m0, s12, 49152
    s_nop 3
    buffer_load_dwordx4 v28, s[76:79], s36 offen offset:0 lds
    buffer_load_dwordx4 v29, s[76:79], s36 offen offset:1024 lds
    v_readlane_b32 s36, v4, 11
    s_add_u32 m0, s12, 57344
    s_nop 3
    buffer_load_dwordx4 v28, s[76:79], s36 offen offset:0 lds
    buffer_load_dword v37, v20, s[92:95], 0 offen
    buffer_load_dwordx4 v29, s[76:79], s36 offen offset:1024 lds
    v_readlane_b32 s36, v4, 12
    s_add_u32 m0, s12, 65536
    s_nop 3
    buffer_load_dwordx4 v28, s[76:79], s36 offen offset:0 lds
    buffer_load_dwordx4 v29, s[76:79], s36 offen offset:1024 lds
    v_readlane_b32 s36, v4, 13
    s_add_u32 m0, s12, 73728
    s_nop 3
    buffer_load_dwordx4 v28, s[76:79], s36 offen offset:0 lds
    s_sub_i32 s29, s5, 0
    s_max_i32 s29, s29, 0
    s_lshl_b32 s29, s29, 11
    s_add_u32 s29, s29, 17039488
    s_load_dword s9, s[72:73], s29
    s_sub_i32 s29, s5, 1
    s_max_i32 s29, s29, 0
    s_lshl_b32 s29, s29, 11
    s_add_u32 s29, s29, 17039488
    s_load_dword s10, s[72:73], s29
    s_sub_i32 s29, s5, 2
    s_max_i32 s29, s29, 0
    s_lshl_b32 s29, s29, 11
    s_add_u32 s29, s29, 17039488
    s_load_dword s11, s[72:73], s29
    buffer_load_dwordx4 v29, s[76:79], s36 offen offset:1024 lds
    v_readlane_b32 s36, v4, 14
    buffer_load_dword v37, v20, s[92:95], 0 offen
    buffer_load_dword v37, v20, s[92:95], 0 offen
    buffer_load_dword v37, v20, s[92:95], 0 offen
    s_branch L_shared
L_spin_1:
    s_mov_b32 s34, 0
L_spin_1_l:
    v_mov_b32 v35, 0
    buffer_load_dword v36, v35, s[92:95], 0 offen sc1
    s_waitcnt vmcnt(0)
    v_readfirstlane_b32 s9, v36
    s_nop 0
    s_add_u32 s34, s34, 1
    s_cmp_gt_u32 s34, 200000
    s_cbranch_scc1 L_spin_1_x
    s_cmp_lt_u32 s9, 16
    s_cbranch_scc1 L_spin_1_l
L_spin_1_x:
    s_branch L_back_2
L_spin_3:
    s_mov_b32 s34, 0
L_spin_3_l:
    v_mov_b32 v35, 0
    s_sub_i32 s29, s5, 0
    s_max_i32 s29, s29, 0
    s_lshl_b32 s29, s29, 11
    s_add_u32 s29, s29, 17039360
    buffer_load_dword v36, v35, s[72:75], s29 offen sc1
    s_sub_i32 s29, s5, 1
    s_max_i32 s29, s29, 0
    s_lshl_b32 s29, s29, 11
    s_add_u32 s29, s29, 17039360
    buffer_load_dword v38, v35, s[72:75], s29 offen sc1
    s_sub_i32 s29, s5, 2
    s_max_i32 s29, s29, 0
    s_lshl_b32 s29, s29, 11
    s_add_u32 s29, s29, 17039360
    buffer_load_dword v39, v35, s[72:75], s29 offen sc1
    s_waitcnt vmcnt(0)
    v_readfirstlane_b32 s9, v36
    v_readfirstlane_b32 s10, v38
    v_readfirstlane_b32 s11, v39
    s_nop 0
    s_add_u32 s34, s34, 1
    s_cmp_gt_u32 s34, 200000
    s_cbranch_scc1 L_spin_3_x
    s_min_u32 s9, s9, s10
    s_min_u32 s9, s9, s11
    s_cmp_lt_u32 s9, 14
    s_cbranch_scc1 L_spin_3_l
L_spin_3_x:
    s_branch L_back_4
L_spin_5:
    s_mov_b32 s34, 0
L_spin_5_l:
    v_mov_b32 v35, 0
    s_add_u32 s29, s28, 256
    buffer_load_dword v36, v35, s[72:75], s29 offen sc1
    s_add_u32 s29, s28, 128
    buffer_load_dword v38, v35, s[72:75], s29 offen sc1
    s_waitcnt vmcnt(0)
    v_readfirstlane_b32 s26, v36
    v_readfirstlane_b32 s27, v38
    s_nop 0
    s_add_u32 s34, s34, 1
    s_cmp_gt_u32 s34, 200000
    s_cbranch_scc1 L_spin_5_x
    s_mul_i32 s27, s27, 7
    s_min_u32 s26, s26, s27
    s_max_u32 s26, s26, s39
    s_cmp_lt_u32 s26, 14
    s_cbranch_scc1 L_spin_5_l
L_spin_5_x:
    s_branch L_back_6
L_vfix_7:
    s_mov_b32 s34, 0
L_vfix_7_l:
    v_mov_b32 v35, 0
    s_sub_i32 s29, s5, 0
    s_max_i32 s29, s29, 0
    s_lshl_b32 s29, s29, 11
    s_add_u32 s29, s29, 17039488
    buffer_load_dword v36, v35, s[72:75], s29 offen sc1
    s_sub_i32 s29, s5, 1
    s_max_i32 s29, s29, 0
    s_lshl_b32 s29, s29, 11
    s_add_u32 s29, s29, 17039488
    buffer_load_dword v38, v35, s[72:75], s29 offen sc1
    s_sub_i32 s29, s5, 2
    s_max_i32 s29, s29, 0
    s_lshl_b32 s29, s29, 11
    s_add_u32 s29, s29, 17039488
    buffer_load_dword v39, v35, s[72:75], s29 offen sc1
    s_waitcnt vmcnt(0)
    v_readfirstlane_b32 s9, v36
    v_readfirstlane_b32 s10, v38
    v_readfirstlane_b32 s11, v39
    s_nop 0
    s_add_u32 s34, s34, 1
    s_cmp_gt_u32 s34, 200000
    s_cbranch_scc1 L_vfix_7_x
    s_min_u32 s9, s9, s10
    s_min_u32 s9, s9, s11
    s_cmp_lt_u32 s9, 2
    s_cbranch_scc1 L_vfix_7_l
L_vfix_7_x:
    v_subrev_u32 v27, s0, v27
    v_subrev_u32 v13, s0, v13
    v_subrev_u32 v18, s0, v18
    s_mul_i32 s33, s6, 448
    s_add_u32 s33, s33, 4194304
    s_lshl_b32 s29, s22, 7
    s_add_u32 s29, s29, 16777216
    buffer_load_dword v34, v18, s[72:75], s29 offen sc1
    s_add_i32 s29, s22, -8
    s_max_i32 s29, s29, 0
    s_mul_i32 s29, s29, 28672
    s_add_u32 s14, s29, s33
    s_add_u32 m0, s12, 24576
    s_mov_b32 exec_lo, 0x0fffffff
    s_mov_b32 exec_hi, 0x0fffffff
    buffer_load_dwordx4 v27, s[72:75], s14 offen sc1 lds
    buffer_load_dwordx4 v13, s[72:75], s14 offen offset:1024 sc1 lds
    s_mov_b64 exec, -1
    s_add_i32 s29, s22, -4
    s_max_i32 s29, s29, 0
    s_mul_i32 s29, s29, 28672
    s_add_u32 s14, s29, s33
    s_add_u32 m0, s12, 32768
    s_mov_b32 exec_lo, 0x0fffffff
    s_mov_b32 exec_hi, 0x0fffffff
    buffer_load_dwordx4 v27, s[72:75], s14 offen sc1 lds
    buffer_load_dwordx4 v13, s[72:75], s14 offen offset:1024 sc1 lds
    s_mov_b64 exec, -1
    s_add_i32 s29, s22, 0
    s_max_i32 s29, s29, 0
    s_mul_i32 s29, s29, 28672
    s_add_u32 s14, s29, s33
    s_add_u32 m0, s12, 40960
    s_mov_b32 exec_lo, 0x0fffffff
    s_mov_b32 exec_hi, 0x0fffffff
    buffer_load_dwordx4 v27, s[72:75], s14 offen sc1 lds
    buffer_load_dwordx4 v13, s[72:75], s14 offen offset:1024 sc1 lds
    s_mov_b64 exec, -1
    s_waitcnt vmcnt(0)
    s_branch L_vfixb_8
L_spin_9:
    s_waitcnt vmcnt(0)
    s_mov_b32 s35, 1
    s_atomic_add s35, s[72:73], s3
    s_lshl_b32 s3, s2, 9
    s_add_u32 s3, s3, 17104896
    s_mov_b32 s34, 0
L_spin_9_l:
    v_mov_b32 v35, 0
    s_add_u32 s29, s28, 384
    buffer_load_dword v36, v35, s[72:75], s29 offen sc1
    s_waitcnt vmcnt(0)
    v_readfirstlane_b32 s9, v36
    s_nop 0
    s_add_u32 s34, s34, 1
    s_cmp_gt_u32 s34, 200000
    s_cbranch_scc1 L_spin_9_x
    s_cmp_lt_u32 s9, 14
    s_cbranch_scc1 L_spin_9_l
L_spin_9_x:
    s_branch L_back_10
L_idle:
    s_waitcnt vmcnt(0)
    s_mov_b32 s35, 1
    s_atomic_add s35, s[72:73], s3
    s_waitcnt lgkmcnt(0)
    s_endpgm
L_spin_11:
    s_mov_b32 s34, 0
L_spin_11_l:
    v_mov_b32 v35, 0
    s_and_b32 s29, s23, 1
    s_lshl1_add_u32 s29, s29, s8
    s_lshl_b32 s29, s29, 8
    s_add_u32 s29, s29, s28
    s_add_u32 s29, s29, 512
    buffer_load_dword v36, v35, s[72:75], s29 offen sc1
    s_add_u32 s29, s29, 128
    buffer_load_dword v38, v35, s[72:75], s29 offen sc1
    s_waitcnt vmcnt(0)
    v_readfirstlane_b32 s9, v36
    v_readfirstlane_b32 s10, v38
    s_nop 0
    s_add_u32 s34, s34, 1
    s_cmp_gt_u32 s34, 200000
    s_cbranch_scc1 L_spin_11_x
    s_min_u32 s9, s9, s10
    s_cmp_lt_u32 s9, 8
    s_cbranch_scc1 L_spin_11_l
L_spin_11_x:
    s_branch L_back_12
L_spin_13:
    s_mov_b32 s34, 0
L_spin_13_l:
    v_mov_b32 v35, 0
    buffer_load_dword v36, v35, s[92:95], 0 offen sc1
    s_waitcnt vmcnt(0)
    v_readfirstlane_b32 s9, v36
    s_nop 0
    s_add_u32 s34, s34, 1
    s_cmp_gt_u32 s34, 200000
    s_cbranch_scc1 L_spin_13_x
    s_cmp_lt_u32 s9, 16
    s_cbranch_scc1 L_spin_13_l
L_spin_13_x:
    s_branch L_back_14
L_spin_15:
    s_mov_b32 s34, 0
L_spin_15_l:
    v_mov_b32 v35, 0
    s_sub_i32 s29, s5, 0
    s_max_i32 s29, s29, 0
    s_lshl_b32 s29, s29, 11
    s_add_u32 s29, s29, 17039360
    buffer_load_dword v36, v35, s[72:75], s29 offen sc1
    s_sub_i32 s29, s5, 1
    s_max_i32 s29, s29, 0
    s_lshl_b32 s29, s29, 11
    s_add_u32 s29, s29, 17039360
    buffer_load_dword v38, v35, s[72:75], s29 offen sc1
    s_sub_i32 s29, s5, 2
    s_max_i32 s29, s29, 0
    s_lshl_b32 s29, s29, 11
    s_add_u32 s29, s29, 17039360
    buffer_load_dword v39, v35, s[72:75], s29 offen sc1
    s_waitcnt vmcnt(0)
    v_readfirstlane_b32 s9, v36
    v_readfirstlane_b32 s10, v38
    v_readfirstlane_b32 s11, v39
    s_nop 0
    s_add_u32 s34, s34, 1
    s_cmp_gt_u32 s34, 200000
    s_cbranch_scc1 L_spin_15_x
    s_min_u32 s9, s9, s10
    s_min_u32 s9, s9, s11
    s_cmp_lt_u32 s9, 14
    s_cbranch_scc1 L_spin_15_l
L_spin_15_x:
    s_branch L_back_16
L_go_17:
    s_mov_b32 s35, 1
    s_atomic_add s35, s[92:93], 0
    s_branch L_go_17_b
L_spin_18:
    s_mov_b32 s34, 0
L_spin_18_l:
    v_mov_b32 v35, 0
    buffer_load_dword v36, v35, s[92:95], 0 offen sc1
    s_waitcnt vmcnt(0)
    v_readfirstlane_b32 s9, v36
    s_nop 0
    s_add_u32 s34, s34, 1
    s_cmp_gt_u32 s34, 200000
    s_cbranch_scc1 L_spin_18_x
    s_cmp_lt_u32 s9, 16
    s_cbranch_scc1 L_spin_18_l
L_spin_18_x:
    s_branch L_back_19
L_spin_20:
    s_mov_b32 s34, 0
L_spin_20_l:
    v_mov_b32 v35, 0
    s_sub_i32 s29, s5, 0
    s_max_i32 s29, s29, 0
    s_lshl_b32 s29, s29, 11
    s_add_u32 s29, s29, 17039360
    buffer_load_dword v36, v35, s[72:75], s29 offen sc1
    s_sub_i32 s29, s5, 1
    s_max_i32 s29, s29, 0
    s_lshl_b32 s29, s29, 11
    s_add_u32 s29, s29, 17039360
    buffer_load_dword v38, v35, s[72:75], s29 offen sc1
    s_sub_i32 s29, s5, 2
    s_max_i32 s29, s29, 0
    s_lshl_b32 s29, s29, 11
    s_add_u32 s29, s29, 17039360
    buffer_load_dword v39, v35, s[72:75], s29 offen sc1
    s_waitcnt vmcnt(0)
    v_readfirstlane_b32 s9, v36
    v_readfirstlane_b32 s10, v38
    v_readfirstlane_b32 s11, v39
    s_nop 0
    s_add_u32 s34, s34, 1
    s_cmp_gt_u32 s34, 200000
    s_cbranch_scc1 L_spin_20_x
    s_min_u32 s9, s9, s10
    s_min_u32 s9, s9, s11
    s_cmp_lt_u32 s9, 14
    s_cbranch_scc1 L_spin_20_l
L_spin_20_x:
    s_branch L_back_21
L_code_end:
.section .rodata,"a"
.p2align 6
.amdhsa_kernel gated_mix__sliding_block__glu_gated_glu__prompt_kernel
  .amdhsa_next_free_vgpr 512
  .amdhsa_next_free_sgpr 102
  .amdhsa_accum_offset 256
  .amdhsa_group_segment_fixed_size 0
  .amdhsa_kernarg_size 88
  .amdhsa_user_sgpr_count 2
  .amdhsa_user_sgpr_kernarg_segment_ptr 1
  .amdhsa_system_sgpr_workgroup_id_x 1
.end_amdhsa_kernel
```
